```python
import torch

def _softmax(x, axis=-1):
    return torch.softmax(x, dim=axis)
def _gelu(x):
    return torch.nn.functional.gelu(x, approximate="tanh")
def _silu(x):
    return torch.nn.functional.silu(x)
def _sigmoid(x):
    return torch.sigmoid(x)
def _layernorm(x, axis=-1, eps=1e-5):
    m = x.mean(dim=axis, keepdim=True)
    v = x.var(dim=axis, keepdim=True, unbiased=False)
    return (x - m) / torch.sqrt(v + eps)
def _scatter_add(tgt, idx, src, axis=0):
    return tgt.clone().index_add_(axis, idx, src)
def _segment_sum(src, seg, n):
    out = torch.zeros((n,) + src.shape[1:], dtype=src.dtype)
    return out.index_add_(0, seg, src)
def _pad(x, pw):
    flat = tuple(v for pair in reversed(pw) for v in pair)
    return torch.nn.functional.pad(x, flat)

kernel_name = 'sequential_preLN__linear_kernel_hedgehog__dense_activation_relu__prompt'

def setup_inputs():

    _w = (lambda a: (lambda t: t.to(torch.bfloat16) if t.is_floating_point() else t)(torch.as_tensor(a)))
    def _A_setup():
        B, S, D, H = 1, 2048, 576, 32
        Dh = D // H
        return {
            "x": _w((lambda *s: torch.randn(*s, dtype=torch.bfloat16) * 0.05)(B, S, D)),
            "wqkv": _w((lambda *s: torch.randn(*s, dtype=torch.bfloat16) * 0.2)(D, 3 * D)),
            "w_phi": _w((lambda *s: torch.randn(*s, dtype=torch.bfloat16) * 0.2)(H, Dh, Dh) * (Dh ** -0.5)),
            "wo": _w((lambda *s: torch.randn(*s, dtype=torch.bfloat16) * 0.05)(D, D)),
        }
    _A_in = _A_setup()

    def _B_setup():
        B, S, D, Dff = 1, 2048, 576, 4608
        return {
            "x": _w((lambda *s: torch.randn(*s, dtype=torch.bfloat16) * 0.05)(B, S, D)),
            "w1": _w((lambda *s: torch.randn(*s, dtype=torch.bfloat16) * 0.05)(D, Dff)),
            "w2": _w((lambda *s: torch.randn(*s, dtype=torch.bfloat16) * 0.05)(Dff, D)),
        }
    _B_in = _B_setup()

    return {
        "A_x": _A_in["x"],
        "A_wqkv": _A_in["wqkv"],
        "A_w_phi": _A_in["w_phi"],
        "A_wo": _A_in["wo"],
        "B_x": _B_in["x"],
        "B_w1": _B_in["w1"],
        "B_w2": _B_in["w2"],
    }

def reference(A_x, A_wqkv, A_w_phi, A_wo, B_x, B_w1, B_w2):
    def _A_ref(x, wqkv, w_phi, wo):
        B, S, D = x.shape
        H = 32; Dh = D // H
        qkv = (lambda x, *d: x.permute(*d))((x @ wqkv).reshape(B, S, 3, H, Dh), 2, 0, 3, 1, 4)
        q, k, v = qkv[0], qkv[1], qkv[2]
        pq = torch.einsum("bhsd,hdf->bhsf", q, w_phi)
        pk = torch.einsum("bhsd,hdf->bhsf", k, w_phi)
        phi_q = torch.concatenate([_softmax(pq, axis=-1), _softmax(-pq, axis=-1)], axis=-1)
        phi_k = torch.concatenate([_softmax(pk, axis=-1), _softmax(-pk, axis=-1)], axis=-1)
        kv = torch.einsum("bhsf,bhsd->bhfd", phi_k, v)
        z  = torch.einsum("bhsf->bhf", phi_k)
        num = torch.einsum("bhqf,bhfd->bhqd", phi_q, kv)
        den = torch.einsum("bhqf,bhf->bhq", phi_q, z)[..., None] + 1e-6
        o = num / den
        return (lambda x, *d: x.permute(*d))(o, 0, 2, 1, 3).reshape(B, S, D) @ wo

    def _B_ref(x, w1, w2):
        h = torch.einsum("bsd,df->bsf", x, w1)
        zero = torch.zeros_like(h)
        h = torch.maximum(h, zero)
        return torch.einsum("bsf,fd->bsd", h, w2)

    x = A_x
    h = x + _A_ref(_layernorm(x, axis=-1), A_wqkv, A_w_phi, A_wo)
    h2 = h + _B_ref(_layernorm(h, axis=-1), B_w1, B_w2)
    return h2
```

```asm
; @launch grid=(256,1,1) block=(256,1,1) lds=163840
.amdgcn_target "amdgcn-amd-amdhsa--gfx950"
.text
.globl sequential_preLN__linear_kernel_hedgehog__dense_activation_relu__prompt_kernel
.p2align 8
.type sequential_preLN__linear_kernel_hedgehog__dense_activation_relu__prompt_kernel,@function
sequential_preLN__linear_kernel_hedgehog__dense_activation_relu__prompt_kernel:
    s_cmp_ge_u32 s2, 256
    s_cbranch_scc1 L_k3_end
    s_load_dwordx4 s[4:7], s[0:1], 0
    s_load_dwordx2 s[8:9], s[0:1], 72
    s_load_dwordx2 s[64:65], s[0:1], 16
    s_load_dwordx2 s[66:67], s[0:1], 40
    s_load_dwordx2 s[68:69], s[0:1], 64
    s_load_dwordx2 s[76:77], s[0:1], 48
    s_load_dwordx2 s[78:79], s[0:1], 24
    s_memrealtime s[74:75]
    s_lshr_b32 s10, s2, 7
    s_lshl_b32 s10, s10, 3
    s_and_b32 s11, s2, 7
    s_add_u32 s10, s10, s11
    s_bfe_u32 s11, s2, 0x40003
    s_lshl_b32 s3, s10, 4
    s_add_u32 s3, s3, s11
    v_lshrrev_b32 v2, 6, v0
    v_and_b32 v1, 63, v0
    v_readfirstlane_b32 s20, v2
    v_lshrrev_b32 v3, 3, v1
    v_and_b32 v4, 7, v1
    v_lshrrev_b32 v5, 1, v3
    v_xor_b32 v5, v5, v4
    v_mul_u32_u24 v6, 1152, v3
    v_lshl_add_u32 v8, v5, 4, v6
    v_xor_b32 v6, 64, v8
    v_add_u32 v9, 8192, v6
    v_add_u32 v10, 16384, v8
    v_add_u32 v11, 24576, v6
    s_lshl_b32 s21, s11, 2
    s_add_u32 s21, s21, s20
    s_mul_i32 s22, s21, 36864
    s_mul_i32 s56, s20, 12288
    s_add_u32 s56, s56, 98304
    v_lshrrev_b32 v23, 4, v1
    v_and_b32 v22, 15, v1
    v_and_b32 v6, 1, v23
    v_and_b32 v7, 2, v23
    v_lshl_or_b32 v6, v7, 1, v6
    v_xor_b32 v6, v6, v22
    s_mul_i32 s45, s10, 72
    s_and_b32 s55, s45, 8
    s_and_b32 s48, s45, 0xfffffff0
    s_and_b32 s44, s20, 1
    s_lshl_b32 s44, s44, 3
    v_mul_u32_u24 v35, 3456, v23
    v_mov_b32 v36, 0x7fffff00
    v_xor_b32 v6, s44, v6
    v_and_b32 v7, 7, v6
    v_lshrrev_b32 v34, 3, v6
    v_mul_u32_u24 v34, 1152, v34
    v_cmp_gt_u32 vcc, 5, v7
    v_lshl_add_u32 v33, v7, 4, v35
    v_add_u32 v33, v33, v34
    v_add_u32 v34, 1152, v33
    v_cndmask_b32 v216, v36, v34, vcc
    v_add_u32 v34, 13952, v33
    v_cndmask_b32 v217, v36, v34, vcc
    v_xor_b32 v6, 8, v6
    v_and_b32 v7, 7, v6
    v_lshrrev_b32 v34, 3, v6
    v_mul_u32_u24 v34, 1152, v34
    v_cmp_gt_u32 vcc, 5, v7
    v_lshl_add_u32 v33, v7, 4, v35
    v_add_u32 v33, v33, v34
    v_add_u32 v34, 26752, v33
    v_cndmask_b32 v218, v36, v34, vcc
    v_add_u32 v34, 39552, v33
    v_cndmask_b32 v219, v36, v34, vcc
    s_mul_i32 s46, s20, 6 * 13824
    s_add_u32 s45, s48, s46
    s_mul_i32 s46, s20, 6 * 1024
    s_waitcnt lgkmcnt(0)
    s_mov_b32 s12, s4
    s_mov_b32 s13, s5
    s_mov_b32 s14, 0x240000
    s_mov_b32 s15, 0x20000
    s_mov_b32 s16, s6
    s_mov_b32 s17, s7
    s_mov_b32 s18, 0x1e6000
    s_mov_b32 s19, 0x20000
    s_mov_b32 s24, s78
    s_mov_b32 s25, s79
    s_mov_b32 s26, 0xa2000
    s_mov_b32 s27, 0x20000
    s_lshl_b32 s47, s2, 2
    s_add_u32 s47, s47, s20
    v_lshlrev_b32 v32, 7, v1
    s_mul_i32 s58, s47, 1944
    v_min_u32 v33, 1920, v32
    buffer_load_dword a207, v33, s[16:19], s58 offen
    s_mul_i32 s58, s47, 648
    v_min_u32 v33, 640, v32
    buffer_load_dword a208, v33, s[24:27], s58 offen
    s_add_u32 m0, s56, 0
    s_add_u32 s57, s22, 0
    buffer_load_dwordx4 v8, s[12:15], s57 offen offset:0 lds
    buffer_load_dwordx4 v9, s[12:15], s57 offen offset:1024 lds
    buffer_load_dwordx4 v10, s[12:15], s57 offen offset:2048 lds
    buffer_load_dwordx4 v11, s[12:15], s57 offen offset:3072 lds
    s_add_u32 m0, s56, 4096
    s_add_u32 s57, s22, 128
    buffer_load_dwordx4 v8, s[12:15], s57 offen offset:0 lds
    buffer_load_dwordx4 v9, s[12:15], s57 offen offset:1024 lds
    buffer_load_dwordx4 v10, s[12:15], s57 offen offset:2048 lds
    buffer_load_dwordx4 v11, s[12:15], s57 offen offset:3072 lds
    s_lshl_b32 s52, s20, 12
    s_add_u32 s52, s52, 147456
    s_add_u32 m0, s46, 0
    v_lshrrev_b32 v7, 1, v22
    s_add_u32 s23, s45, 0
    v_xor_b32 v7, v7, v23
    v_lshlrev_b32 v7, 4, v7
    v_lshl_add_u32 v7, v22, 7, v7
    v_add_u32 v12, s56, v7
    v_xor_b32 v13, 64, v12
    v_bfe_u32 v24, v1, 2, 2
    v_and_b32 v25, 3, v1
    v_and_b32 v7, 1, v24
    v_and_b32 v33, 2, v24
    v_lshl_or_b32 v7, v33, 1, v7
    v_and_b32 v37, 1, v23
    v_lshl_or_b32 v7, v37, 3, v7
    v_lshlrev_b32 v7, 4, v7
    v_lshl_add_u32 v38, v23, 3, v24
    v_lshlrev_b32 v33, 8, v38
    v_and_b32 v34, 1, v25
    v_lshrrev_b32 v35, 1, v25
    v_lshlrev_b32 v36, 5, v34
    v_lshl_add_u32 v36, v35, 7, v36
    v_add_u32 v36, s55, v36
    v_lshlrev_b32 v39, 3, v35
    v_xor_b32 v40, 0, v39
    v_add_u32 v40, v40, v36
    v_xor_b32 v40, v40, v7
    v_add_u32 v14, v33, v40
    v_xor_b32 v40, 8, v39
    v_add_u32 v40, v40, v36
    v_xor_b32 v40, v40, v7
    v_add_u32 v15, v33, v40
    v_xor_b32 v40, 16, v39
    v_add_u32 v40, v40, v36
    v_xor_b32 v40, v40, v7
    v_add_u32 v16, v33, v40
    v_xor_b32 v40, 24, v39
    v_add_u32 v40, v40, v36
    v_xor_b32 v40, v40, v7
    v_add_u32 v17, v33, v40
    v_mov_b32 v41, 192
    v_cmp_eq_u32 vcc, 0, v35
    v_add_u32 v40, 32, v36
    v_add_u32 v41, s55, v41
    v_cndmask_b32 v40, v41, v40, vcc
    v_xor_b32 v40, v40, v7
    v_add_u32 v18, v33, v40
    v_lshrrev_b32 v40, 1, v24
    v_lshl_or_b32 v40, v37, 1, v40
    buffer_load_dwordx4 v216, s[16:19], s23 offen offset:0 lds
    v_lshlrev_b32 v40, 5, v40
    v_lshlrev_b32 v33, 7, v38
    v_add_u32 v33, 49152, v33
    v_lshlrev_b32 v41, 3, v25
    v_add_u32 v41, s55, v41
    v_add_u32 v42, 0, v41
    v_xor_b32 v42, v42, v40
    v_add_u32 v19, v33, v42
    v_add_u32 v42, 32, v41
    v_xor_b32 v42, v42, v40
    v_add_u32 v20, v33, v42
    v_mov_b32 v42, 64
    v_add_u32 v42, s55, v42
    buffer_load_dwordx4 v217, s[16:19], s23 offen offset:1024 lds
    v_xor_b32 v42, v42, v40
    v_add_u32 v21, v33, v42
    v_and_b32 v40, 2, v3
    v_xor_b32 v40, v40, v4
    v_mul_u32_u24 v41, 3456, v3
    v_mov_b32 v43, 0x7fffff00
    v_cmp_gt_u32 vcc, 5, v40
    v_lshl_add_u32 v42, v40, 4, v41
    v_add_u32 v42, 0, v42
    v_cndmask_b32 v220, v43, v42, vcc
    v_xor_b32 v40, 4, v40
    v_cmp_gt_u32 vcc, 5, v40
    v_lshl_add_u32 v42, v40, 4, v41
    buffer_load_dwordx4 v218, s[16:19], s23 offen offset:2048 lds
    v_add_u32 v42, 26624, v42
    v_cndmask_b32 v221, v43, v42, vcc
    s_mul_i32 s47, s20, 16 * 3456
    s_add_u32 s48, s48, s47
    s_lshl_b32 s49, s20, 11
    s_add_u32 s49, s49, 49152
    v_mov_b32 v28, 0x3f803f80
    v_mov_b32 v29, 0x3f803f80
    v_mov_b32 v30, 0x3f803f80
    v_mov_b32 v31, 0x3f803f80
    s_add_u32 s32, s8, 0x4c0000
    s_addc_u32 s33, s9, 0
    s_mov_b32 s34, 0x180000
    s_mov_b32 s35, 0x20000
    s_add_u32 s36, s8, 0x0
    s_addc_u32 s37, s9, 0
    s_mov_b32 s38, 0x240000
    s_mov_b32 s39, 0x20000
    s_mov_b32 s28, s66
    s_mov_b32 s29, s67
    s_mov_b32 s30, 0x510000
    s_mov_b32 s31, 0x20000
    buffer_load_dwordx4 v219, s[16:19], s23 offen offset:3072 lds
    v_mov_b32 v244, 0
    s_add_u32 m0, s46, 4096
    v_mov_b32 v245, 0
    s_add_u32 s23, s45, 55296
    v_mov_b32 v246, 0
    buffer_load_dwordx4 v216, s[16:19], s23 offen offset:0 lds
    v_mov_b32 v247, 0
    v_lshlrev_b32 v2, 4, v1
    v_add_u32 v237, s52, v2
    s_and_b32 s47, s20, 1
    s_mul_i32 s59, s47, 720
    s_add_u32 s59, s59, s52
    s_add_u32 s54, s52, 2048
    v_add_u32 v2, 0, v1
    v_mul_u32_u24 v3, 57, v2
    v_lshrrev_b32 v3, 9, v3
    v_lshlrev_b32 v4, 2, v2
    v_lshl_add_u32 v4, v3, 2, v4
    v_add_u32 v238, s59, v4
    buffer_load_dwordx4 v217, s[16:19], s23 offen offset:1024 lds
    s_barrier
    v_add_u32 v2, 64, v1
    s_add_u32 m0, s56, 8192
    v_mul_u32_u24 v3, 57, v2
    s_add_u32 s57, s22, 256
    v_lshrrev_b32 v3, 9, v3
    v_lshlrev_b32 v4, 2, v2
    v_lshl_add_u32 v4, v3, 2, v4
    v_add_u32 v239, s59, v4
    v_add_u32 v2, 128, v1
    v_mul_u32_u24 v3, 57, v2
    v_lshrrev_b32 v3, 9, v3
    v_lshlrev_b32 v4, 2, v2
    v_lshl_add_u32 v4, v3, 2, v4
    v_add_u32 v240, s59, v4
    buffer_load_dwordx4 v8, s[12:15], s57 offen offset:0 lds
    v_cmp_gt_u32 vcc, 162, v2
    v_mov_b32 v3, s54
    v_mul_u32_u24 v2, 40, v24
    v_cndmask_b32 v240, v3, v240, vcc
    v_add_u32 v2, 147456, v2
    v_mov_b32 v3, 155648
    v_mul_u32_u24 v4, 4096 + 640, v37
    v_cmp_eq_u32 vcc, v23, v25
    v_add_u32 v4, v4, v2
    buffer_load_dwordx4 v9, s[12:15], s57 offen offset:1024 lds
    v_lshrrev_b32 v5, 1, v23
    v_cndmask_b32 v235, v3, v4, vcc
    v_cmp_eq_u32 vcc, v5, v35
    v_lshl_add_u32 v4, v34, 12, v2
    v_mul_u32_u24 v5, 160, v37
    v_add_u32 v4, v4, v5
    v_cndmask_b32 v236, v3, v4, vcc
    v_mov_b32 v26, v37
    v_mov_b32 v27, v38
    s_getpc_b64 s[70:71]
L_pc_1:
    s_lshr_b32 s72, s2, 3
    s_mul_i32 s72, s72, 1024
    buffer_load_dwordx4 v10, s[12:15], s57 offen offset:2048 lds
    v_lshlrev_b32 v252, 2, v0
    v_add_u32 v252, s72, v252
    v_min_u32 v252, L_k1_last - L_pc_1 - 8, v252
    global_load_dword v254, v252, s[70:71]
    s_mov_b32 s60, s68
    s_mov_b32 s61, s69
    s_mov_b32 s62, 0x100
    s_mov_b32 s63, 0x20000
    s_mov_b32 s40, s64
    s_mov_b32 s41, s65
    s_mov_b32 s42, 0x5100
    s_mov_b32 s43, 0x20000
    s_or_b32 s74, s74, 1
    buffer_load_dwordx4 v11, s[12:15], s57 offen offset:3072 lds
    v_mov_b32 v248, s74
    s_add_u32 m0, s46, 24576
    v_mov_b32 v249, s75
    s_add_u32 s23, s45, 331776
    v_mov_b32 v250, 0
    buffer_load_dwordx4 v216, s[16:19], s23 offen offset:0 lds
    v_mov_b32 v251, 0
    v_cmp_eq_u32 vcc, 0, v0
    v_mov_b32 v6, 0x7fffff00
    s_lshl_b32 s47, s10, 1
    v_cndmask_b32 v6, v6, 0, vcc
    s_lshl_b32 s59, s10, 4
    buffer_atomic_cmpswap_x2 v[248:251], v6, s[60:63], s59 offen sc0 sc1
    s_add_u32 s47, s47, s20
    s_mul_i32 s47, s47, 648
    s_cmp_lt_u32 s20, 2
    s_cselect_b32 s47, s47, 0x7fff0000
    v_lshlrev_b32 v6, 2, v1
    buffer_load_dword a204, v6, s[40:43], s47 offen offset:0
    buffer_load_dword a205, v6, s[40:43], s47 offen offset:256
    buffer_load_dword a206, v6, s[40:43], s47 offen offset:512
    buffer_load_dwordx4 v217, s[16:19], s23 offen offset:1024 lds
    buffer_load_dwordx4 v218, s[16:19], s23 offen offset:2048 lds
    buffer_load_dwordx4 v219, s[16:19], s23 offen offset:3072 lds
    s_waitcnt vmcnt(23)
    ds_read_b128 a[0:3], v12 offset:0
    ds_read_b128 a[72:75], v12 offset:2048
    ds_read_b128 a[4:7], v13 offset:0
    ds_read_b128 a[76:79], v13 offset:2048
    s_waitcnt vmcnt(19)
    ds_read_b128 a[8:11], v12 offset:4096
    ds_read_b128 a[80:83], v12 offset:6144
    ds_read_b128 a[12:15], v13 offset:4096
    ds_read_b128 a[84:87], v13 offset:6144
    s_waitcnt vmcnt(13)
    s_barrier
    ds_read_b64_tr_b16 v[132:133], v14 offset:0
    ds_read_b64_tr_b16 v[134:135], v14 offset:1024
    ds_read_b64_tr_b16 v[136:137], v15 offset:0
    ds_read_b64_tr_b16 v[138:139], v15 offset:1024
    ds_read_b64_tr_b16 v[140:141], v16 offset:0
    ds_read_b64_tr_b16 v[142:143], v16 offset:1024
    ds_read_b64_tr_b16 v[144:145], v17 offset:0
    s_waitcnt lgkmcnt(14)
    ds_read_b64_tr_b16 v[146:147], v17 offset:1024
    s_waitcnt lgkmcnt(14)
    s_waitcnt lgkmcnt(4)
    v_mfma_f32_16x16x32_bf16 v[32:35], v[132:135], a[0:3], 0
    ds_read_b64_tr_b16 v[148:149], v18 offset:0
    s_add_u32 m0, s46, 28672
    v_mfma_f32_16x16x32_bf16 v[36:39], v[132:135], a[72:75], 0
    ds_read_b64_tr_b16 v[150:151], v18 offset:1024
    s_add_u32 s23, s45, 387072
    v_mfma_f32_16x16x32_bf16 v[96:99], v[28:31], v[132:135], 0
    v_mfma_f32_16x16x32_bf16 v[40:43], v[136:139], a[0:3], 0
    ds_read_b64_tr_b16 v[152:153], v14 offset:8192
    s_lshl_b32 s47, s20, 5
    v_mfma_f32_16x16x32_bf16 v[44:47], v[136:139], a[72:75], 0
    ds_read_b64_tr_b16 v[154:155], v14 offset:9216
    v_lshrrev_b32 v5, 1, v23
    v_mfma_f32_16x16x32_bf16 v[100:103], v[28:31], v[136:139], 0
    s_waitcnt lgkmcnt(4)
    v_mfma_f32_16x16x32_bf16 v[48:51], v[140:143], a[0:3], 0
    ds_read_b64_tr_b16 v[132:133], v15 offset:8192
    v_lshl_add_u32 v4, v5, 4, v22
    v_mfma_f32_16x16x32_bf16 v[52:55], v[140:143], a[72:75], 0
    ds_read_b64_tr_b16 v[134:135], v15 offset:9216
    v_add_u32 v4, s47, v4
    v_mfma_f32_16x16x32_bf16 v[104:107], v[28:31], v[140:143], 0
    v_mfma_f32_16x16x32_bf16 v[56:59], v[144:147], a[0:3], 0
    ds_read_b64_tr_b16 v[136:137], v16 offset:8192
    v_mul_u32_u24 v2, 80, v4
    v_mfma_f32_16x16x32_bf16 v[60:63], v[144:147], a[72:75], 0
    ds_read_b64_tr_b16 v[138:139], v16 offset:9216
    v_add_u32 v2, 24576, v2
    v_mfma_f32_16x16x32_bf16 v[108:111], v[28:31], v[144:147], 0
    buffer_load_dwordx4 v216, s[16:19], s23 offen offset:0 lds
    s_waitcnt lgkmcnt(4)
    v_mfma_f32_16x16x32_bf16 v[64:67], v[148:151], a[0:3], 0
    ds_read_b64_tr_b16 v[140:141], v17 offset:8192
    v_lshl_add_u32 v232, v26, 5, v2
    v_mfma_f32_16x16x32_bf16 v[68:71], v[148:151], a[72:75], 0
    ds_read_b64_tr_b16 v[142:143], v17 offset:9216
    v_lshl_add_u32 v233, v26, 3, v2
    v_mfma_f32_16x16x32_bf16 v[112:115], v[28:31], v[148:151], 0
    buffer_load_dwordx4 v217, s[16:19], s23 offen offset:1024 lds
    v_mfma_f32_16x16x32_bf16 v[116:119], v[28:31], a[0:3], 0
    v_mfma_f32_16x16x32_bf16 v[124:127], a[0:3], a[0:3], 0
    v_mfma_f32_16x16x32_bf16 v[120:123], v[28:31], a[72:75], 0
    v_mfma_f32_16x16x32_bf16 v[128:131], a[72:75], a[72:75], 0
    v_mfma_f32_16x16x32_bf16 v[32:35], v[152:155], a[4:7], v[32:35]
    ds_read_b64_tr_b16 v[144:145], v18 offset:8192
    s_add_u32 m0, s56, 0
    v_mfma_f32_16x16x32_bf16 v[36:39], v[152:155], a[76:79], v[36:39]
    ds_read_b64_tr_b16 v[146:147], v18 offset:9216
    s_add_u32 s57, s22, 384
    v_mfma_f32_16x16x32_bf16 v[96:99], v[28:31], v[152:155], v[96:99]
    buffer_load_dwordx4 v8, s[12:15], s57 offen offset:0 lds
    s_waitcnt lgkmcnt(4)
    v_mfma_f32_16x16x32_bf16 v[40:43], v[132:135], a[4:7], v[40:43]
    ds_read_b64_tr_b16 v[148:149], v14 offset:16384
    v_mul_u32_u24 v4, 96, v4
    v_mfma_f32_16x16x32_bf16 v[44:47], v[132:135], a[76:79], v[44:47]
    ds_read_b64_tr_b16 v[150:151], v14 offset:17408
    v_mul_u32_u24 v5, 12288, v26
    v_mfma_f32_16x16x32_bf16 v[100:103], v[28:31], v[132:135], v[100:103]
    buffer_load_dwordx4 v9, s[12:15], s57 offen offset:1024 lds
    v_mfma_f32_16x16x32_bf16 v[48:51], v[136:139], a[4:7], v[48:51]
    ds_read_b64_tr_b16 v[152:153], v15 offset:16384
    v_add_u32 v234, v4, v5
    v_mfma_f32_16x16x32_bf16 v[52:55], v[136:139], a[76:79], v[52:55]
    ds_read_b64_tr_b16 v[154:155], v15 offset:17408
    v_mul_u32_u24 v2, 96, v27
    v_mfma_f32_16x16x32_bf16 v[104:107], v[28:31], v[136:139], v[104:107]
    buffer_load_dwordx4 v10, s[12:15], s57 offen offset:2048 lds
    s_waitcnt lgkmcnt(4)
    v_mfma_f32_16x16x32_bf16 v[56:59], v[140:143], a[4:7], v[56:59]
    ds_read_b64_tr_b16 v[132:133], v16 offset:16384
    v_lshl_add_u32 v2, v25, 3, v2
    v_mfma_f32_16x16x32_bf16 v[60:63], v[140:143], a[76:79], v[60:63]
    ds_read_b64_tr_b16 v[134:135], v16 offset:17408
    v_mul_u32_u24 v3, 80, v27
    v_mfma_f32_16x16x32_bf16 v[108:111], v[28:31], v[140:143], v[108:111]
    buffer_load_dwordx4 v11, s[12:15], s57 offen offset:3072 lds
    v_mfma_f32_16x16x32_bf16 v[64:67], v[144:147], a[4:7], v[64:67]
    ds_read_b64_tr_b16 v[136:137], v17 offset:16384
    s_add_u32 m0, s56, 4096
    v_mfma_f32_16x16x32_bf16 v[68:71], v[144:147], a[76:79], v[68:71]
    ds_read_b64_tr_b16 v[138:139], v17 offset:17408
    s_add_u32 s57, s22, 512
    v_mfma_f32_16x16x32_bf16 v[112:115], v[28:31], v[144:147], v[112:115]
    s_waitcnt vmcnt(14)
    ds_read_b128 a[16:19], v12 offset:8192
    v_mfma_f32_16x16x32_bf16 v[116:119], v[28:31], a[4:7], v[116:119]
    ds_read_b128 a[88:91], v12 offset:10240
    v_mfma_f32_16x16x32_bf16 v[124:127], a[4:7], a[4:7], v[124:127]
    buffer_load_dwordx4 v8, s[12:15], s57 offen offset:0 lds
    v_mfma_f32_16x16x32_bf16 v[120:123], v[28:31], a[76:79], v[120:123]
    ds_read_b128 a[20:23], v13 offset:8192
    v_mfma_f32_16x16x32_bf16 v[128:131], a[76:79], a[76:79], v[128:131]
    buffer_load_dwordx4 v9, s[12:15], s57 offen offset:1024 lds
    s_waitcnt lgkmcnt(7)
    v_mfma_f32_16x16x32_bf16 v[32:35], v[148:151], a[8:11], v[32:35]
    ds_read_b64_tr_b16 v[140:141], v18 offset:16384
    v_add_u32 v3, 24576, v3
    v_mfma_f32_16x16x32_bf16 v[36:39], v[148:151], a[80:83], v[36:39]
    ds_read_b64_tr_b16 v[142:143], v18 offset:17408
    v_add_u32 v4, 72, v3
    v_mfma_f32_16x16x32_bf16 v[96:99], v[28:31], v[148:151], v[96:99]
    buffer_load_dwordx4 v10, s[12:15], s57 offen offset:2048 lds
    ds_read_b128 a[92:95], v13 offset:10240
    buffer_load_dwordx4 v11, s[12:15], s57 offen offset:3072 lds
    s_waitcnt vmcnt(8)
    s_barrier
    v_mfma_f32_16x16x32_bf16 v[40:43], v[152:155], a[8:11], v[40:43]
    ds_read_b64_tr_b16 v[144:145], v14 offset:24576
    s_add_u32 m0, s46, 49152
    v_mfma_f32_16x16x32_bf16 v[44:47], v[152:155], a[80:83], v[44:47]
    ds_read_b64_tr_b16 v[146:147], v14 offset:25600
    s_add_u32 s23, s45, 663552
    v_mfma_f32_16x16x32_bf16 v[100:103], v[28:31], v[152:155], v[100:103]
    buffer_load_dwordx4 v216, s[16:19], s23 offen offset:0 lds
    s_waitcnt lgkmcnt(8)
    v_mfma_f32_16x16x32_bf16 v[48:51], v[132:135], a[8:11], v[48:51]
    ds_read_b64_tr_b16 v[148:149], v15 offset:24576
    v_mov_b32 v7, 0x7fffff00
    v_mfma_f32_16x16x32_bf16 v[52:55], v[132:135], a[80:83], v[52:55]
    ds_read_b64_tr_b16 v[150:151], v15 offset:25600
    s_add_u32 s53, s20, 0
    v_mfma_f32_16x16x32_bf16 v[104:107], v[28:31], v[132:135], v[104:107]
    buffer_load_dwordx4 v217, s[16:19], s23 offen offset:1024 lds
    v_mfma_f32_16x16x32_bf16 v[56:59], v[136:139], a[8:11], v[56:59]
    ds_read_b64_tr_b16 v[152:153], v16 offset:24576
    s_cmp_ge_u32 s53, 3
    s_cselect_b32 s54, 1, 0
    v_mfma_f32_16x16x32_bf16 v[60:63], v[136:139], a[80:83], v[60:63]
    ds_read_b64_tr_b16 v[154:155], v16 offset:25600
    s_mul_i32 s58, s54, 3
    v_mfma_f32_16x16x32_bf16 v[108:111], v[28:31], v[136:139], v[108:111]
    s_waitcnt lgkmcnt(4)
    v_mfma_f32_16x16x32_bf16 v[64:67], v[140:143], a[8:11], v[64:67]
    ds_read_b64_tr_b16 v[132:133], v17 offset:24576
    s_sub_u32 s58, s53, s58
    v_mfma_f32_16x16x32_bf16 v[68:71], v[140:143], a[80:83], v[68:71]
    ds_read_b64_tr_b16 v[134:135], v17 offset:25600
    s_min_u32 s59, s58, 2
    v_mfma_f32_16x16x32_bf16 v[112:115], v[28:31], v[140:143], v[112:115]
    buffer_load_dwordx4 v218, s[16:19], s23 offen offset:2048 lds
    v_mfma_f32_16x16x32_bf16 v[116:119], v[28:31], a[8:11], v[116:119]
    buffer_load_dwordx4 v219, s[16:19], s23 offen offset:3072 lds
    v_mfma_f32_16x16x32_bf16 v[124:127], a[8:11], a[8:11], v[124:127]
    v_mfma_f32_16x16x32_bf16 v[120:123], v[28:31], a[80:83], v[120:123]
    v_mfma_f32_16x16x32_bf16 v[128:131], a[80:83], a[80:83], v[128:131]
    s_add_u32 m0, s46, 53248
    s_add_u32 s23, s45, 718848
    buffer_load_dwordx4 v216, s[16:19], s23 offen offset:0 lds
    buffer_load_dwordx4 v217, s[16:19], s23 offen offset:1024 lds
    v_mfma_f32_16x16x32_bf16 v[32:35], v[144:147], a[12:15], v[32:35]
    ds_read_b64_tr_b16 v[136:137], v18 offset:24576
    s_add_u32 m0, s56, 8192
    v_mfma_f32_16x16x32_bf16 v[36:39], v[144:147], a[84:87], v[36:39]
    ds_read_b64_tr_b16 v[138:139], v18 offset:25600
    s_add_u32 s57, s22, 640
    v_mfma_f32_16x16x32_bf16 v[96:99], v[28:31], v[144:147], v[96:99]
    s_waitcnt lgkmcnt(4)
    v_mfma_f32_16x16x32_bf16 v[40:43], v[148:151], a[12:15], v[40:43]
    ds_read_b64_tr_b16 v[140:141], v14 offset:32768
    s_mul_i32 s47, s54, 12288
    v_mfma_f32_16x16x32_bf16 v[44:47], v[148:151], a[84:87], v[44:47]
    ds_read_b64_tr_b16 v[142:143], v14 offset:33792
    s_lshl_b32 s59, s59, 5
    v_mfma_f32_16x16x32_bf16 v[100:103], v[28:31], v[148:151], v[100:103]
    v_mfma_f32_16x16x32_bf16 v[48:51], v[152:155], a[12:15], v[48:51]
    ds_read_b64_tr_b16 v[144:145], v15 offset:32768
    s_add_u32 s47, s47, s59
    v_mfma_f32_16x16x32_bf16 v[52:55], v[152:155], a[84:87], v[52:55]
    ds_read_b64_tr_b16 v[146:147], v15 offset:33792
    v_add_u32 v222, s47, v2
    v_mfma_f32_16x16x32_bf16 v[104:107], v[28:31], v[152:155], v[104:107]
    s_waitcnt lgkmcnt(4)
    v_mfma_f32_16x16x32_bf16 v[56:59], v[132:135], a[12:15], v[56:59]
    ds_read_b64_tr_b16 v[148:149], v16 offset:32768
    s_lshl_b32 s47, s54, 5
    v_mfma_f32_16x16x32_bf16 v[60:63], v[132:135], a[84:87], v[60:63]
    ds_read_b64_tr_b16 v[150:151], v16 offset:33792
    v_add_u32 v5, s47, v3
    v_mfma_f32_16x16x32_bf16 v[108:111], v[28:31], v[132:135], v[108:111]
    buffer_load_dwordx4 v8, s[12:15], s57 offen offset:0 lds
    v_mfma_f32_16x16x32_bf16 v[64:67], v[136:139], a[12:15], v[64:67]
    ds_read_b64_tr_b16 v[152:153], v17 offset:32768
    v_lshl_add_u32 v223, v25, 3, v5
    v_mfma_f32_16x16x32_bf16 v[68:71], v[136:139], a[84:87], v[68:71]
    ds_read_b64_tr_b16 v[154:155], v17 offset:33792
    v_cmp_eq_u32 vcc, 0, v25
    v_mfma_f32_16x16x32_bf16 v[112:115], v[28:31], v[136:139], v[112:115]
    buffer_load_dwordx4 v9, s[12:15], s57 offen offset:1024 lds
    v_mfma_f32_16x16x32_bf16 v[116:119], v[28:31], a[12:15], v[116:119]
    buffer_load_dwordx4 v10, s[12:15], s57 offen offset:2048 lds
    v_mfma_f32_16x16x32_bf16 v[124:127], a[12:15], a[12:15], v[124:127]
    buffer_load_dwordx4 v11, s[12:15], s57 offen offset:3072 lds
    v_mfma_f32_16x16x32_bf16 v[120:123], v[28:31], a[84:87], v[120:123]
    v_mfma_f32_16x16x32_bf16 v[128:131], a[84:87], a[84:87], v[128:131]
    s_waitcnt lgkmcnt(4)
    v_mfma_f32_16x16x32_bf16 v[32:35], v[140:143], a[16:19], v[32:35]
    ds_read_b64_tr_b16 v[132:133], v18 offset:32768
    s_add_u32 m0, s46, 73728
    v_mfma_f32_16x16x32_bf16 v[36:39], v[140:143], a[88:91], v[36:39]
    ds_read_b64_tr_b16 v[134:135], v18 offset:33792
    s_add_u32 s23, s45, 995328
    v_mfma_f32_16x16x32_bf16 v[96:99], v[28:31], v[140:143], v[96:99]
    buffer_load_dwordx4 v216, s[16:19], s23 offen offset:0 lds
    v_mfma_f32_16x16x32_bf16 v[40:43], v[144:147], a[16:19], v[40:43]
    ds_read_b64_tr_b16 v[136:137], v14 offset:40960
    v_add_u32 v5, 32, v5
    v_mfma_f32_16x16x32_bf16 v[44:47], v[144:147], a[88:91], v[44:47]
    ds_read_b64_tr_b16 v[138:139], v14 offset:41984
    s_lshl_b32 s47, s54, 1
    v_mfma_f32_16x16x32_bf16 v[100:103], v[28:31], v[144:147], v[100:103]
    s_waitcnt lgkmcnt(4)
    v_mfma_f32_16x16x32_bf16 v[48:51], v[148:151], a[16:19], v[48:51]
    ds_read_b64_tr_b16 v[140:141], v15 offset:40960
    v_cndmask_b32 v224, v4, v5, vcc
    v_mfma_f32_16x16x32_bf16 v[52:55], v[148:151], a[88:91], v[52:55]
    ds_read_b64_tr_b16 v[142:143], v15 offset:41984
    v_subrev_u32 v225, s47, v22
    v_mfma_f32_16x16x32_bf16 v[104:107], v[28:31], v[148:151], v[104:107]
    buffer_load_dwordx4 v217, s[16:19], s23 offen offset:1024 lds
    v_mfma_f32_16x16x32_bf16 v[56:59], v[152:155], a[16:19], v[56:59]
    ds_read_b64_tr_b16 v[144:145], v16 offset:40960
    s_sub_u32 s59, 16, s47
    v_mfma_f32_16x16x32_bf16 v[60:63], v[152:155], a[88:91], v[60:63]
    ds_read_b64_tr_b16 v[146:147], v16 offset:41984
    v_add_u32 v226, s59, v22
    v_mfma_f32_16x16x32_bf16 v[108:111], v[28:31], v[152:155], v[108:111]
    s_waitcnt vmcnt(16)
    ds_read_b128 a[24:27], v12 offset:0
    s_waitcnt lgkmcnt(5)
    v_mfma_f32_16x16x32_bf16 v[64:67], v[132:135], a[16:19], v[64:67]
    ds_read_b64_tr_b16 v[148:149], v17 offset:40960
    v_cmp_gt_u32 vcc, 18, v226
    v_mfma_f32_16x16x32_bf16 v[68:71], v[132:135], a[88:91], v[68:71]
    ds_read_b64_tr_b16 v[150:151], v17 offset:41984
    v_mov_b32 v5, 64
    v_mfma_f32_16x16x32_bf16 v[112:115], v[28:31], v[132:135], v[112:115]
    buffer_load_dwordx4 v218, s[16:19], s23 offen offset:2048 lds
    v_mfma_f32_16x16x32_bf16 v[116:119], v[28:31], a[16:19], v[116:119]
    ds_read_b128 a[96:99], v12 offset:2048
    v_mfma_f32_16x16x32_bf16 v[124:127], a[16:19], a[16:19], v[124:127]
    buffer_load_dwordx4 v219, s[16:19], s23 offen offset:3072 lds
    v_mfma_f32_16x16x32_bf16 v[120:123], v[28:31], a[88:91], v[120:123]
    ds_read_b128 a[28:31], v13 offset:0
    v_mfma_f32_16x16x32_bf16 v[128:131], a[88:91], a[88:91], v[128:131]
    ds_read_b128 a[100:103], v13 offset:2048
    v_mfma_f32_16x16x32_bf16 v[32:35], v[136:139], a[20:23], v[32:35]
    ds_read_b64_tr_b16 v[152:153], v18 offset:40960
    s_add_u32 m0, s46, 77824
    v_mfma_f32_16x16x32_bf16 v[36:39], v[136:139], a[92:95], v[36:39]
    ds_read_b64_tr_b16 v[154:155], v18 offset:41984
    s_add_u32 s23, s45, 1050624
    v_mfma_f32_16x16x32_bf16 v[96:99], v[28:31], v[136:139], v[96:99]
    s_waitcnt vmcnt(14)
    ds_read_b128 a[32:35], v12 offset:4096
    ds_read_b128 a[104:107], v12 offset:6144
    ds_read_b128 a[36:39], v13 offset:4096
    s_waitcnt lgkmcnt(14)
    ds_read_b128 a[108:111], v13 offset:6144
    buffer_load_dwordx4 v216, s[16:19], s23 offen offset:0 lds
    buffer_load_dwordx4 v217, s[16:19], s23 offen offset:1024 lds
    s_waitcnt vmcnt(10)
    s_barrier
    s_waitcnt lgkmcnt(12)
    v_mfma_f32_16x16x32_bf16 v[40:43], v[140:143], a[20:23], v[40:43]
    ds_read_b64_tr_b16 v[132:133], v14 offset:49152
    s_lshl_b32 s59, s58, 2
    v_mfma_f32_16x16x32_bf16 v[44:47], v[140:143], a[92:95], v[44:47]
    ds_read_b64_tr_b16 v[134:135], v14 offset:50176
    v_cndmask_b32 v226, v5, v226, vcc
    v_mfma_f32_16x16x32_bf16 v[100:103], v[28:31], v[140:143], v[100:103]
    v_mfma_f32_16x16x32_bf16 v[48:51], v[144:147], a[20:23], v[48:51]
    ds_read_b64_tr_b16 v[136:137], v15 offset:49152
    v_cmp_eq_u32 vcc, 4, v22
    v_mfma_f32_16x16x32_bf16 v[52:55], v[144:147], a[92:95], v[52:55]
    s_waitcnt lgkmcnt(14)
    ds_read_b64_tr_b16 v[138:139], v15 offset:50176
    v_add_u32 v5, s59, v23
    v_mfma_f32_16x16x32_bf16 v[104:107], v[28:31], v[144:147], v[104:107]
    s_waitcnt lgkmcnt(8)
    v_mfma_f32_16x16x32_bf16 v[56:59], v[148:151], a[20:23], v[56:59]
    ds_read_b64_tr_b16 v[140:141], v16 offset:49152
    s_mul_i32 s59, s54, 10
    v_mfma_f32_16x16x32_bf16 v[60:63], v[148:151], a[92:95], v[60:63]
    ds_read_b64_tr_b16 v[142:143], v16 offset:50176
    v_cndmask_b32 v226, v226, 18, vcc
    v_mfma_f32_16x16x32_bf16 v[108:111], v[28:31], v[148:151], v[108:111]
    v_mfma_f32_16x16x32_bf16 v[64:67], v[152:155], a[20:23], v[64:67]
    ds_read_b64_tr_b16 v[144:145], v17 offset:49152
    v_cmp_gt_u32 s[50:51], 10, v5
    v_mfma_f32_16x16x32_bf16 v[68:71], v[152:155], a[92:95], v[68:71]
    ds_read_b64_tr_b16 v[146:147], v17 offset:50176
    v_add_u32 v5, s59, v5
    v_mfma_f32_16x16x32_bf16 v[112:115], v[28:31], v[152:155], v[112:115]
    v_mfma_f32_16x16x32_bf16 v[116:119], v[28:31], a[20:23], v[116:119]
    v_mfma_f32_16x16x32_bf16 v[124:127], a[20:23], a[20:23], v[124:127]
    v_mfma_f32_16x16x32_bf16 v[120:123], v[28:31], a[92:95], v[120:123]
    v_mfma_f32_16x16x32_bf16 v[128:131], a[92:95], a[92:95], v[128:131]
    s_waitcnt lgkmcnt(4)
    v_mfma_f32_16x16x32_bf16 v[32:35], v[132:135], a[24:27], v[32:35]
    ds_read_b64_tr_b16 v[148:149], v18 offset:49152
    s_add_u32 m0, s56, 0
    v_mfma_f32_16x16x32_bf16 v[36:39], v[132:135], a[96:99], v[36:39]
    ds_read_b64_tr_b16 v[150:151], v18 offset:50176
    s_add_u32 s57, s22, 768
    v_mfma_f32_16x16x32_bf16 v[96:99], v[28:31], v[132:135], v[96:99]
    buffer_load_dwordx4 v8, s[12:15], s57 offen offset:0 lds
    v_mfma_f32_16x16x32_bf16 v[40:43], v[136:139], a[24:27], v[40:43]
    ds_read_b64_tr_b16 v[152:153], v14 offset:57344
    v_mul_u32_u24 v5, 19, v5
    v_mfma_f32_16x16x32_bf16 v[44:47], v[136:139], a[96:99], v[44:47]
    ds_read_b64_tr_b16 v[154:155], v14 offset:58368
    v_cmp_gt_u32 vcc, 19, v225
    v_mfma_f32_16x16x32_bf16 v[100:103], v[28:31], v[136:139], v[100:103]
    ds_write_b128 v237, v[244:247]
    s_waitcnt lgkmcnt(5)
    v_mfma_f32_16x16x32_bf16 v[48:51], v[140:143], a[24:27], v[48:51]
    ds_read_b64_tr_b16 v[132:133], v15 offset:57344
    v_add_lshl_u32 v225, v5, v225, 4
    v_mfma_f32_16x16x32_bf16 v[52:55], v[140:143], a[96:99], v[52:55]
    ds_read_b64_tr_b16 v[134:135], v15 offset:58368
    s_and_b64 vcc, vcc, s[50:51]
    v_mfma_f32_16x16x32_bf16 v[104:107], v[28:31], v[140:143], v[104:107]
    buffer_load_dwordx4 v9, s[12:15], s57 offen offset:1024 lds
    v_mfma_f32_16x16x32_bf16 v[56:59], v[144:147], a[24:27], v[56:59]
    ds_read_b64_tr_b16 v[136:137], v16 offset:57344
    s_nop 1
    v_mfma_f32_16x16x32_bf16 v[60:63], v[144:147], a[96:99], v[60:63]
    ds_read_b64_tr_b16 v[138:139], v16 offset:58368
    v_cndmask_b32 v225, v7, v225, vcc
    v_mfma_f32_16x16x32_bf16 v[108:111], v[28:31], v[144:147], v[108:111]
    ds_write_b128 v237, v[244:247] offset:1024
    s_waitcnt lgkmcnt(6)
    v_mfma_f32_16x16x32_bf16 v[64:67], v[148:151], a[24:27], v[64:67]
    ds_read_b64_tr_b16 v[140:141], v17 offset:57344
    v_cmp_gt_u32 vcc, 19, v226
    v_mfma_f32_16x16x32_bf16 v[68:71], v[148:151], a[96:99], v[68:71]
    ds_read_b64_tr_b16 v[142:143], v17 offset:58368
    v_add_lshl_u32 v226, v5, v226, 4
    v_mfma_f32_16x16x32_bf16 v[112:115], v[28:31], v[148:151], v[112:115]
    buffer_load_dwordx4 v10, s[12:15], s57 offen offset:2048 lds
    v_mfma_f32_16x16x32_bf16 v[116:119], v[28:31], a[24:27], v[116:119]
    ds_write_b32 v238, a204
    v_mfma_f32_16x16x32_bf16 v[124:127], a[24:27], a[24:27], v[124:127]
    buffer_load_dwordx4 v11, s[12:15], s57 offen offset:3072 lds
    v_mfma_f32_16x16x32_bf16 v[120:123], v[28:31], a[96:99], v[120:123]
    ds_write_b32 v239, a205
    v_mfma_f32_16x16x32_bf16 v[128:131], a[96:99], a[96:99], v[128:131]
    ds_write_b32 v240, a206
    v_mfma_f32_16x16x32_bf16 v[32:35], v[152:155], a[28:31], v[32:35]
    ds_read_b64_tr_b16 v[144:145], v18 offset:57344
    v_add_u32 v14, 0x10000, v14
    v_mfma_f32_16x16x32_bf16 v[36:39], v[152:155], a[100:103], v[36:39]
    ds_read_b64_tr_b16 v[146:147], v18 offset:58368
    s_add_u32 m0, s56, 4096
    v_mfma_f32_16x16x32_bf16 v[96:99], v[28:31], v[152:155], v[96:99]
    s_waitcnt lgkmcnt(8)
    v_mfma_f32_16x16x32_bf16 v[40:43], v[132:135], a[28:31], v[40:43]
    ds_read_b64_tr_b16 v[148:149], v14 offset:0
    v_add_u32 v15, 0x10000, v15
    v_mfma_f32_16x16x32_bf16 v[44:47], v[132:135], a[100:103], v[44:47]
    ds_read_b64_tr_b16 v[150:151], v14 offset:1024
    s_add_u32 s57, s22, 896
    v_mfma_f32_16x16x32_bf16 v[100:103], v[28:31], v[132:135], v[100:103]
    buffer_load_dwordx4 v8, s[12:15], s57 offen offset:0 lds
    v_mfma_f32_16x16x32_bf16 v[48:51], v[136:139], a[28:31], v[48:51]
    ds_read_b64_tr_b16 v[152:153], v15 offset:0
    v_add_u32 v16, 0x10000, v16
    v_mfma_f32_16x16x32_bf16 v[52:55], v[136:139], a[100:103], v[52:55]
    ds_read_b64_tr_b16 v[154:155], v15 offset:1024
    s_and_b64 vcc, vcc, s[50:51]
    v_mfma_f32_16x16x32_bf16 v[104:107], v[28:31], v[136:139], v[104:107]
    buffer_load_dwordx4 v9, s[12:15], s57 offen offset:1024 lds
    s_waitcnt lgkmcnt(4)
    v_mfma_f32_16x16x32_bf16 v[56:59], v[140:143], a[28:31], v[56:59]
    ds_read_b64_tr_b16 v[132:133], v16 offset:0
    v_add_u32 v17, 0x10000, v17
    v_mfma_f32_16x16x32_bf16 v[60:63], v[140:143], a[100:103], v[60:63]
    ds_read_b64_tr_b16 v[134:135], v16 offset:1024
    s_nop 1
    v_mfma_f32_16x16x32_bf16 v[108:111], v[28:31], v[140:143], v[108:111]
    buffer_load_dwordx4 v10, s[12:15], s57 offen offset:2048 lds
    v_mfma_f32_16x16x32_bf16 v[64:67], v[144:147], a[28:31], v[64:67]
    ds_read_b64_tr_b16 v[136:137], v17 offset:0
    v_add_u32 v18, 0x10000, v18
    v_mfma_f32_16x16x32_bf16 v[68:71], v[144:147], a[100:103], v[68:71]
    ds_read_b64_tr_b16 v[138:139], v17 offset:1024
    v_cndmask_b32 v226, v7, v226, vcc
    v_mfma_f32_16x16x32_bf16 v[112:115], v[28:31], v[144:147], v[112:115]
    s_waitcnt vmcnt(13)
    ds_read_b128 a[40:43], v12 offset:8192
    v_mfma_f32_16x16x32_bf16 v[116:119], v[28:31], a[28:31], v[116:119]
    ds_read_b128 a[112:115], v12 offset:10240
    v_mfma_f32_16x16x32_bf16 v[124:127], a[28:31], a[28:31], v[124:127]
    buffer_load_dwordx4 v11, s[12:15], s57 offen offset:3072 lds
    v_mfma_f32_16x16x32_bf16 v[120:123], v[28:31], a[100:103], v[120:123]
    ds_read_b128 a[44:47], v13 offset:8192
    v_mfma_f32_16x16x32_bf16 v[128:131], a[100:103], a[100:103], v[128:131]
    ds_read_b128 a[116:119], v13 offset:10240
    s_waitcnt lgkmcnt(8)
    v_mfma_f32_16x16x32_bf16 v[32:35], v[148:151], a[32:35], v[32:35]
    ds_read_b64_tr_b16 v[140:141], v18 offset:0
    s_add_u32 m0, s46, 0
    v_mfma_f32_16x16x32_bf16 v[36:39], v[148:151], a[104:107], v[36:39]
    ds_read_b64_tr_b16 v[142:143], v18 offset:1024
    s_add_u32 s23, s45, 1327104
    v_mfma_f32_16x16x32_bf16 v[96:99], v[28:31], v[148:151], v[96:99]
    buffer_load_dwordx4 v216, s[16:19], s23 offen offset:0 lds
    buffer_load_dwordx4 v217, s[16:19], s23 offen offset:1024 lds
    buffer_load_dwordx4 v218, s[16:19], s23 offen offset:2048 lds
    buffer_load_dwordx4 v219, s[16:19], s23 offen offset:3072 lds
    s_waitcnt vmcnt(12)
    s_barrier
    v_mfma_f32_16x16x32_bf16 v[40:43], v[152:155], a[32:35], v[40:43]
    ds_read_b64_tr_b16 v[144:145], v14 offset:8192
    s_add_u32 m0, s46, 4096
    v_mfma_f32_16x16x32_bf16 v[44:47], v[152:155], a[104:107], v[44:47]
    ds_read_b64_tr_b16 v[146:147], v14 offset:9216
    s_add_u32 s23, s45, 1382400
    v_mfma_f32_16x16x32_bf16 v[100:103], v[28:31], v[152:155], v[100:103]
    s_waitcnt lgkmcnt(8)
    v_mfma_f32_16x16x32_bf16 v[48:51], v[132:135], a[32:35], v[48:51]
    ds_read_b64_tr_b16 v[148:149], v15 offset:8192
    s_add_u32 s53, s20, 4
    v_mfma_f32_16x16x32_bf16 v[52:55], v[132:135], a[104:107], v[52:55]
    ds_read_b64_tr_b16 v[150:151], v15 offset:9216
    s_cmp_ge_u32 s53, 3
    s_cselect_b32 s54, 1, 0
    v_mfma_f32_16x16x32_bf16 v[104:107], v[28:31], v[132:135], v[104:107]
    v_mfma_f32_16x16x32_bf16 v[56:59], v[136:139], a[32:35], v[56:59]
    ds_read_b64_tr_b16 v[152:153], v16 offset:8192
    s_mul_i32 s58, s54, 3
    v_mfma_f32_16x16x32_bf16 v[60:63], v[136:139], a[104:107], v[60:63]
    ds_read_b64_tr_b16 v[154:155], v16 offset:9216
    s_sub_u32 s58, s53, s58
    v_mfma_f32_16x16x32_bf16 v[108:111], v[28:31], v[136:139], v[108:111]
    buffer_load_dwordx4 v216, s[16:19], s23 offen offset:0 lds
    s_waitcnt lgkmcnt(4)
    v_mfma_f32_16x16x32_bf16 v[64:67], v[140:143], a[32:35], v[64:67]
    ds_read_b64_tr_b16 v[132:133], v17 offset:8192
    s_min_u32 s59, s58, 2
    v_mfma_f32_16x16x32_bf16 v[68:71], v[140:143], a[104:107], v[68:71]
    ds_read_b64_tr_b16 v[134:135], v17 offset:9216
    s_mul_i32 s47, s54, 12288
    v_mfma_f32_16x16x32_bf16 v[112:115], v[28:31], v[140:143], v[112:115]
    buffer_load_dwordx4 v217, s[16:19], s23 offen offset:1024 lds
    v_mfma_f32_16x16x32_bf16 v[116:119], v[28:31], a[32:35], v[116:119]
    v_mfma_f32_16x16x32_bf16 v[124:127], a[32:35], a[32:35], v[124:127]
    v_mfma_f32_16x16x32_bf16 v[120:123], v[28:31], a[104:107], v[120:123]
    v_mfma_f32_16x16x32_bf16 v[128:131], a[104:107], a[104:107], v[128:131]
    v_mfma_f32_16x16x32_bf16 v[32:35], v[144:147], a[36:39], v[32:35]
    ds_read_b64_tr_b16 v[136:137], v18 offset:8192
    s_add_u32 m0, s56, 8192
    v_mfma_f32_16x16x32_bf16 v[36:39], v[144:147], a[108:111], v[36:39]
    ds_read_b64_tr_b16 v[138:139], v18 offset:9216
    s_add_u32 s57, s22, 1024
    v_mfma_f32_16x16x32_bf16 v[96:99], v[28:31], v[144:147], v[96:99]
    ds_read_b64_tr_b16 v[156:157], v235 offset:0
    s_waitcnt lgkmcnt(5)
    v_mfma_f32_16x16x32_bf16 v[40:43], v[148:151], a[36:39], v[40:43]
    ds_read_b64_tr_b16 v[140:141], v14 offset:16384
    s_lshl_b32 s59, s59, 5
    v_mfma_f32_16x16x32_bf16 v[44:47], v[148:151], a[108:111], v[44:47]
    ds_read_b64_tr_b16 v[142:143], v14 offset:17408
    s_add_u32 s47, s47, s59
    v_mfma_f32_16x16x32_bf16 v[100:103], v[28:31], v[148:151], v[100:103]
    buffer_load_dwordx4 v8, s[12:15], s57 offen offset:0 lds
    v_mfma_f32_16x16x32_bf16 v[48:51], v[152:155], a[36:39], v[48:51]
    ds_read_b64_tr_b16 v[144:145], v15 offset:16384
    v_add_u32 v227, s47, v2
    v_mfma_f32_16x16x32_bf16 v[52:55], v[152:155], a[108:111], v[52:55]
    ds_read_b64_tr_b16 v[146:147], v15 offset:17408
    s_lshl_b32 s47, s54, 5
    v_mfma_f32_16x16x32_bf16 v[104:107], v[28:31], v[152:155], v[104:107]
    ds_read_b64_tr_b16 v[158:159], v235 offset:160
    s_waitcnt lgkmcnt(6)
    v_mfma_f32_16x16x32_bf16 v[56:59], v[132:135], a[36:39], v[56:59]
    ds_read_b64_tr_b16 v[148:149], v16 offset:16384
    v_add_u32 v5, s47, v3
    v_mfma_f32_16x16x32_bf16 v[60:63], v[132:135], a[108:111], v[60:63]
    ds_read_b64_tr_b16 v[150:151], v16 offset:17408
    v_lshl_add_u32 v228, v25, 3, v5
    v_mfma_f32_16x16x32_bf16 v[108:111], v[28:31], v[132:135], v[108:111]
    buffer_load_dwordx4 v9, s[12:15], s57 offen offset:1024 lds
    v_mfma_f32_16x16x32_bf16 v[64:67], v[136:139], a[36:39], v[64:67]
    ds_read_b64_tr_b16 v[152:153], v17 offset:16384
    v_cmp_eq_u32 vcc, 0, v25
    v_mfma_f32_16x16x32_bf16 v[68:71], v[136:139], a[108:111], v[68:71]
    ds_read_b64_tr_b16 v[154:155], v17 offset:17408
    v_add_u32 v5, 32, v5
    v_mfma_f32_16x16x32_bf16 v[112:115], v[28:31], v[136:139], v[112:115]
    ds_read_b64_tr_b16 v[160:161], v235 offset:8
    v_mfma_f32_16x16x32_bf16 v[116:119], v[28:31], a[36:39], v[116:119]
    ds_read_b64_tr_b16 v[162:163], v235 offset:168
    v_mfma_f32_16x16x32_bf16 v[124:127], a[36:39], a[36:39], v[124:127]
    buffer_load_dwordx4 v10, s[12:15], s57 offen offset:2048 lds
    v_mfma_f32_16x16x32_bf16 v[120:123], v[28:31], a[108:111], v[120:123]
    ds_read_b64_tr_b16 v[164:165], v235 offset:16
    v_mfma_f32_16x16x32_bf16 v[128:131], a[108:111], a[108:111], v[128:131]
    buffer_load_dwordx4 v11, s[12:15], s57 offen offset:3072 lds
    s_waitcnt lgkmcnt(8)
    v_mfma_f32_16x16x32_bf16 v[32:35], v[140:143], a[40:43], v[32:35]
    ds_read_b64_tr_b16 v[132:133], v18 offset:16384
    s_add_u32 m0, s46, 24576
    v_mfma_f32_16x16x32_bf16 v[36:39], v[140:143], a[112:115], v[36:39]
    ds_read_b64_tr_b16 v[134:135], v18 offset:17408
    s_add_u32 s23, s45, 1658880
    v_mfma_f32_16x16x32_bf16 v[96:99], v[28:31], v[140:143], v[96:99]
    buffer_load_dwordx4 v216, s[16:19], s23 offen offset:0 lds
    v_mfma_f32_16x16x32_bf16 v[40:43], v[144:147], a[40:43], v[40:43]
    ds_read_b64_tr_b16 v[136:137], v14 offset:24576
    s_lshl_b32 s47, s54, 1
    v_mfma_f32_16x16x32_bf16 v[44:47], v[144:147], a[112:115], v[44:47]
    ds_read_b64_tr_b16 v[138:139], v14 offset:25600
    v_cndmask_b32 v229, v4, v5, vcc
    v_mfma_f32_16x16x32_bf16 v[100:103], v[28:31], v[144:147], v[100:103]
    ds_read_b64_tr_b16 v[166:167], v235 offset:176
    s_waitcnt lgkmcnt(8)
    v_mfma_f32_16x16x32_bf16 v[48:51], v[148:151], a[40:43], v[48:51]
    ds_read_b64_tr_b16 v[140:141], v15 offset:24576
    v_subrev_u32 v230, s47, v22
    v_mfma_f32_16x16x32_bf16 v[52:55], v[148:151], a[112:115], v[52:55]
    ds_read_b64_tr_b16 v[142:143], v15 offset:25600
    s_sub_u32 s59, 16, s47
    v_mfma_f32_16x16x32_bf16 v[104:107], v[28:31], v[148:151], v[104:107]
    buffer_load_dwordx4 v217, s[16:19], s23 offen offset:1024 lds
    v_mfma_f32_16x16x32_bf16 v[56:59], v[152:155], a[40:43], v[56:59]
    ds_read_b64_tr_b16 v[144:145], v16 offset:24576
    v_add_u32 v231, s59, v22
    v_mfma_f32_16x16x32_bf16 v[60:63], v[152:155], a[112:115], v[60:63]
    ds_read_b64_tr_b16 v[146:147], v16 offset:25600
    v_cmp_gt_u32 vcc, 18, v231
    v_mfma_f32_16x16x32_bf16 v[108:111], v[28:31], v[152:155], v[108:111]
    ds_read_b64_tr_b16 v[168:169], v235 offset:24
    s_waitcnt lgkmcnt(6)
    v_mfma_f32_16x16x32_bf16 v[64:67], v[132:135], a[40:43], v[64:67]
    ds_read_b64_tr_b16 v[148:149], v17 offset:24576
    v_mov_b32 v5, 64
    v_mfma_f32_16x16x32_bf16 v[68:71], v[132:135], a[112:115], v[68:71]
    ds_read_b64_tr_b16 v[150:151], v17 offset:25600
    s_lshl_b32 s59, s58, 2
    v_mfma_f32_16x16x32_bf16 v[112:115], v[28:31], v[132:135], v[112:115]
    buffer_load_dwordx4 v218, s[16:19], s23 offen offset:2048 lds
    v_mfma_f32_16x16x32_bf16 v[116:119], v[28:31], a[40:43], v[116:119]
    ds_read_b64_tr_b16 v[170:171], v235 offset:184
    v_mfma_f32_16x16x32_bf16 v[124:127], a[40:43], a[40:43], v[124:127]
    buffer_load_dwordx4 v219, s[16:19], s23 offen offset:3072 lds
    v_mfma_f32_16x16x32_bf16 v[120:123], v[28:31], a[112:115], v[120:123]
    ds_read_b64_tr_b16 v[172:173], v235 offset:32
    v_mfma_f32_16x16x32_bf16 v[128:131], a[112:115], a[112:115], v[128:131]
    ds_read_b64_tr_b16 v[174:175], v235 offset:192
    v_mfma_f32_16x16x32_bf16 v[32:35], v[136:139], a[44:47], v[32:35]
    ds_read_b64_tr_b16 v[152:153], v18 offset:24576
    v_add_u32 v14, 0xffff0000, v14
    v_mfma_f32_16x16x32_bf16 v[36:39], v[136:139], a[116:119], v[36:39]
    ds_read_b64_tr_b16 v[154:155], v18 offset:25600
    s_add_u32 m0, s46, 28672
    v_mfma_f32_16x16x32_bf16 v[96:99], v[28:31], v[136:139], v[96:99]
    ds_read_b64_tr_b16 v[176:177], v235 offset:320
    ds_read_b64_tr_b16 v[178:179], v235 offset:480
    s_waitcnt lgkmcnt(14)
    ds_read_b64_tr_b16 v[180:181], v235 offset:328
    s_waitcnt lgkmcnt(14)
    ds_read_b64_tr_b16 v[182:183], v235 offset:488
    s_waitcnt lgkmcnt(14)
    ds_read_b64_tr_b16 v[184:185], v235 offset:336
    s_waitcnt lgkmcnt(14)
    ds_read_b64_tr_b16 v[186:187], v235 offset:496
    s_waitcnt lgkmcnt(14)
    ds_read_b64_tr_b16 v[188:189], v235 offset:344
    s_waitcnt lgkmcnt(14)
    ds_read_b64_tr_b16 v[190:191], v235 offset:504
    s_waitcnt vmcnt(18)
    s_waitcnt lgkmcnt(14)
    ds_read_b128 a[48:51], v12 offset:0
    s_waitcnt lgkmcnt(14)
    ds_read_b128 a[120:123], v12 offset:2048
    s_waitcnt lgkmcnt(14)
    ds_read_b128 a[52:55], v13 offset:0
    s_waitcnt lgkmcnt(14)
    ds_read_b128 a[124:127], v13 offset:2048
    s_waitcnt vmcnt(14)
    s_waitcnt lgkmcnt(14)
    ds_read_b128 a[56:59], v12 offset:4096
    s_waitcnt lgkmcnt(14)
    ds_read_b128 a[128:131], v12 offset:6144
    s_waitcnt lgkmcnt(14)
    ds_read_b128 a[60:63], v13 offset:4096
    s_waitcnt lgkmcnt(14)
    ds_read_b128 a[132:135], v13 offset:6144
    s_add_u32 s23, s45, 1714176
    buffer_load_dwordx4 v216, s[16:19], s23 offen offset:0 lds
    buffer_load_dwordx4 v217, s[16:19], s23 offen offset:1024 lds
    s_waitcnt vmcnt(10)
    s_barrier
    v_mfma_f32_16x16x32_bf16 v[40:43], v[140:143], a[44:47], v[40:43]
    s_waitcnt lgkmcnt(14)
    ds_read_b64_tr_b16 v[132:133], v14 offset:0
    v_add_u32 v15, 0xffff0000, v15
    v_mfma_f32_16x16x32_bf16 v[44:47], v[140:143], a[116:119], v[44:47]
    s_waitcnt lgkmcnt(14)
    ds_read_b64_tr_b16 v[134:135], v14 offset:1024
    v_cndmask_b32 v231, v5, v231, vcc
    v_mfma_f32_16x16x32_bf16 v[100:103], v[28:31], v[140:143], v[100:103]
    v_mfma_f32_16x16x32_bf16 v[48:51], v[144:147], a[44:47], v[48:51]
    s_waitcnt lgkmcnt(14)
    ds_read_b64_tr_b16 v[136:137], v15 offset:0
    v_add_u32 v16, 0xffff0000, v16
    v_mfma_f32_16x16x32_bf16 v[52:55], v[144:147], a[116:119], v[52:55]
    s_waitcnt lgkmcnt(14)
    ds_read_b64_tr_b16 v[138:139], v15 offset:1024
    v_cmp_eq_u32 vcc, 4, v22
    v_mfma_f32_16x16x32_bf16 v[104:107], v[28:31], v[144:147], v[104:107]
    v_mfma_f32_16x16x32_bf16 v[56:59], v[148:151], a[44:47], v[56:59]
    s_waitcnt lgkmcnt(14)
    ds_read_b64_tr_b16 v[140:141], v16 offset:0
    v_add_u32 v17, 0xffff0000, v17
    v_mfma_f32_16x16x32_bf16 v[60:63], v[148:151], a[116:119], v[60:63]
    s_waitcnt lgkmcnt(14)
    ds_read_b64_tr_b16 v[142:143], v16 offset:1024
    v_add_u32 v5, s59, v23
    v_mfma_f32_16x16x32_bf16 v[108:111], v[28:31], v[148:151], v[108:111]
    v_mfma_f32_16x16x32_bf16 v[64:67], v[152:155], a[44:47], v[64:67]
    s_waitcnt lgkmcnt(14)
    ds_read_b64_tr_b16 v[144:145], v17 offset:0
    v_add_u32 v18, 0xffff0000, v18
    v_mfma_f32_16x16x32_bf16 v[68:71], v[152:155], a[116:119], v[68:71]
    s_waitcnt lgkmcnt(14)
    ds_read_b64_tr_b16 v[146:147], v17 offset:1024
    s_mul_i32 s59, s54, 10
    v_mfma_f32_16x16x32_bf16 v[112:115], v[28:31], v[152:155], v[112:115]
    v_mfma_f32_16x16x32_bf16 v[116:119], v[28:31], a[44:47], v[116:119]
    v_mfma_f32_16x16x32_bf16 v[124:127], a[44:47], a[44:47], v[124:127]
    v_mfma_f32_16x16x32_bf16 v[120:123], v[28:31], a[116:119], v[120:123]
    v_mfma_f32_16x16x32_bf16 v[128:131], a[116:119], a[116:119], v[128:131]
    s_waitcnt lgkmcnt(14)
    s_waitcnt lgkmcnt(4)
    v_mfma_f32_16x16x32_bf16 v[32:35], v[132:135], a[48:51], v[32:35]
    ds_read_b64_tr_b16 v[148:149], v18 offset:0
    s_add_u32 m0, s49, 0
    v_mfma_f32_16x16x32_bf16 v[36:39], v[132:135], a[120:123], v[36:39]
    ds_read_b64_tr_b16 v[150:151], v18 offset:1024
    s_add_u32 s23, s48, 0
    v_mfma_f32_16x16x32_bf16 v[96:99], v[28:31], v[132:135], v[96:99]
    buffer_load_dwordx4 v220, s[16:19], s23 offen offset:0 lds
    v_mfma_f32_16x16x32_bf16 v[40:43], v[136:139], a[48:51], v[40:43]
    ds_read_b64_tr_b16 v[152:153], v14 offset:8192
    v_cndmask_b32 v231, v231, 18, vcc
    v_mfma_f32_16x16x32_bf16 v[44:47], v[136:139], a[120:123], v[44:47]
    ds_read_b64_tr_b16 v[154:155], v14 offset:9216
    v_cmp_gt_u32 s[50:51], 10, v5
    v_mfma_f32_16x16x32_bf16 v[100:103], v[28:31], v[136:139], v[100:103]
    ds_read_b64_tr_b16 v[192:193], v235 offset:352
    s_waitcnt lgkmcnt(5)
    v_mfma_f32_16x16x32_bf16 v[48:51], v[140:143], a[48:51], v[48:51]
    ds_read_b64_tr_b16 v[132:133], v15 offset:8192
    v_add_u32 v5, s59, v5
    v_mfma_f32_16x16x32_bf16 v[52:55], v[140:143], a[120:123], v[52:55]
    ds_read_b64_tr_b16 v[134:135], v15 offset:9216
    v_mul_u32_u24 v5, 19, v5
    v_mfma_f32_16x16x32_bf16 v[104:107], v[28:31], v[140:143], v[104:107]
    buffer_load_dwordx4 v221, s[16:19], s23 offen offset:1024 lds
    v_mfma_f32_16x16x32_bf16 v[56:59], v[144:147], a[48:51], v[56:59]
    ds_read_b64_tr_b16 v[136:137], v16 offset:8192
    s_add_u32 m0, s49, 8192
    v_mfma_f32_16x16x32_bf16 v[60:63], v[144:147], a[120:123], v[60:63]
    ds_read_b64_tr_b16 v[138:139], v16 offset:9216
    s_add_u32 s23, s48, 221184
    v_mfma_f32_16x16x32_bf16 v[108:111], v[28:31], v[144:147], v[108:111]
    ds_read_b64_tr_b16 v[194:195], v235 offset:512
    s_waitcnt lgkmcnt(6)
    v_mfma_f32_16x16x32_bf16 v[64:67], v[148:151], a[48:51], v[64:67]
    ds_read_b64_tr_b16 v[140:141], v17 offset:8192
    v_cmp_gt_u32 vcc, 19, v230
    v_mfma_f32_16x16x32_bf16 v[68:71], v[148:151], a[120:123], v[68:71]
    ds_read_b64_tr_b16 v[142:143], v17 offset:9216
    v_add_lshl_u32 v230, v5, v230, 4
    v_mfma_f32_16x16x32_bf16 v[112:115], v[28:31], v[148:151], v[112:115]
    buffer_load_dwordx4 v220, s[16:19], s23 offen offset:0 lds
    v_mfma_f32_16x16x32_bf16 v[116:119], v[28:31], a[48:51], v[116:119]
    ds_read_b64_tr_b16 v[196:197], v235 offset:640
    v_mfma_f32_16x16x32_bf16 v[124:127], a[48:51], a[48:51], v[124:127]
    buffer_load_dwordx4 v221, s[16:19], s23 offen offset:1024 lds
    v_mfma_f32_16x16x32_bf16 v[120:123], v[28:31], a[120:123], v[120:123]
    ds_read_b64_tr_b16 v[198:199], v235 offset:800
    v_mfma_f32_16x16x32_bf16 v[128:131], a[120:123], a[120:123], v[128:131]
    ds_read_b64_tr_b16 v[200:201], v235 offset:648
    v_mfma_f32_16x16x32_bf16 v[32:35], v[152:155], a[52:55], v[32:35]
    ds_read_b64_tr_b16 v[144:145], v18 offset:8192
    s_add_u32 m0, s49, 16384
    v_mfma_f32_16x16x32_bf16 v[36:39], v[152:155], a[124:127], v[36:39]
    ds_read_b64_tr_b16 v[146:147], v18 offset:9216
    s_add_u32 s23, s48, 442368
    v_mfma_f32_16x16x32_bf16 v[96:99], v[28:31], v[152:155], v[96:99]
    ds_read_b64_tr_b16 v[202:203], v235 offset:808
    s_waitcnt lgkmcnt(9)
    v_mfma_f32_16x16x32_bf16 v[40:43], v[132:135], a[52:55], v[40:43]
    ds_read_b64_tr_b16 v[148:149], v14 offset:16384
    s_and_b64 vcc, vcc, s[50:51]
    v_mfma_f32_16x16x32_bf16 v[44:47], v[132:135], a[124:127], v[44:47]
    ds_read_b64_tr_b16 v[150:151], v14 offset:17408
    s_nop 1
    v_mfma_f32_16x16x32_bf16 v[100:103], v[28:31], v[132:135], v[100:103]
    buffer_load_dwordx4 v220, s[16:19], s23 offen offset:0 lds
    v_mfma_f32_16x16x32_bf16 v[48:51], v[136:139], a[52:55], v[48:51]
    ds_read_b64_tr_b16 v[152:153], v15 offset:16384
    v_cndmask_b32 v230, v7, v230, vcc
    v_mfma_f32_16x16x32_bf16 v[52:55], v[136:139], a[124:127], v[52:55]
    ds_read_b64_tr_b16 v[154:155], v15 offset:17408
    v_cmp_gt_u32 vcc, 19, v231
    v_mfma_f32_16x16x32_bf16 v[104:107], v[28:31], v[136:139], v[104:107]
    ds_read_b64_tr_b16 v[204:205], v235 offset:656
    s_waitcnt lgkmcnt(6)
    v_mfma_f32_16x16x32_bf16 v[56:59], v[140:143], a[52:55], v[56:59]
    ds_read_b64_tr_b16 v[132:133], v16 offset:16384
    v_add_lshl_u32 v231, v5, v231, 4
    v_mfma_f32_16x16x32_bf16 v[60:63], v[140:143], a[124:127], v[60:63]
    ds_read_b64_tr_b16 v[134:135], v16 offset:17408
    s_and_b64 vcc, vcc, s[50:51]
    v_mfma_f32_16x16x32_bf16 v[108:111], v[28:31], v[140:143], v[108:111]
    buffer_load_dwordx4 v221, s[16:19], s23 offen offset:1024 lds
    v_mfma_f32_16x16x32_bf16 v[64:67], v[144:147], a[52:55], v[64:67]
    ds_read_b64_tr_b16 v[136:137], v17 offset:16384
    s_nop 1
    v_mfma_f32_16x16x32_bf16 v[68:71], v[144:147], a[124:127], v[68:71]
    ds_read_b64_tr_b16 v[138:139], v17 offset:17408
    v_cndmask_b32 v231, v7, v231, vcc
    v_mfma_f32_16x16x32_bf16 v[112:115], v[28:31], v[144:147], v[112:115]
    ds_read_b64_tr_b16 v[206:207], v235 offset:816
    v_mfma_f32_16x16x32_bf16 v[116:119], v[28:31], a[52:55], v[116:119]
    ds_read_b64_tr_b16 v[208:209], v235 offset:664
    v_mfma_f32_16x16x32_bf16 v[124:127], a[52:55], a[52:55], v[124:127]
    ds_read_b64_tr_b16 v[210:211], v235 offset:824
    v_mfma_f32_16x16x32_bf16 v[120:123], v[28:31], a[124:127], v[120:123]
    ds_read_b64_tr_b16 v[212:213], v235 offset:672
    v_mfma_f32_16x16x32_bf16 v[128:131], a[124:127], a[124:127], v[128:131]
    ds_read_b64_tr_b16 v[214:215], v235 offset:832
    s_waitcnt lgkmcnt(10)
    v_mfma_f32_16x16x32_bf16 v[32:35], v[148:151], a[56:59], v[32:35]
    ds_read_b64_tr_b16 v[140:141], v18 offset:16384
    s_lshr_b32 s44, s2, 3
    v_mfma_f32_16x16x32_bf16 v[36:39], v[148:151], a[128:131], v[36:39]
    ds_read_b64_tr_b16 v[142:143], v18 offset:17408
    s_cmp_ge_u32 s44, 9
    s_cselect_b32 s64, 9, 0
    s_cselect_b32 s65, 8, 0
    v_mfma_f32_16x16x32_bf16 v[96:99], v[28:31], v[148:151], v[96:99]
    ds_read_b64_tr_b16 a[144:145], v236 offset:0
    ds_read_b64_tr_b16 a[146:147], v236 offset:320
    ds_read_b64_tr_b16 a[148:149], v236 offset:8
    s_waitcnt lgkmcnt(14)
    ds_read_b64_tr_b16 a[150:151], v236 offset:328
    s_waitcnt lgkmcnt(14)
    ds_read_b64_tr_b16 a[152:153], v236 offset:16
    s_waitcnt lgkmcnt(14)
    ds_read_b64_tr_b16 a[154:155], v236 offset:336
    s_waitcnt lgkmcnt(14)
    ds_read_b64_tr_b16 a[156:157], v236 offset:24
    s_waitcnt lgkmcnt(14)
    ds_read_b64_tr_b16 a[158:159], v236 offset:344
    s_waitcnt vmcnt(12)
    s_waitcnt lgkmcnt(14)
    ds_read_b128 a[64:67], v12 offset:8192
    s_waitcnt lgkmcnt(14)
    ds_read_b128 a[136:139], v12 offset:10240
    s_waitcnt lgkmcnt(14)
    ds_read_b128 a[68:71], v13 offset:8192
    s_waitcnt lgkmcnt(14)
    ds_read_b128 a[140:143], v13 offset:10240
    s_waitcnt lgkmcnt(0)
    s_waitcnt vmcnt(6)
    s_barrier
    v_mfma_f32_16x16x32_bf16 v[40:43], v[152:155], a[56:59], v[40:43]
    ds_read_b64_tr_b16 v[144:145], v14 offset:24576
    s_sub_u32 s69, s44, s64
    v_mfma_f32_16x16x32_bf16 v[44:47], v[152:155], a[128:131], v[44:47]
    ds_read_b64_tr_b16 v[146:147], v14 offset:25600
    s_and_b32 s64, s2, 7
    v_mfma_f32_16x16x32_bf16 v[100:103], v[28:31], v[152:155], v[100:103]
    v_mfma_f32_16x16x32_bf16 v[48:51], v[132:135], a[56:59], v[48:51]
    ds_read_b64_tr_b16 v[148:149], v15 offset:24576
    s_add_u32 s64, s64, s65
    v_mfma_f32_16x16x32_bf16 v[52:55], v[132:135], a[128:131], v[52:55]
    ds_read_b64_tr_b16 v[150:151], v15 offset:25600
    s_lshl_b32 s68, s64, 2
    v_mfma_f32_16x16x32_bf16 v[104:107], v[28:31], v[132:135], v[104:107]
    v_mfma_f32_16x16x32_bf16 v[56:59], v[136:139], a[56:59], v[56:59]
    ds_read_b64_tr_b16 v[152:153], v16 offset:24576
    s_add_u32 s68, s68, s20
    v_mfma_f32_16x16x32_bf16 v[60:63], v[136:139], a[128:131], v[60:63]
    ds_read_b64_tr_b16 v[154:155], v16 offset:25600
    s_cmp_ge_u32 s44, 18
    s_cselect_b32 s44, 0x7ff00000, 0
    v_mfma_f32_16x16x32_bf16 v[108:111], v[28:31], v[136:139], v[108:111]
    s_waitcnt lgkmcnt(4)
    v_mfma_f32_16x16x32_bf16 v[64:67], v[140:143], a[56:59], v[64:67]
    ds_read_b64_tr_b16 v[132:133], v17 offset:24576
    s_lshl_b32 s65, s69, 7
    v_mfma_f32_16x16x32_bf16 v[68:71], v[140:143], a[128:131], v[68:71]
    ds_read_b64_tr_b16 v[134:135], v17 offset:25600
    s_add_u32 s65, s65, s44
    v_mfma_f32_16x16x32_bf16 v[112:115], v[28:31], v[140:143], v[112:115]
    v_mfma_f32_16x16x32_bf16 v[116:119], v[28:31], a[56:59], v[116:119]
    v_mfma_f32_16x16x32_bf16 v[124:127], a[56:59], a[56:59], v[124:127]
    v_mfma_f32_16x16x32_bf16 v[120:123], v[28:31], a[128:131], v[120:123]
    v_mfma_f32_16x16x32_bf16 v[128:131], a[128:131], a[128:131], v[128:131]
    v_mfma_f32_16x16x32_bf16 v[32:35], v[144:147], a[60:63], v[32:35]
    ds_read_b64_tr_b16 v[136:137], v18 offset:24576
    s_add_u32 m0, s49, 24576
    v_mfma_f32_16x16x32_bf16 v[36:39], v[144:147], a[132:135], v[36:39]
    ds_read_b64_tr_b16 v[138:139], v18 offset:25600
    s_add_u32 s23, s48, 663552
    v_mfma_f32_16x16x32_bf16 v[96:99], v[28:31], v[144:147], v[96:99]
    ds_read_b64_tr_b16 a[160:161], v236 offset:32
    s_waitcnt lgkmcnt(5)
    v_mfma_f32_16x16x32_bf16 v[40:43], v[148:151], a[60:63], v[40:43]
    ds_read_b64_tr_b16 v[140:141], v14 offset:32768
    s_mul_i32 s64, s20, 18 * 9216
    v_mfma_f32_16x16x32_bf16 v[44:47], v[148:151], a[132:135], v[44:47]
    ds_read_b64_tr_b16 v[142:143], v14 offset:33792
    s_add_u32 s64, s64, s65
    v_mfma_f32_16x16x32_bf16 v[100:103], v[28:31], v[148:151], v[100:103]
    buffer_load_dwordx4 v220, s[16:19], s23 offen offset:0 lds
    v_mfma_f32_16x16x32_bf16 v[48:51], v[152:155], a[60:63], v[48:51]
    ds_read_b64_tr_b16 v[144:145], v15 offset:32768
    s_mul_i32 s66, s68, 36864
    v_mfma_f32_16x16x32_bf16 v[52:55], v[152:155], a[132:135], v[52:55]
    ds_read_b64_tr_b16 v[146:147], v15 offset:33792
    s_add_u32 s65, s65, s66
    v_mfma_f32_16x16x32_bf16 v[104:107], v[28:31], v[152:155], v[104:107]
    ds_read_b64_tr_b16 a[162:163], v236 offset:352
    s_waitcnt lgkmcnt(6)
    v_mfma_f32_16x16x32_bf16 v[56:59], v[132:135], a[60:63], v[56:59]
    ds_read_b64_tr_b16 v[148:149], v16 offset:32768
    s_mul_i32 s66, s20, 18 * 1024
    v_mfma_f32_16x16x32_bf16 v[60:63], v[132:135], a[132:135], v[60:63]
    ds_read_b64_tr_b16 v[150:151], v16 offset:33792
    s_and_b32 s53, s3, 0xf0
    v_mfma_f32_16x16x32_bf16 v[108:111], v[28:31], v[132:135], v[108:111]
    buffer_load_dwordx4 v221, s[16:19], s23 offen offset:1024 lds
    v_mfma_f32_16x16x32_bf16 v[64:67], v[136:139], a[60:63], v[64:67]
    ds_read_b64_tr_b16 v[152:153], v17 offset:32768
    s_add_u32 m0, s49, 32768
    v_mfma_f32_16x16x32_bf16 v[68:71], v[136:139], a[132:135], v[68:71]
    ds_read_b64_tr_b16 v[154:155], v17 offset:33792
    s_add_u32 s23, s48, 884736
    v_mfma_f32_16x16x32_bf16 v[112:115], v[28:31], v[136:139], v[112:115]
    ds_read_b64_tr_b16 a[164:165], v236 offset:640
    v_mfma_f32_16x16x32_bf16 v[116:119], v[28:31], a[60:63], v[116:119]
    ds_read_b64_tr_b16 a[166:167], v236 offset:960
    v_mfma_f32_16x16x32_bf16 v[124:127], a[60:63], a[60:63], v[124:127]
    buffer_load_dwordx4 v220, s[16:19], s23 offen offset:0 lds
    v_mfma_f32_16x16x32_bf16 v[120:123], v[28:31], a[132:135], v[120:123]
    ds_read_b64_tr_b16 a[168:169], v236 offset:648
    v_mfma_f32_16x16x32_bf16 v[128:131], a[132:135], a[132:135], v[128:131]
    buffer_load_dwordx4 v221, s[16:19], s23 offen offset:1024 lds
    s_waitcnt lgkmcnt(8)
    v_mfma_f32_16x16x32_bf16 v[32:35], v[140:143], a[64:67], v[32:35]
    ds_read_b64_tr_b16 v[132:133], v18 offset:32768
    s_add_u32 m0, s49, 40960
    v_mfma_f32_16x16x32_bf16 v[36:39], v[140:143], a[136:139], v[36:39]
    ds_read_b64_tr_b16 v[134:135], v18 offset:33792
    s_add_u32 s23, s48, 1105920
    v_mfma_f32_16x16x32_bf16 v[96:99], v[28:31], v[140:143], v[96:99]
    buffer_load_dwordx4 v220, s[16:19], s23 offen offset:0 lds
    v_mfma_f32_16x16x32_bf16 v[40:43], v[144:147], a[64:67], v[40:43]
    ds_read_b64_tr_b16 v[136:137], v14 offset:40960
    s_mul_i32 s53, s53, 6144
    v_mfma_f32_16x16x32_bf16 v[44:47], v[144:147], a[136:139], v[44:47]
    ds_read_b64_tr_b16 v[138:139], v14 offset:41984
    v_mfma_f32_16x16x32_bf16 v[100:103], v[28:31], v[144:147], v[100:103]
    ds_read_b64_tr_b16 a[170:171], v236 offset:968
    s_waitcnt lgkmcnt(8)
    v_mfma_f32_16x16x32_bf16 v[48:51], v[148:151], a[64:67], v[48:51]
    ds_read_b64_tr_b16 v[140:141], v15 offset:40960
    v_mfma_f32_16x16x32_bf16 v[52:55], v[148:151], a[136:139], v[52:55]
    ds_read_b64_tr_b16 v[142:143], v15 offset:41984
    v_mfma_f32_16x16x32_bf16 v[104:107], v[28:31], v[148:151], v[104:107]
    buffer_load_dwordx4 v221, s[16:19], s23 offen offset:1024 lds
    v_mfma_f32_16x16x32_bf16 v[56:59], v[152:155], a[64:67], v[56:59]
    ds_read_b64_tr_b16 v[144:145], v16 offset:40960
    s_add_u32 m0, s49, 49152
    v_mfma_f32_16x16x32_bf16 v[60:63], v[152:155], a[136:139], v[60:63]
    ds_read_b64_tr_b16 v[146:147], v16 offset:41984
    s_add_u32 s23, s48, 1327104
    v_mfma_f32_16x16x32_bf16 v[108:111], v[28:31], v[152:155], v[108:111]
    ds_read_b64_tr_b16 a[172:173], v236 offset:656
    s_waitcnt lgkmcnt(6)
    v_mfma_f32_16x16x32_bf16 v[64:67], v[132:135], a[64:67], v[64:67]
    ds_read_b64_tr_b16 v[148:149], v17 offset:40960
    v_mfma_f32_16x16x32_bf16 v[68:71], v[132:135], a[136:139], v[68:71]
    ds_read_b64_tr_b16 v[150:151], v17 offset:41984
    v_mfma_f32_16x16x32_bf16 v[112:115], v[28:31], v[132:135], v[112:115]
    buffer_load_dwordx4 v220, s[16:19], s23 offen offset:0 lds
    v_mfma_f32_16x16x32_bf16 v[116:119], v[28:31], a[64:67], v[116:119]
    ds_read_b64_tr_b16 a[174:175], v236 offset:976
    v_mfma_f32_16x16x32_bf16 v[124:127], a[64:67], a[64:67], v[124:127]
    buffer_load_dwordx4 v221, s[16:19], s23 offen offset:1024 lds
    v_mfma_f32_16x16x32_bf16 v[120:123], v[28:31], a[136:139], v[120:123]
    ds_read_b64_tr_b16 a[176:177], v236 offset:664
    v_mfma_f32_16x16x32_bf16 v[128:131], a[136:139], a[136:139], v[128:131]
    ds_read_b64_tr_b16 a[178:179], v236 offset:984
    v_mfma_f32_16x16x32_bf16 v[32:35], v[136:139], a[68:71], v[32:35]
    ds_read_b64_tr_b16 v[152:153], v18 offset:40960
    s_add_u32 m0, s49, 57344
    v_mfma_f32_16x16x32_bf16 v[36:39], v[136:139], a[140:143], v[36:39]
    ds_read_b64_tr_b16 v[154:155], v18 offset:41984
    s_add_u32 s23, s48, 1548288
    v_mfma_f32_16x16x32_bf16 v[96:99], v[28:31], v[136:139], v[96:99]
    ds_read_b64_tr_b16 a[180:181], v236 offset:672
    s_waitcnt lgkmcnt(9)
    v_mfma_f32_16x16x32_bf16 v[40:43], v[140:143], a[68:71], v[40:43]
    v_mfma_f32_16x16x32_bf16 v[44:47], v[140:143], a[140:143], v[44:47]
    v_mfma_f32_16x16x32_bf16 v[100:103], v[28:31], v[140:143], v[100:103]
    buffer_load_dwordx4 v220, s[16:19], s23 offen offset:0 lds
    v_mfma_f32_16x16x32_bf16 v[48:51], v[144:147], a[68:71], v[48:51]
    v_mfma_f32_16x16x32_bf16 v[52:55], v[144:147], a[140:143], v[52:55]
    v_mfma_f32_16x16x32_bf16 v[104:107], v[28:31], v[144:147], v[104:107]
    ds_read_b64_tr_b16 a[182:183], v236 offset:992
    s_waitcnt lgkmcnt(2)
    v_mfma_f32_16x16x32_bf16 v[56:59], v[148:151], a[68:71], v[56:59]
    v_mfma_f32_16x16x32_bf16 v[60:63], v[148:151], a[140:143], v[60:63]
    v_mfma_f32_16x16x32_bf16 v[108:111], v[28:31], v[148:151], v[108:111]
    buffer_load_dwordx4 v221, s[16:19], s23 offen offset:1024 lds
    v_mfma_f32_16x16x32_bf16 v[64:67], v[152:155], a[68:71], v[64:67]
    s_add_u32 m0, s49, 65536
    v_mfma_f32_16x16x32_bf16 v[68:71], v[152:155], a[140:143], v[68:71]
    s_add_u32 s23, s48, 1769472
    v_mfma_f32_16x16x32_bf16 v[112:115], v[28:31], v[152:155], v[112:115]
    ds_read_b64_tr_b16 a[184:185], v236 offset:1280
    v_mfma_f32_16x16x32_bf16 v[116:119], v[28:31], a[68:71], v[116:119]
    ds_read_b64_tr_b16 a[186:187], v236 offset:1600
    v_mfma_f32_16x16x32_bf16 v[124:127], a[68:71], a[68:71], v[124:127]
    buffer_load_dwordx4 v220, s[16:19], s23 offen offset:0 lds
    v_mfma_f32_16x16x32_bf16 v[120:123], v[28:31], a[140:143], v[120:123]
    ds_read_b64_tr_b16 a[188:189], v236 offset:1288
    v_mfma_f32_16x16x32_bf16 v[128:131], a[140:143], a[140:143], v[128:131]
    buffer_load_dwordx4 v221, s[16:19], s23 offen offset:1024 lds
    ds_read_b64_tr_b16 a[190:191], v236 offset:1608
    ds_read_b64_tr_b16 a[192:193], v236 offset:1296
    ds_read_b64_tr_b16 a[194:195], v236 offset:1616
    ds_read_b64_tr_b16 a[196:197], v236 offset:1304
    ds_read_b64_tr_b16 a[198:199], v236 offset:1624
    ds_read_b64_tr_b16 a[200:201], v236 offset:1312
    ds_read_b64_tr_b16 a[202:203], v236 offset:1632
    s_mov_b32 s12, s76
    s_mov_b32 s13, s77
    s_mov_b32 s14, 0x510000
    s_mov_b32 s15, 0x20000
    s_lshl_b32 s47, s2, 2
    s_add_u32 s47, s47, s20
    v_lshlrev_b32 v3, 7, v1
    s_mul_i32 s58, s47, 5184
    v_min_u32 v4, 5120, v3
    buffer_load_dword a210, v4, s[12:15], s58 offen
    v_or_b32 v6, v248, v249
    v_mov_b32 v7, 162368
    v_cmp_eq_u32 vcc, 0, v6
    v_mov_b32 v2, s74
    v_mov_b32 v3, s75
    v_cndmask_b32 v248, v248, v2, vcc
    v_cndmask_b32 v249, v249, v3, vcc
    v_cmp_eq_u32 vcc, 0, v0
    v_mov_b32 v6, 162304
    v_lshrrev_b32 v2, 2, v22
    v_cndmask_b32 v7, v7, v6, vcc
    ds_write_b64 v7, v[248:249]
    v_cmp_eq_u32 s[50:51], v2, v23
    v_cmp_eq_u32 vcc, 1, v25
    s_nop 1
    v_cndmask_b32 v124, v124, v125, vcc
    v_cndmask_b32 v128, v128, v129, vcc
    v_cmp_eq_u32 vcc, 2, v25
    s_nop 1
    v_cndmask_b32 v124, v124, v126, vcc
    v_cndmask_b32 v128, v128, v130, vcc
    v_cmp_eq_u32 vcc, 3, v25
    s_nop 1
    v_cndmask_b32 v124, v124, v127, vcc
    v_cndmask_b32 v128, v128, v131, vcc
    v_cndmask_b32 v124, 0, v124, s[50:51]
    v_cndmask_b32 v128, 0, v128, s[50:51]
    v_mov_b32 v125, v124
    v_mov_b32 v129, v128
    s_nop 1
    v_permlane32_swap_b32 v124, v125
    v_permlane32_swap_b32 v128, v129
    s_nop 0
    v_add_f32 v124, v124, v125
    v_add_f32 v128, v128, v129
    v_mov_b32 v125, v124
    v_mov_b32 v129, v128
    s_nop 1
    v_permlane16_swap_b32 v124, v125
    v_permlane16_swap_b32 v128, v129
    s_nop 0
    v_add_f32 v124, v124, v125
    v_add_f32 v128, v128, v129
    v_mul_f32 v116, 0x3ae38e39, v116
    v_mul_f32 v120, 0x3ae38e39, v120
    v_mul_f32 v124, 0x3ae38e39, v124
    v_mul_f32 v128, 0x3ae38e39, v128
    v_fma_f32 v124, -v116, v116, v124
    v_fma_f32 v128, -v120, v120, v128
    v_max_f32 v124, 0, v124
    v_max_f32 v128, 0, v128
    v_cvt_pk_bf16_f32 v116, v116, v124
    v_cvt_pk_bf16_f32 v120, v120, v128
    v_and_b32 v124, 0xffff0000, v116
    v_and_b32 v128, 0xffff0000, v120
    v_add_f32 v124, 0x3727c5ac, v124
    v_add_f32 v128, 0x3727c5ac, v128
    v_cvt_pk_bf16_f32 v124, v124, v124
    v_cvt_pk_bf16_f32 v128, v128, v128
    v_and_b32 v124, 0xffff0000, v124
    v_and_b32 v128, 0xffff0000, v128
    v_sqrt_f32 v124, v124
    v_sqrt_f32 v128, v128
    v_and_b32 v116, 0xffff, v116
    v_and_b32 v120, 0xffff, v120
    v_cvt_pk_bf16_f32 v124, v124, v124
    v_cvt_pk_bf16_f32 v128, v128, v128
    v_and_b32 v124, 0xffff0000, v124
    v_and_b32 v128, 0xffff0000, v128
    v_rcp_f32 v126, v124
    v_rcp_f32 v130, v128
    v_lshl_or_b32 v116, v116, 16, v116
    v_lshl_or_b32 v120, v120, 16, v120
    v_xor_b32 v116, 0x80008000, v116
    v_xor_b32 v120, 0x80008000, v120
    v_cmp_gt_u32 vcc, 16, v1
    v_mov_b32 v241, 0
    v_mov_b32 v242, 0
    v_mov_b32 v243, 0
    v_mov_b32 v127, v126
    v_mov_b32 v245, 0
    v_mov_b32 v246, 0
    v_mov_b32 v247, 0
    v_mov_b32 v131, v130
    v_cndmask_b32 v240, 0, v116, vcc
    v_cndmask_b32 v244, 0, v120, vcc
    v_cvt_pk_bf16_f32 v97, v96, v96
    v_and_b32 v97, 0xffff0000, v97
    v_sub_f32 v96, v96, v97
    v_cvt_pk_bf16_f32 v96, v97, v96
    v_mov_b32 v97, 0
    v_mov_b32 v98, 0
    v_mov_b32 v99, 0
    v_cvt_pk_bf16_f32 v101, v100, v100
    v_and_b32 v101, 0xffff0000, v101
    v_sub_f32 v100, v100, v101
    v_cvt_pk_bf16_f32 v100, v101, v100
    v_mov_b32 v101, 0
    v_mov_b32 v102, 0
    v_mov_b32 v103, 0
    v_cvt_pk_bf16_f32 v105, v104, v104
    v_and_b32 v105, 0xffff0000, v105
    v_sub_f32 v104, v104, v105
    v_cvt_pk_bf16_f32 v104, v105, v104
    v_mov_b32 v105, 0
    v_mov_b32 v106, 0
    v_mov_b32 v107, 0
    v_cvt_pk_bf16_f32 v109, v108, v108
    v_and_b32 v109, 0xffff0000, v109
    v_sub_f32 v108, v108, v109
    v_cvt_pk_bf16_f32 v108, v109, v108
    v_mov_b32 v109, 0
    v_mov_b32 v110, 0
    v_mov_b32 v111, 0
    v_cvt_pk_bf16_f32 v113, v112, v112
    v_and_b32 v113, 0xffff0000, v113
    v_sub_f32 v112, v112, v113
    v_cvt_pk_bf16_f32 v112, v113, v112
    v_mov_b32 v113, 0
    v_mov_b32 v114, 0
    v_mov_b32 v115, 0
    v_cmp_gt_u32 vcc, 32, v1
    v_mfma_f32_16x16x32_bf16 v[32:35], v[96:99], v[240:243], v[32:35]
    v_mfma_f32_16x16x32_bf16 v[36:39], v[96:99], v[244:247], v[36:39]
    v_mfma_f32_16x16x32_bf16 v[40:43], v[100:103], v[240:243], v[40:43]
    v_mfma_f32_16x16x32_bf16 v[44:47], v[100:103], v[244:247], v[44:47]
    v_mfma_f32_16x16x32_bf16 v[48:51], v[104:107], v[240:243], v[48:51]
    v_mfma_f32_16x16x32_bf16 v[52:55], v[104:107], v[244:247], v[52:55]
    v_mfma_f32_16x16x32_bf16 v[56:59], v[108:111], v[240:243], v[56:59]
    v_mfma_f32_16x16x32_bf16 v[60:63], v[108:111], v[244:247], v[60:63]
    v_mfma_f32_16x16x32_bf16 v[64:67], v[112:115], v[240:243], v[64:67]
    v_mfma_f32_16x16x32_bf16 v[68:71], v[112:115], v[244:247], v[68:71]
    v_cndmask_b32 v218, v130, v126, vcc
    v_mul_f32 v218, 0x3fb8aa3b, v218
    v_mov_b32 v219, v218
    v_mov_b32 v216, 0x3fb8aa3b
    v_mov_b32 v217, 0x3fb8aa3b
    s_waitcnt lgkmcnt(0)
    s_barrier
    v_mov_b32 v6, 162304
    ds_read_b64 v[248:249], v6
    v_pk_mul_f32 v[32:33], v[32:33], v[126:127]
    v_pk_mul_f32 v[34:35], v[34:35], v[126:127]
    v_pk_mul_f32 v[36:37], v[36:37], v[130:131]
    v_pk_mul_f32 v[38:39], v[38:39], v[130:131]
    v_cvt_pk_bf16_f32 v132, v32, v33
    v_cvt_pk_bf16_f32 v133, v34, v35
    v_cvt_pk_bf16_f32 v144, v36, v37
    v_cvt_pk_bf16_f32 v145, v38, v39
    v_pk_mul_f32 v[40:41], v[40:41], v[126:127]
    v_pk_mul_f32 v[42:43], v[42:43], v[126:127]
    v_pk_mul_f32 v[44:45], v[44:45], v[130:131]
    v_pk_mul_f32 v[46:47], v[46:47], v[130:131]
    v_cvt_pk_bf16_f32 v134, v40, v41
    v_cvt_pk_bf16_f32 v135, v42, v43
    v_cvt_pk_bf16_f32 v146, v44, v45
    v_cvt_pk_bf16_f32 v147, v46, v47
    v_pk_mul_f32 v[48:49], v[48:49], v[126:127]
    v_pk_mul_f32 v[50:51], v[50:51], v[126:127]
    v_pk_mul_f32 v[52:53], v[52:53], v[130:131]
    v_pk_mul_f32 v[54:55], v[54:55], v[130:131]
    v_cvt_pk_bf16_f32 v136, v48, v49
    v_cvt_pk_bf16_f32 v137, v50, v51
    v_cvt_pk_bf16_f32 v148, v52, v53
    v_cvt_pk_bf16_f32 v149, v54, v55
    v_pk_mul_f32 v[56:57], v[56:57], v[126:127]
    v_pk_mul_f32 v[58:59], v[58:59], v[126:127]
    v_pk_mul_f32 v[60:61], v[60:61], v[130:131]
    v_pk_mul_f32 v[62:63], v[62:63], v[130:131]
    v_cvt_pk_bf16_f32 v138, v56, v57
    v_cvt_pk_bf16_f32 v139, v58, v59
    v_cvt_pk_bf16_f32 v150, v60, v61
    v_cvt_pk_bf16_f32 v151, v62, v63
    v_pk_mul_f32 v[64:65], v[64:65], v[126:127]
    v_pk_mul_f32 v[66:67], v[66:67], v[126:127]
    v_pk_mul_f32 v[68:69], v[68:69], v[130:131]
    v_pk_mul_f32 v[70:71], v[70:71], v[130:131]
    v_cvt_pk_bf16_f32 v140, v64, v65
    v_cvt_pk_bf16_f32 v141, v66, v67
    v_cvt_pk_bf16_f32 v152, v68, v69
    v_cvt_pk_bf16_f32 v153, v70, v71
    v_mov_b32 v142, 0
    v_mov_b32 v143, 0
    v_permlane32_swap_b32 v132, v144
    v_permlane32_swap_b32 v133, v145
    v_permlane32_swap_b32 v134, v146
    v_permlane32_swap_b32 v135, v147
    v_permlane32_swap_b32 v136, v148
    v_permlane32_swap_b32 v137, v149
    v_permlane32_swap_b32 v138, v150
    v_permlane32_swap_b32 v139, v151
    v_permlane32_swap_b32 v140, v152
    v_permlane32_swap_b32 v141, v153
    v_and_b32 v2, 1, v23
    v_cmp_eq_u32 vcc, 0, v2
    v_mfma_f32_16x16x32_bf16 v[32:35], v[156:159], v[132:135], 0
    v_mfma_f32_16x16x32_bf16 v[36:39], v[160:163], v[132:135], 0
    v_mfma_f32_16x16x32_bf16 v[40:43], v[164:167], v[132:135], 0
    v_mfma_f32_16x16x32_bf16 v[44:47], v[168:171], v[132:135], 0
    v_mfma_f32_16x16x32_bf16 v[48:51], v[172:175], v[132:135], 0
    v_mfma_f32_16x16x32_bf16 v[32:35], v[176:179], v[136:139], v[32:35]
    v_mfma_f32_16x16x32_bf16 v[36:39], v[180:183], v[136:139], v[36:39]
    v_mfma_f32_16x16x32_bf16 v[40:43], v[184:187], v[136:139], v[40:43]
    v_mfma_f32_16x16x32_bf16 v[44:47], v[188:191], v[136:139], v[44:47]
    v_mfma_f32_16x16x32_bf16 v[48:51], v[192:195], v[136:139], v[48:51]
    v_mfma_f32_16x16x32_bf16 v[32:35], v[196:199], v[140:143], v[32:35]
    v_mfma_f32_16x16x32_bf16 v[36:39], v[200:203], v[140:143], v[36:39]
    v_mfma_f32_16x16x32_bf16 v[40:43], v[204:207], v[140:143], v[40:43]
    v_mfma_f32_16x16x32_bf16 v[44:47], v[208:211], v[140:143], v[44:47]
    v_mfma_f32_16x16x32_bf16 v[48:51], v[212:215], v[140:143], v[48:51]
    v_mov_b32 v3, 0x3f80
    v_cndmask_b32 v152, v3, v152, vcc
    v_cndmask_b32 v153, 0, v153, vcc
    ds_write_b64 v232, v[144:145] offset:8
    ds_write_b64 v232, v[146:147] offset:0
    ds_write_b64 v232, v[148:149] offset:24
    ds_write_b64 v232, v[150:151] offset:16
    ds_write_b64 v233, v[152:153] offset:64
    s_waitcnt lgkmcnt(5)
    v_readfirstlane_b32 s74, v248
    v_readfirstlane_b32 s75, v249
    s_and_b32 s70, s74, 0xfff
    s_bfe_u32 s71, s74, 0xc000c
    s_lshr_b64 s[72:73], s[74:75], 24
    s_bfe_u32 s73, s72, 0xc000c
    s_and_b32 s72, s72, 0xfff
    v_max3_f32 v72, v32, v33, v34
    v_min3_f32 v74, v32, v33, v34
    v_max3_f32 v73, v35, v36, v37
    v_min3_f32 v75, v35, v36, v37
    v_max3_f32 v72, v72, v38, v39
    v_min3_f32 v74, v74, v38, v39
    v_max3_f32 v73, v73, v40, v41
    v_min3_f32 v75, v75, v40, v41
    v_max3_f32 v72, v72, v42, v43
    v_min3_f32 v74, v74, v42, v43
    v_max3_f32 v73, v73, v44, v45
    v_min3_f32 v75, v75, v44, v45
    v_max3_f32 v72, v72, v46, v47
    v_min3_f32 v74, v74, v46, v47
    v_max3_f32 v73, v73, v48, v49
    v_min3_f32 v75, v75, v48, v49
    v_max_f32 v72, v72, v73
    v_min_f32 v74, v74, v75
    v_mul_f32 v73, v216, v72
    v_mul_f32 v75, v216, v74
    v_mul_f32 v72, v216, v72
    v_mul_f32 v74, v216, v74
    v_pk_fma_f32 v[52:53], v[32:33], v[216:217], v[74:75] neg_lo:[1,0,0] neg_hi:[1,0,0]
    v_pk_fma_f32 v[32:33], v[32:33], v[216:217], v[72:73] neg_lo:[0,0,1] neg_hi:[0,0,1]
    v_pk_fma_f32 v[54:55], v[34:35], v[216:217], v[74:75] neg_lo:[1,0,0] neg_hi:[1,0,0]
    v_pk_fma_f32 v[34:35], v[34:35], v[216:217], v[72:73] neg_lo:[0,0,1] neg_hi:[0,0,1]
    v_pk_fma_f32 v[56:57], v[36:37], v[216:217], v[74:75] neg_lo:[1,0,0] neg_hi:[1,0,0]
    v_pk_fma_f32 v[36:37], v[36:37], v[216:217], v[72:73] neg_lo:[0,0,1] neg_hi:[0,0,1]
    v_pk_fma_f32 v[58:59], v[38:39], v[216:217], v[74:75] neg_lo:[1,0,0] neg_hi:[1,0,0]
    v_pk_fma_f32 v[38:39], v[38:39], v[216:217], v[72:73] neg_lo:[0,0,1] neg_hi:[0,0,1]
    v_pk_fma_f32 v[60:61], v[40:41], v[216:217], v[74:75] neg_lo:[1,0,0] neg_hi:[1,0,0]
    v_pk_fma_f32 v[40:41], v[40:41], v[216:217], v[72:73] neg_lo:[0,0,1] neg_hi:[0,0,1]
    v_pk_fma_f32 v[62:63], v[42:43], v[216:217], v[74:75] neg_lo:[1,0,0] neg_hi:[1,0,0]
    v_pk_fma_f32 v[42:43], v[42:43], v[216:217], v[72:73] neg_lo:[0,0,1] neg_hi:[0,0,1]
    v_pk_fma_f32 v[64:65], v[44:45], v[216:217], v[74:75] neg_lo:[1,0,0] neg_hi:[1,0,0]
    v_pk_fma_f32 v[44:45], v[44:45], v[216:217], v[72:73] neg_lo:[0,0,1] neg_hi:[0,0,1]
    v_pk_fma_f32 v[66:67], v[46:47], v[216:217], v[74:75] neg_lo:[1,0,0] neg_hi:[1,0,0]
    v_pk_fma_f32 v[46:47], v[46:47], v[216:217], v[72:73] neg_lo:[0,0,1] neg_hi:[0,0,1]
    v_pk_fma_f32 v[68:69], v[48:49], v[216:217], v[74:75] neg_lo:[1,0,0] neg_hi:[1,0,0]
    v_pk_fma_f32 v[48:49], v[48:49], v[216:217], v[72:73] neg_lo:[0,0,1] neg_hi:[0,0,1]
    v_exp_f32 v52, v52
    v_exp_f32 v32, v32
    v_exp_f32 v53, v53
    v_exp_f32 v33, v33
    v_exp_f32 v54, v54
    v_exp_f32 v34, v34
    v_exp_f32 v55, v55
    v_exp_f32 v35, v35
    v_exp_f32 v56, v56
    v_exp_f32 v36, v36
    v_exp_f32 v57, v57
    v_exp_f32 v37, v37
    v_exp_f32 v58, v58
    v_exp_f32 v38, v38
    v_exp_f32 v59, v59
    v_exp_f32 v39, v39
    v_exp_f32 v60, v60
    v_exp_f32 v40, v40
    v_exp_f32 v61, v61
    v_exp_f32 v41, v41
    v_exp_f32 v62, v62
    v_exp_f32 v42, v42
    v_exp_f32 v63, v63
    v_exp_f32 v43, v43
    v_exp_f32 v64, v64
    v_exp_f32 v44, v44
    v_exp_f32 v65, v65
    v_exp_f32 v45, v45
    v_exp_f32 v66, v66
    v_exp_f32 v46, v46
    v_exp_f32 v67, v67
    v_exp_f32 v47, v47
    v_exp_f32 v68, v68
    v_exp_f32 v48, v48
    v_exp_f32 v69, v69
    v_exp_f32 v49, v49
    v_pk_add_f32 v[74:75], v[52:53], v[54:55]
    v_pk_add_f32 v[72:73], v[32:33], v[34:35]
    v_pk_add_f32 v[74:75], v[74:75], v[56:57]
    v_pk_add_f32 v[72:73], v[72:73], v[36:37]
    v_pk_add_f32 v[74:75], v[74:75], v[58:59]
    v_pk_add_f32 v[72:73], v[72:73], v[38:39]
    v_pk_add_f32 v[74:75], v[74:75], v[60:61]
    v_pk_add_f32 v[72:73], v[72:73], v[40:41]
    v_pk_add_f32 v[74:75], v[74:75], v[62:63]
    v_pk_add_f32 v[72:73], v[72:73], v[42:43]
    v_pk_add_f32 v[74:75], v[74:75], v[64:65]
    v_pk_add_f32 v[72:73], v[72:73], v[44:45]
    v_pk_add_f32 v[74:75], v[74:75], v[66:67]
    v_pk_add_f32 v[72:73], v[72:73], v[46:47]
    v_pk_add_f32 v[74:75], v[74:75], v[68:69]
    v_pk_add_f32 v[72:73], v[72:73], v[48:49]
    v_add_f32 v72, v72, v73
    v_add_f32 v74, v74, v75
    v_rcp_f32 v73, v72
    v_rcp_f32 v75, v74
    v_rcp_f32 v72, v72
    v_rcp_f32 v74, v74
    v_mov_b32 v114, 0
    v_mov_b32 v115, 0
    v_mov_b32 v116, 0
    v_mov_b32 v117, 0
    v_mov_b32 v118, 0
    v_mov_b32 v119, 0
    v_pk_mul_f32 v[32:33], v[32:33], v[72:73]
    v_pk_mul_f32 v[52:53], v[52:53], v[74:75]
    v_pk_mul_f32 v[34:35], v[34:35], v[72:73]
    v_pk_mul_f32 v[54:55], v[54:55], v[74:75]
    v_pk_mul_f32 v[36:37], v[36:37], v[72:73]
    v_pk_mul_f32 v[56:57], v[56:57], v[74:75]
    v_pk_mul_f32 v[38:39], v[38:39], v[72:73]
    v_pk_mul_f32 v[58:59], v[58:59], v[74:75]
    v_pk_mul_f32 v[40:41], v[40:41], v[72:73]
    v_pk_mul_f32 v[60:61], v[60:61], v[74:75]
    v_pk_mul_f32 v[42:43], v[42:43], v[72:73]
    v_pk_mul_f32 v[62:63], v[62:63], v[74:75]
    v_pk_mul_f32 v[44:45], v[44:45], v[72:73]
    v_pk_mul_f32 v[64:65], v[64:65], v[74:75]
    v_pk_mul_f32 v[46:47], v[46:47], v[72:73]
    v_pk_mul_f32 v[66:67], v[66:67], v[74:75]
    v_pk_mul_f32 v[48:49], v[48:49], v[72:73]
    v_pk_mul_f32 v[68:69], v[68:69], v[74:75]
    v_cvt_pk_bf16_f32 v96, v32, v33
    v_cvt_pk_bf16_f32 v97, v34, v35
    v_cvt_pk_bf16_f32 v98, v36, v37
    v_cvt_pk_bf16_f32 v99, v38, v39
    v_cvt_pk_bf16_f32 v100, v40, v41
    v_cvt_pk_bf16_f32 v101, v42, v43
    v_cvt_pk_bf16_f32 v102, v44, v45
    v_cvt_pk_bf16_f32 v103, v46, v47
    v_cvt_pk_bf16_f32 v104, v48, v49
    v_cvt_pk_bf16_f32 v105, v52, v53
    v_cvt_pk_bf16_f32 v106, v54, v55
    v_cvt_pk_bf16_f32 v107, v56, v57
    v_cvt_pk_bf16_f32 v108, v58, v59
    v_cvt_pk_bf16_f32 v109, v60, v61
    v_cvt_pk_bf16_f32 v110, v62, v63
    v_cvt_pk_bf16_f32 v111, v64, v65
    v_cvt_pk_bf16_f32 v112, v66, v67
    v_cvt_pk_bf16_f32 v113, v68, v69
    ds_write_b128 v234, v[96:99] offset:0
    ds_write_b128 v234, v[100:103] offset:16
    ds_write_b128 v234, v[104:107] offset:32
    ds_write_b128 v234, v[108:111] offset:48
    ds_write_b128 v234, v[112:115] offset:64
    ds_write_b128 v234, v[116:119] offset:80
    s_lshr_b32 s47, s2, 3
    s_lshl_b32 s47, s47, 2
    s_add_u32 s47, s47, s20
    s_lshl_b32 s47, s47, 9
    v_min_u32 v3, 3, v1
    s_getpc_b64 s[76:77]
L_k1_pc2:
    v_lshl_add_u32 v4, v3, 7, s47
    v_min_u32 v4, L_text_last - L_k1_pc2 - 4, v4
    global_load_dword a211, v4, s[76:77]
    v_mov_b32 v72, 0
    v_mov_b32 v73, 0
    v_mov_b32 v74, 0
    v_mov_b32 v75, 0
    v_and_b32 v2, 7, v1
    v_lshlrev_b32 v2, 4, v2
    ds_write_b128 v2, v[72:75] offset:39904
    s_waitcnt lgkmcnt(0)
    s_waitcnt vmcnt(2)
    s_barrier
    ds_read_b64_tr_b16 v[32:33], v222 offset:0
    ds_read_b64_tr_b16 v[34:35], v222 offset:384
    ds_read_b64_tr_b16 v[148:149], v223 offset:0
    ds_read_b64_tr_b16 v[150:151], v223 offset:320
    ds_read_b64_tr_b16 v[152:153], v224 offset:0
    ds_read_b64_tr_b16 v[154:155], v224 offset:320
    ds_read_b64_tr_b16 v[36:37], v222 offset:3072
    ds_read_b64_tr_b16 v[38:39], v222 offset:3456
    ds_read_b64_tr_b16 v[156:157], v223 offset:2560
    ds_read_b64_tr_b16 v[158:159], v223 offset:2880
    ds_read_b64_tr_b16 v[160:161], v224 offset:2560
    ds_read_b64_tr_b16 v[162:163], v224 offset:2880
    ds_read_b64_tr_b16 v[40:41], v222 offset:6144
    ds_read_b64_tr_b16 v[42:43], v222 offset:6528
    ds_read_b64_tr_b16 v[164:165], v223 offset:5120
    s_waitcnt lgkmcnt(14)
    ds_read_b64_tr_b16 v[166:167], v223 offset:5440
    s_waitcnt lgkmcnt(14)
    ds_read_b64_tr_b16 v[168:169], v224 offset:5120
    s_waitcnt lgkmcnt(14)
    ds_read_b64_tr_b16 v[170:171], v224 offset:5440
    s_waitcnt lgkmcnt(14)
    ds_read_b64_tr_b16 v[44:45], v222 offset:9216
    s_waitcnt lgkmcnt(14)
    ds_read_b64_tr_b16 v[46:47], v222 offset:9600
    s_waitcnt lgkmcnt(14)
    ds_read_b64_tr_b16 v[172:173], v223 offset:7680
    s_waitcnt lgkmcnt(14)
    ds_read_b64_tr_b16 v[174:175], v223 offset:8000
    s_waitcnt lgkmcnt(14)
    ds_read_b64_tr_b16 v[176:177], v224 offset:7680
    s_waitcnt lgkmcnt(14)
    ds_read_b64_tr_b16 v[178:179], v224 offset:8000
    s_waitcnt lgkmcnt(14)
    ds_read_b64_tr_b16 v[48:49], v227 offset:0
    s_waitcnt lgkmcnt(14)
    ds_read_b64_tr_b16 v[50:51], v227 offset:384
    s_waitcnt lgkmcnt(14)
    ds_read_b64_tr_b16 v[180:181], v228 offset:0
    s_waitcnt lgkmcnt(14)
    ds_read_b64_tr_b16 v[182:183], v228 offset:320
    s_waitcnt lgkmcnt(14)
    ds_read_b64_tr_b16 v[184:185], v229 offset:0
    s_waitcnt lgkmcnt(14)
    ds_read_b64_tr_b16 v[186:187], v229 offset:320
    s_waitcnt lgkmcnt(14)
    ds_read_b64_tr_b16 v[52:53], v227 offset:3072
    s_waitcnt lgkmcnt(14)
    ds_read_b64_tr_b16 v[54:55], v227 offset:3456
    s_waitcnt lgkmcnt(14)
    ds_read_b64_tr_b16 v[188:189], v228 offset:2560
    s_waitcnt lgkmcnt(14)
    ds_read_b64_tr_b16 v[190:191], v228 offset:2880
    s_waitcnt lgkmcnt(14)
    ds_read_b64_tr_b16 v[192:193], v229 offset:2560
    s_waitcnt lgkmcnt(14)
    ds_read_b64_tr_b16 v[194:195], v229 offset:2880
    s_waitcnt lgkmcnt(14)
    ds_read_b64_tr_b16 v[56:57], v227 offset:6144
    s_waitcnt lgkmcnt(14)
    ds_read_b64_tr_b16 v[58:59], v227 offset:6528
    s_waitcnt lgkmcnt(14)
    ds_read_b64_tr_b16 v[196:197], v228 offset:5120
    s_waitcnt lgkmcnt(14)
    ds_read_b64_tr_b16 v[198:199], v228 offset:5440
    s_waitcnt lgkmcnt(14)
    ds_read_b64_tr_b16 v[200:201], v229 offset:5120
    s_waitcnt lgkmcnt(14)
    ds_read_b64_tr_b16 v[202:203], v229 offset:5440
    s_waitcnt lgkmcnt(14)
    ds_read_b64_tr_b16 v[60:61], v227 offset:9216
    s_waitcnt lgkmcnt(14)
    ds_read_b64_tr_b16 v[62:63], v227 offset:9600
    s_waitcnt lgkmcnt(14)
    ds_read_b64_tr_b16 v[204:205], v228 offset:7680
    s_waitcnt lgkmcnt(14)
    ds_read_b64_tr_b16 v[206:207], v228 offset:8000
    s_waitcnt lgkmcnt(14)
    ds_read_b64_tr_b16 v[208:209], v229 offset:7680
    s_waitcnt lgkmcnt(14)
    ds_read_b64_tr_b16 v[210:211], v229 offset:8000
    v_mfma_f32_16x16x32_bf16 v[64:67], v[32:35], v[148:151], 0
    v_mfma_f32_16x16x32_bf16 v[68:71], v[32:35], v[152:155], 0
    v_mfma_f32_16x16x32_bf16 v[64:67], v[36:39], v[156:159], v[64:67]
    v_mfma_f32_16x16x32_bf16 v[68:71], v[36:39], v[160:163], v[68:71]
    v_mfma_f32_16x16x32_bf16 v[64:67], v[40:43], v[164:167], v[64:67]
    v_mfma_f32_16x16x32_bf16 v[68:71], v[40:43], v[168:171], v[68:71]
    v_mfma_f32_16x16x32_bf16 v[64:67], v[44:47], v[172:175], v[64:67]
    v_mfma_f32_16x16x32_bf16 v[68:71], v[44:47], v[176:179], v[68:71]
    v_mfma_f32_16x16x32_bf16 v[120:123], v[48:51], v[180:183], 0
    v_mfma_f32_16x16x32_bf16 v[124:127], v[48:51], v[184:187], 0
    s_waitcnt lgkmcnt(12)
    v_mfma_f32_16x16x32_bf16 v[120:123], v[52:55], v[188:191], v[120:123]
    v_mfma_f32_16x16x32_bf16 v[124:127], v[52:55], v[192:195], v[124:127]
    s_waitcnt lgkmcnt(6)
    v_mfma_f32_16x16x32_bf16 v[120:123], v[56:59], v[196:199], v[120:123]
    v_mfma_f32_16x16x32_bf16 v[124:127], v[56:59], v[200:203], v[124:127]
    s_waitcnt lgkmcnt(0)
    v_mfma_f32_16x16x32_bf16 v[120:123], v[60:63], v[204:207], v[120:123]
    v_mfma_f32_16x16x32_bf16 v[124:127], v[60:63], v[208:211], v[124:127]
    s_mul_i32 s47, s3, 6144
    v_mov_b32 v2, 0xfff
    ds_read_b64_tr_b16 v[132:133], v19 offset:0
    ds_read_b64_tr_b16 v[134:135], v19 offset:512
    ds_read_b64_tr_b16 v[136:137], v20 offset:0
    ds_read_b64_tr_b16 v[138:139], v20 offset:512
    ds_read_b64_tr_b16 v[140:141], v21 offset:0
    ds_read_b64_tr_b16 v[142:143], v21 offset:512
    v_bfi_b32 v64, v2, s70, v64
    v_bfi_b32 v65, v2, s71, v65
    v_bfi_b32 v66, v2, s72, v66
    v_bfi_b32 v67, v2, s73, v67
    buffer_store_dwordx4 v[64:67], v225, s[32:35], s47 offen sc1
    v_bfi_b32 v68, v2, s70, v68
    v_bfi_b32 v69, v2, s71, v69
    v_bfi_b32 v70, v2, s72, v70
    v_bfi_b32 v71, v2, s73, v71
    buffer_store_dwordx4 v[68:71], v226, s[32:35], s47 offen sc1
    v_bfi_b32 v120, v2, s70, v120
    v_bfi_b32 v121, v2, s71, v121
    v_bfi_b32 v122, v2, s72, v122
    v_bfi_b32 v123, v2, s73, v123
    buffer_store_dwordx4 v[120:123], v230, s[32:35], s47 offen sc1
    v_bfi_b32 v124, v2, s70, v124
    v_bfi_b32 v125, v2, s71, v125
    v_bfi_b32 v126, v2, s72, v126
    v_bfi_b32 v127, v2, s73, v127
    buffer_store_dwordx4 v[124:127], v231, s[32:35], s47 offen sc1
    ds_read_b64_tr_b16 v[144:145], v19 offset:4096
    ds_read_b64_tr_b16 v[146:147], v19 offset:4608
    s_waitcnt lgkmcnt(4)
    v_mfma_f32_16x16x32_bf16 v[72:75], v[132:135], a[0:3], 0
    ds_read_b64_tr_b16 v[148:149], v20 offset:4096
    v_mul_u32_u24 v207, 6144, v22
    v_mfma_f32_16x16x32_bf16 v[76:79], v[132:135], a[72:75], 0
    ds_read_b64_tr_b16 v[150:151], v20 offset:4608
    v_mov_b32 v7, 0x7fffff00
    v_mfma_f32_16x16x32_bf16 v[96:99], v[28:31], v[132:135], 0
    v_mov_b32 v2, v0
    v_mfma_f32_16x16x32_bf16 v[80:83], v[136:139], a[0:3], 0
    ds_read_b64_tr_b16 v[152:153], v21 offset:4096
    v_cmp_gt_u32 vcc, 380, v2
    v_mfma_f32_16x16x32_bf16 v[84:87], v[136:139], a[72:75], 0
    ds_read_b64_tr_b16 v[154:155], v21 offset:4608
    v_lshlrev_b32 v3, 4, v2
    v_mfma_f32_16x16x32_bf16 v[100:103], v[28:31], v[136:139], 0
    v_mul_u32_u24 v4, 3450, v2
    s_waitcnt lgkmcnt(4)
    v_mfma_f32_16x16x32_bf16 v[88:91], v[140:143], a[0:3], 0
    ds_read_b64_tr_b16 v[132:133], v19 offset:8192
    v_cndmask_b32 v188, v7, v3, vcc
    v_mfma_f32_16x16x32_bf16 v[92:95], v[140:143], a[72:75], 0
    ds_read_b64_tr_b16 v[134:135], v19 offset:8704
    v_lshrrev_b32 v3, 16, v4
    v_mfma_f32_16x16x32_bf16 v[104:107], v[28:31], v[140:143], 0
    v_mul_u32_u24 v4, 19, v3
    v_mfma_f32_16x16x32_bf16 v[72:75], v[144:147], a[4:7], v[72:75]
    ds_read_b64_tr_b16 v[136:137], v20 offset:8192
    v_sub_u32 v4, v2, v4
    v_mfma_f32_16x16x32_bf16 v[76:79], v[144:147], a[76:79], v[76:79]
    ds_read_b64_tr_b16 v[138:139], v20 offset:8704
    v_cmp_le_u32 s[50:51], 10, v3
    v_mfma_f32_16x16x32_bf16 v[96:99], v[28:31], v[144:147], v[96:99]
    v_mul_u32_u24 v4, 80, v4
    s_waitcnt lgkmcnt(4)
    v_mfma_f32_16x16x32_bf16 v[80:83], v[148:151], a[4:7], v[80:83]
    ds_read_b64_tr_b16 v[140:141], v21 offset:8192
    v_lshl_add_u32 v4, v3, 3, v4
    v_mfma_f32_16x16x32_bf16 v[84:87], v[148:151], a[76:79], v[84:87]
    ds_read_b64_tr_b16 v[142:143], v21 offset:8704
    v_add_u32 v5, 1440, v4
    v_mfma_f32_16x16x32_bf16 v[100:103], v[28:31], v[148:151], v[100:103]
    v_cndmask_b32 v4, v4, v5, s[50:51]
    v_mfma_f32_16x16x32_bf16 v[88:91], v[152:155], a[4:7], v[88:91]
    ds_read_b64_tr_b16 v[144:145], v19 offset:12288
    v_add_u32 v4, 36864, v4
    v_mfma_f32_16x16x32_bf16 v[92:95], v[152:155], a[76:79], v[92:95]
    ds_read_b64_tr_b16 v[146:147], v19 offset:12800
    v_mov_b32 v5, 40960
    v_mfma_f32_16x16x32_bf16 v[104:107], v[28:31], v[152:155], v[104:107]
    v_cndmask_b32 v190, v5, v4, vcc
    s_waitcnt lgkmcnt(4)
    v_mfma_f32_16x16x32_bf16 v[72:75], v[132:135], a[8:11], v[72:75]
    ds_read_b64_tr_b16 v[148:149], v20 offset:12288
    v_lshrrev_b32 v2, 1, v0
    v_mfma_f32_16x16x32_bf16 v[76:79], v[132:135], a[80:83], v[76:79]
    ds_read_b64_tr_b16 v[150:151], v20 offset:12800
    v_add_u32 v2, 256, v2
    v_mfma_f32_16x16x32_bf16 v[96:99], v[28:31], v[132:135], v[96:99]
    v_and_b32 v6, 1, v0
    v_mfma_f32_16x16x32_bf16 v[80:83], v[136:139], a[8:11], v[80:83]
    ds_read_b64_tr_b16 v[152:153], v21 offset:12288
    v_cmp_gt_u32 vcc, 380, v2
    v_mfma_f32_16x16x32_bf16 v[84:87], v[136:139], a[80:83], v[84:87]
    ds_read_b64_tr_b16 v[154:155], v21 offset:12800
    v_lshlrev_b32 v3, 4, v2
    v_mfma_f32_16x16x32_bf16 v[100:103], v[28:31], v[136:139], v[100:103]
    v_lshl_add_u32 v3, v6, 3, v3
    s_waitcnt lgkmcnt(4)
    v_mfma_f32_16x16x32_bf16 v[88:91], v[140:143], a[8:11], v[88:91]
    ds_read_b64_tr_b16 v[132:133], v19 offset:16384
    v_mul_u32_u24 v4, 3450, v2
    v_mfma_f32_16x16x32_bf16 v[92:95], v[140:143], a[80:83], v[92:95]
    ds_read_b64_tr_b16 v[134:135], v19 offset:16896
    v_cndmask_b32 v189, v7, v3, vcc
    v_mfma_f32_16x16x32_bf16 v[104:107], v[28:31], v[140:143], v[104:107]
    v_lshrrev_b32 v3, 16, v4
    v_mfma_f32_16x16x32_bf16 v[72:75], v[144:147], a[12:15], v[72:75]
    ds_read_b64_tr_b16 v[136:137], v20 offset:16384
    v_mul_u32_u24 v4, 19, v3
    v_mfma_f32_16x16x32_bf16 v[76:79], v[144:147], a[84:87], v[76:79]
    ds_read_b64_tr_b16 v[138:139], v20 offset:16896
    v_sub_u32 v4, v2, v4
    v_mfma_f32_16x16x32_bf16 v[96:99], v[28:31], v[144:147], v[96:99]
    v_cmp_le_u32 s[50:51], 10, v3
    s_waitcnt lgkmcnt(4)
    v_mfma_f32_16x16x32_bf16 v[80:83], v[148:151], a[12:15], v[80:83]
    ds_read_b64_tr_b16 v[140:141], v21 offset:16384
    v_mul_u32_u24 v4, 80, v4
    v_mfma_f32_16x16x32_bf16 v[84:87], v[148:151], a[84:87], v[84:87]
    ds_read_b64_tr_b16 v[142:143], v21 offset:16896
    v_lshl_add_u32 v4, v3, 3, v4
    v_mfma_f32_16x16x32_bf16 v[100:103], v[28:31], v[148:151], v[100:103]
    v_add_u32 v5, 1440, v4
    v_mfma_f32_16x16x32_bf16 v[88:91], v[152:155], a[12:15], v[88:91]
    ds_read_b64_tr_b16 v[144:145], v19 offset:20480
    v_cndmask_b32 v4, v4, v5, s[50:51]
    v_mfma_f32_16x16x32_bf16 v[92:95], v[152:155], a[84:87], v[92:95]
    ds_read_b64_tr_b16 v[146:147], v19 offset:20992
    v_add_u32 v4, 36864, v4
    v_mfma_f32_16x16x32_bf16 v[104:107], v[28:31], v[152:155], v[104:107]
    v_lshl_add_u32 v4, v6, 2, v4
    s_waitcnt lgkmcnt(4)
    v_mfma_f32_16x16x32_bf16 v[72:75], v[132:135], a[16:19], v[72:75]
    ds_read_b64_tr_b16 v[148:149], v20 offset:20480
    v_mov_b32 v5, 40960
    v_mfma_f32_16x16x32_bf16 v[76:79], v[132:135], a[88:91], v[76:79]
    ds_read_b64_tr_b16 v[150:151], v20 offset:20992
    v_cndmask_b32 v191, v5, v4, vcc
    v_mfma_f32_16x16x32_bf16 v[96:99], v[28:31], v[132:135], v[96:99]
    v_mov_b32 v7, 39904
    v_mfma_f32_16x16x32_bf16 v[80:83], v[136:139], a[16:19], v[80:83]
    ds_read_b64_tr_b16 v[152:153], v21 offset:20480
    v_lshrrev_b32 v2, 3, v22
    v_mfma_f32_16x16x32_bf16 v[84:87], v[136:139], a[88:91], v[84:87]
    ds_read_b64_tr_b16 v[154:155], v21 offset:20992
    v_lshlrev_b32 v2, 1, v2
    v_mfma_f32_16x16x32_bf16 v[100:103], v[28:31], v[136:139], v[100:103]
    v_sub_u32 v2, v23, v2
    s_waitcnt lgkmcnt(4)
    v_mfma_f32_16x16x32_bf16 v[88:91], v[140:143], a[16:19], v[88:91]
    ds_read_b64_tr_b16 v[132:133], v19 offset:24576
    v_mul_u32_u24 v3, 1520, v25
    v_mfma_f32_16x16x32_bf16 v[92:95], v[140:143], a[88:91], v[92:95]
    ds_read_b64_tr_b16 v[134:135], v19 offset:25088
    v_add_u32 v3, 38304, v3
    v_mfma_f32_16x16x32_bf16 v[104:107], v[28:31], v[140:143], v[104:107]
    v_cmp_eq_u32 vcc, v2, v25
    v_mfma_f32_16x16x32_bf16 v[72:75], v[144:147], a[20:23], v[72:75]
    ds_read_b64_tr_b16 v[136:137], v20 offset:24576
    v_cmp_gt_u32 s[50:51], 2, v25
    v_mfma_f32_16x16x32_bf16 v[76:79], v[144:147], a[92:95], v[76:79]
    ds_read_b64_tr_b16 v[138:139], v20 offset:25088
    v_and_b32 v4, 7, v22
    v_mfma_f32_16x16x32_bf16 v[96:99], v[28:31], v[144:147], v[96:99]
    s_and_b64 vcc, vcc, s[50:51]
    s_waitcnt lgkmcnt(4)
    v_mfma_f32_16x16x32_bf16 v[80:83], v[148:151], a[20:23], v[80:83]
    ds_read_b64_tr_b16 v[140:141], v21 offset:24576
    v_mul_u32_u24 v5, 80, v4
    v_mfma_f32_16x16x32_bf16 v[84:87], v[148:151], a[92:95], v[84:87]
    ds_read_b64_tr_b16 v[142:143], v21 offset:25088
    v_cndmask_b32 v192, v7, v3, vcc
    v_mfma_f32_16x16x32_bf16 v[100:103], v[28:31], v[148:151], v[100:103]
    v_cmp_eq_u32 vcc, 0, v2
    v_mfma_f32_16x16x32_bf16 v[88:91], v[152:155], a[20:23], v[88:91]
    ds_read_b64_tr_b16 v[144:145], v19 offset:28672
    v_add_u32 v3, 36864, v5
    v_mfma_f32_16x16x32_bf16 v[92:95], v[152:155], a[92:95], v[92:95]
    ds_read_b64_tr_b16 v[146:147], v19 offset:29184
    s_nop 1
    v_mfma_f32_16x16x32_bf16 v[104:107], v[28:31], v[152:155], v[104:107]
    v_cndmask_b32 v193, v7, v3, vcc
    s_waitcnt lgkmcnt(4)
    v_mfma_f32_16x16x32_bf16 v[72:75], v[132:135], a[24:27], v[72:75]
    ds_read_b64_tr_b16 v[148:149], v20 offset:28672
    v_cmp_eq_u32 vcc, 0, v2
    v_mfma_f32_16x16x32_bf16 v[76:79], v[132:135], a[96:99], v[76:79]
    ds_read_b64_tr_b16 v[150:151], v20 offset:29184
    v_add_u32 v3, 37504, v5
    v_mfma_f32_16x16x32_bf16 v[96:99], v[28:31], v[132:135], v[96:99]
    s_nop 1
    v_mfma_f32_16x16x32_bf16 v[80:83], v[136:139], a[24:27], v[80:83]
    ds_read_b64_tr_b16 v[152:153], v21 offset:28672
    v_cndmask_b32 v194, v7, v3, vcc
    v_mfma_f32_16x16x32_bf16 v[84:87], v[136:139], a[96:99], v[84:87]
    ds_read_b64_tr_b16 v[154:155], v21 offset:29184
    v_cmp_gt_u32 s[50:51], 2, v4
    v_mfma_f32_16x16x32_bf16 v[100:103], v[28:31], v[136:139], v[100:103]
    v_add_u32 v3, 38144, v5
    s_waitcnt lgkmcnt(4)
    v_mfma_f32_16x16x32_bf16 v[88:91], v[140:143], a[24:27], v[88:91]
    ds_read_b64_tr_b16 v[132:133], v19 offset:32768
    v_add_u32 v6, 38224, v5
    v_mfma_f32_16x16x32_bf16 v[92:95], v[140:143], a[96:99], v[92:95]
    ds_read_b64_tr_b16 v[134:135], v19 offset:33280
    v_cndmask_b32 v3, v6, v3, s[50:51]
    v_mfma_f32_16x16x32_bf16 v[104:107], v[28:31], v[140:143], v[104:107]
    v_cndmask_b32 v6, 1, 0, s[50:51]
    v_mfma_f32_16x16x32_bf16 v[72:75], v[144:147], a[28:31], v[72:75]
    ds_read_b64_tr_b16 v[136:137], v20 offset:32768
    v_cmp_eq_u32 vcc, v6, v2
    v_mfma_f32_16x16x32_bf16 v[76:79], v[144:147], a[100:103], v[76:79]
    ds_read_b64_tr_b16 v[138:139], v20 offset:33280
    s_nop 1
    v_mfma_f32_16x16x32_bf16 v[96:99], v[28:31], v[144:147], v[96:99]
    v_cndmask_b32 v195, v7, v3, vcc
    s_waitcnt lgkmcnt(4)
    v_mfma_f32_16x16x32_bf16 v[80:83], v[148:151], a[28:31], v[80:83]
    ds_read_b64_tr_b16 v[140:141], v21 offset:32768
    v_add_u32 v19, 36864, v19
    v_mfma_f32_16x16x32_bf16 v[84:87], v[148:151], a[100:103], v[84:87]
    ds_read_b64_tr_b16 v[142:143], v21 offset:33280
    v_cmp_eq_u32 vcc, 1, v2
    v_mfma_f32_16x16x32_bf16 v[100:103], v[28:31], v[148:151], v[100:103]
    v_add_u32 v3, 38864, v5
    v_mfma_f32_16x16x32_bf16 v[88:91], v[152:155], a[28:31], v[88:91]
    ds_read_b64_tr_b16 v[144:145], v19 offset:0
    v_add_u32 v20, 36864, v20
    v_mfma_f32_16x16x32_bf16 v[92:95], v[152:155], a[100:103], v[92:95]
    ds_read_b64_tr_b16 v[146:147], v19 offset:512
    s_nop 1
    v_mfma_f32_16x16x32_bf16 v[104:107], v[28:31], v[152:155], v[104:107]
    v_cndmask_b32 v196, v7, v3, vcc
    s_waitcnt lgkmcnt(4)
    v_mfma_f32_16x16x32_bf16 v[72:75], v[132:135], a[32:35], v[72:75]
    ds_read_b64_tr_b16 v[148:149], v20 offset:0
    v_add_u32 v21, 36864, v21
    v_mfma_f32_16x16x32_bf16 v[76:79], v[132:135], a[104:107], v[76:79]
    ds_read_b64_tr_b16 v[150:151], v20 offset:512
    v_cmp_eq_u32 vcc, 1, v2
    v_mfma_f32_16x16x32_bf16 v[96:99], v[28:31], v[132:135], v[96:99]
    v_add_u32 v3, 39504, v5
    v_mfma_f32_16x16x32_bf16 v[80:83], v[136:139], a[32:35], v[80:83]
    ds_read_b64_tr_b16 v[152:153], v21 offset:0
    v_cmp_gt_u32 s[50:51], 4, v4
    v_mfma_f32_16x16x32_bf16 v[84:87], v[136:139], a[104:107], v[84:87]
    ds_read_b64_tr_b16 v[154:155], v21 offset:512
    s_and_b64 vcc, vcc, s[50:51]
    v_mfma_f32_16x16x32_bf16 v[100:103], v[28:31], v[136:139], v[100:103]
    s_nop 1
    s_waitcnt lgkmcnt(4)
    v_mfma_f32_16x16x32_bf16 v[88:91], v[140:143], a[32:35], v[88:91]
    ds_read_b64_tr_b16 v[132:133], v19 offset:4096
    v_cndmask_b32 v197, v7, v3, vcc
    v_mfma_f32_16x16x32_bf16 v[92:95], v[140:143], a[104:107], v[92:95]
    ds_read_b64_tr_b16 v[134:135], v19 offset:4608
    s_mul_i32 s47, s10, 9
    v_mfma_f32_16x16x32_bf16 v[104:107], v[28:31], v[140:143], v[104:107]
    v_and_b32 v6, 1, v23
    v_mfma_f32_16x16x32_bf16 v[72:75], v[144:147], a[36:39], v[72:75]
    ds_read_b64_tr_b16 v[136:137], v20 offset:4096
    v_lshrrev_b32 v4, 1, v23
    v_mfma_f32_16x16x32_bf16 v[76:79], v[144:147], a[108:111], v[76:79]
    ds_read_b64_tr_b16 v[138:139], v20 offset:4608
    v_mul_u32_u24 v4, 18432, v4
    v_mfma_f32_16x16x32_bf16 v[96:99], v[28:31], v[144:147], v[96:99]
    v_lshl_add_u32 v4, v22, 4, v4
    s_waitcnt lgkmcnt(4)
    v_mfma_f32_16x16x32_bf16 v[80:83], v[148:151], a[36:39], v[80:83]
    ds_read_b64_tr_b16 v[140:141], v21 offset:4096
    v_add_u32 v2, s47, v6
    v_mfma_f32_16x16x32_bf16 v[84:87], v[148:151], a[108:111], v[84:87]
    ds_read_b64_tr_b16 v[142:143], v21 offset:4608
    v_lshrrev_b32 v3, 1, v2
    v_mfma_f32_16x16x32_bf16 v[100:103], v[28:31], v[148:151], v[100:103]
    v_and_b32 v2, 1, v2
    v_mfma_f32_16x16x32_bf16 v[88:91], v[152:155], a[36:39], v[88:91]
    ds_read_b64_tr_b16 v[144:145], v19 offset:8192
    v_lshl_add_u32 v4, v2, 3, v4
    v_mfma_f32_16x16x32_bf16 v[92:95], v[152:155], a[108:111], v[92:95]
    ds_read_b64_tr_b16 v[146:147], v19 offset:8704
    v_lshl_add_u32 v198, v3, 8, v4
    v_mfma_f32_16x16x32_bf16 v[104:107], v[28:31], v[152:155], v[104:107]
    v_cmp_eq_u32 vcc, 0, v6
    s_waitcnt lgkmcnt(4)
    v_mfma_f32_16x16x32_bf16 v[72:75], v[132:135], a[40:43], v[72:75]
    ds_read_b64_tr_b16 v[148:149], v20 offset:8192
    v_mov_b32 v7, 0x7fffff00
    v_mfma_f32_16x16x32_bf16 v[76:79], v[132:135], a[112:115], v[76:79]
    ds_read_b64_tr_b16 v[150:151], v20 offset:8704
    v_lshrrev_b32 v2, 3, v1
    v_mfma_f32_16x16x32_bf16 v[96:99], v[28:31], v[132:135], v[96:99]
    v_cndmask_b32 v199, v7, v198, vcc
    v_mfma_f32_16x16x32_bf16 v[80:83], v[136:139], a[40:43], v[80:83]
    ds_read_b64_tr_b16 v[152:153], v21 offset:8192
    v_and_b32 v4, 7, v1
    v_mfma_f32_16x16x32_bf16 v[84:87], v[136:139], a[112:115], v[84:87]
    ds_read_b64_tr_b16 v[154:155], v21 offset:8704
    v_and_b32 v5, 2, v2
    v_mfma_f32_16x16x32_bf16 v[100:103], v[28:31], v[136:139], v[100:103]
    v_xor_b32 v4, v4, v5
    s_waitcnt lgkmcnt(4)
    v_mfma_f32_16x16x32_bf16 v[88:91], v[140:143], a[40:43], v[88:91]
    ds_read_b64_tr_b16 v[132:133], v19 offset:12288
    v_mul_u32_u24 v2, 1152, v2
    v_mfma_f32_16x16x32_bf16 v[92:95], v[140:143], a[112:115], v[92:95]
    ds_read_b64_tr_b16 v[134:135], v19 offset:12800
    v_lshl_add_u32 v203, v4, 4, v2
    v_mfma_f32_16x16x32_bf16 v[104:107], v[28:31], v[140:143], v[104:107]
    v_xor_b32 v2, 64, v203
    v_mfma_f32_16x16x32_bf16 v[72:75], v[144:147], a[44:47], v[72:75]
    ds_read_b64_tr_b16 v[136:137], v20 offset:12288
    v_add_u32 v204, 8192, v2
    v_mfma_f32_16x16x32_bf16 v[76:79], v[144:147], a[116:119], v[76:79]
    ds_read_b64_tr_b16 v[138:139], v20 offset:12800
    v_add_u32 v205, 16384, v203
    v_mfma_f32_16x16x32_bf16 v[96:99], v[28:31], v[144:147], v[96:99]
    v_add_u32 v206, 24576, v2
    s_waitcnt lgkmcnt(4)
    v_mfma_f32_16x16x32_bf16 v[80:83], v[148:151], a[44:47], v[80:83]
    ds_read_b64_tr_b16 v[140:141], v21 offset:12288
    v_mfma_f32_16x16x32_bf16 v[84:87], v[148:151], a[116:119], v[84:87]
    ds_read_b64_tr_b16 v[142:143], v21 offset:12800
    v_mfma_f32_16x16x32_bf16 v[100:103], v[28:31], v[148:151], v[100:103]
    v_mfma_f32_16x16x32_bf16 v[88:91], v[152:155], a[44:47], v[88:91]
    ds_read_b64_tr_b16 v[144:145], v19 offset:16384
    v_mfma_f32_16x16x32_bf16 v[92:95], v[152:155], a[116:119], v[92:95]
    ds_read_b64_tr_b16 v[146:147], v19 offset:16896
    v_mfma_f32_16x16x32_bf16 v[104:107], v[28:31], v[152:155], v[104:107]
    s_waitcnt lgkmcnt(4)
    v_mfma_f32_16x16x32_bf16 v[72:75], v[132:135], a[48:51], v[72:75]
    ds_read_b64_tr_b16 v[148:149], v20 offset:16384
    v_mfma_f32_16x16x32_bf16 v[76:79], v[132:135], a[120:123], v[76:79]
    ds_read_b64_tr_b16 v[150:151], v20 offset:16896
    v_mfma_f32_16x16x32_bf16 v[96:99], v[28:31], v[132:135], v[96:99]
    buffer_load_dword v248, v207, s[32:35], s53 offen sc1
    v_mfma_f32_16x16x32_bf16 v[80:83], v[136:139], a[48:51], v[80:83]
    ds_read_b64_tr_b16 v[152:153], v21 offset:16384
    v_mfma_f32_16x16x32_bf16 v[84:87], v[136:139], a[120:123], v[84:87]
    ds_read_b64_tr_b16 v[154:155], v21 offset:16896
    v_mfma_f32_16x16x32_bf16 v[100:103], v[28:31], v[136:139], v[100:103]
    s_waitcnt lgkmcnt(4)
    v_mfma_f32_16x16x32_bf16 v[88:91], v[140:143], a[48:51], v[88:91]
    ds_read_b64_tr_b16 v[132:133], v19 offset:20480
    v_mfma_f32_16x16x32_bf16 v[92:95], v[140:143], a[120:123], v[92:95]
    ds_read_b64_tr_b16 v[134:135], v19 offset:20992
    v_mfma_f32_16x16x32_bf16 v[104:107], v[28:31], v[140:143], v[104:107]
    v_mfma_f32_16x16x32_bf16 v[72:75], v[144:147], a[52:55], v[72:75]
    ds_read_b64_tr_b16 v[136:137], v20 offset:20480
    v_mfma_f32_16x16x32_bf16 v[76:79], v[144:147], a[124:127], v[76:79]
    ds_read_b64_tr_b16 v[138:139], v20 offset:20992
    v_mfma_f32_16x16x32_bf16 v[96:99], v[28:31], v[144:147], v[96:99]
    s_waitcnt lgkmcnt(4)
    v_mfma_f32_16x16x32_bf16 v[80:83], v[148:151], a[52:55], v[80:83]
    ds_read_b64_tr_b16 v[140:141], v21 offset:20480
    v_mfma_f32_16x16x32_bf16 v[84:87], v[148:151], a[124:127], v[84:87]
    ds_read_b64_tr_b16 v[142:143], v21 offset:20992
    v_mfma_f32_16x16x32_bf16 v[100:103], v[28:31], v[148:151], v[100:103]
    v_mfma_f32_16x16x32_bf16 v[88:91], v[152:155], a[52:55], v[88:91]
    ds_read_b64_tr_b16 v[144:145], v19 offset:24576
    v_mfma_f32_16x16x32_bf16 v[92:95], v[152:155], a[124:127], v[92:95]
    ds_read_b64_tr_b16 v[146:147], v19 offset:25088
    v_mfma_f32_16x16x32_bf16 v[104:107], v[28:31], v[152:155], v[104:107]
    s_waitcnt lgkmcnt(4)
    v_mfma_f32_16x16x32_bf16 v[72:75], v[132:135], a[56:59], v[72:75]
    ds_read_b64_tr_b16 v[148:149], v20 offset:24576
    v_mfma_f32_16x16x32_bf16 v[76:79], v[132:135], a[128:131], v[76:79]
    ds_read_b64_tr_b16 v[150:151], v20 offset:25088
    v_mfma_f32_16x16x32_bf16 v[96:99], v[28:31], v[132:135], v[96:99]
    v_mfma_f32_16x16x32_bf16 v[80:83], v[136:139], a[56:59], v[80:83]
    ds_read_b64_tr_b16 v[152:153], v21 offset:24576
    v_mfma_f32_16x16x32_bf16 v[84:87], v[136:139], a[128:131], v[84:87]
    ds_read_b64_tr_b16 v[154:155], v21 offset:25088
    v_mfma_f32_16x16x32_bf16 v[100:103], v[28:31], v[136:139], v[100:103]
    s_waitcnt lgkmcnt(4)
    v_mfma_f32_16x16x32_bf16 v[88:91], v[140:143], a[56:59], v[88:91]
    ds_read_b64_tr_b16 v[132:133], v19 offset:28672
    v_mfma_f32_16x16x32_bf16 v[92:95], v[140:143], a[128:131], v[92:95]
    ds_read_b64_tr_b16 v[134:135], v19 offset:29184
    v_mfma_f32_16x16x32_bf16 v[104:107], v[28:31], v[140:143], v[104:107]
    v_mfma_f32_16x16x32_bf16 v[72:75], v[144:147], a[60:63], v[72:75]
    ds_read_b64_tr_b16 v[136:137], v20 offset:28672
    v_mfma_f32_16x16x32_bf16 v[76:79], v[144:147], a[132:135], v[76:79]
    ds_read_b64_tr_b16 v[138:139], v20 offset:29184
    v_mfma_f32_16x16x32_bf16 v[96:99], v[28:31], v[144:147], v[96:99]
    s_waitcnt lgkmcnt(4)
    v_mfma_f32_16x16x32_bf16 v[80:83], v[148:151], a[60:63], v[80:83]
    ds_read_b64_tr_b16 v[140:141], v21 offset:28672
    v_mfma_f32_16x16x32_bf16 v[84:87], v[148:151], a[132:135], v[84:87]
    ds_read_b64_tr_b16 v[142:143], v21 offset:29184
    v_mfma_f32_16x16x32_bf16 v[100:103], v[28:31], v[148:151], v[100:103]
    v_mfma_f32_16x16x32_bf16 v[88:91], v[152:155], a[60:63], v[88:91]
    ds_read_b64_tr_b16 v[144:145], v19 offset:32768
    v_mfma_f32_16x16x32_bf16 v[92:95], v[152:155], a[132:135], v[92:95]
    ds_read_b64_tr_b16 v[146:147], v19 offset:33280
    v_mfma_f32_16x16x32_bf16 v[104:107], v[28:31], v[152:155], v[104:107]
    s_waitcnt lgkmcnt(4)
    v_mfma_f32_16x16x32_bf16 v[72:75], v[132:135], a[64:67], v[72:75]
    ds_read_b64_tr_b16 v[148:149], v20 offset:32768
    v_mfma_f32_16x16x32_bf16 v[76:79], v[132:135], a[136:139], v[76:79]
    ds_read_b64_tr_b16 v[150:151], v20 offset:33280
    v_mfma_f32_16x16x32_bf16 v[96:99], v[28:31], v[132:135], v[96:99]
    v_mfma_f32_16x16x32_bf16 v[80:83], v[136:139], a[64:67], v[80:83]
    ds_read_b64_tr_b16 v[152:153], v21 offset:32768
    v_mfma_f32_16x16x32_bf16 v[84:87], v[136:139], a[136:139], v[84:87]
    ds_read_b64_tr_b16 v[154:155], v21 offset:33280
    v_mfma_f32_16x16x32_bf16 v[100:103], v[28:31], v[136:139], v[100:103]
    s_waitcnt lgkmcnt(4)
    v_mfma_f32_16x16x32_bf16 v[88:91], v[140:143], a[64:67], v[88:91]
    v_mfma_f32_16x16x32_bf16 v[92:95], v[140:143], a[136:139], v[92:95]
    v_mfma_f32_16x16x32_bf16 v[104:107], v[28:31], v[140:143], v[104:107]
    v_mfma_f32_16x16x32_bf16 v[72:75], v[144:147], a[68:71], v[72:75]
    v_mfma_f32_16x16x32_bf16 v[76:79], v[144:147], a[140:143], v[76:79]
    v_mfma_f32_16x16x32_bf16 v[96:99], v[28:31], v[144:147], v[96:99]
    s_waitcnt lgkmcnt(0)
    v_mfma_f32_16x16x32_bf16 v[80:83], v[148:151], a[68:71], v[80:83]
    v_mfma_f32_16x16x32_bf16 v[84:87], v[148:151], a[140:143], v[84:87]
    v_mfma_f32_16x16x32_bf16 v[100:103], v[28:31], v[148:151], v[100:103]
    v_mfma_f32_16x16x32_bf16 v[88:91], v[152:155], a[68:71], v[88:91]
    v_mfma_f32_16x16x32_bf16 v[92:95], v[152:155], a[140:143], v[92:95]
    v_mfma_f32_16x16x32_bf16 v[104:107], v[28:31], v[152:155], v[104:107]
    s_mov_b32 s54, 0
    s_waitcnt vmcnt(0)
L_k1_spin:
    v_xor_b32 v2, s70, v248
    v_and_b32 v2, 0xfff, v2
    v_cmp_ne_u32 vcc, 0, v2
    s_add_u32 s54, s54, 1
    s_cmp_ge_u32 s54, 0x40000
    s_cbranch_scc1 L_k1_go
    s_nop 2
    s_cbranch_vccz L_k1_go
    buffer_load_dword v248, v207, s[32:35], s53 offen sc1
    s_waitcnt vmcnt(0)
    s_branch L_k1_spin
L_k1_go:
    s_barrier
    s_mov_b32 s47, s53
    v_cvt_pk_bf16_f32 v97, v96, v96
    buffer_load_dwordx4 v[32:35], v188, s[32:35], s47 offen sc1
    v_and_b32 v97, 0xffff0000, v97
    buffer_load_dwordx2 v[156:157], v189, s[32:35], s47 offen sc1
    s_add_u32 s47, s47, 6144
    v_sub_f32 v96, v96, v97
    buffer_load_dwordx4 v[36:39], v188, s[32:35], s47 offen sc1
    v_cvt_pk_bf16_f32 v96, v97, v96
    buffer_load_dwordx2 v[158:159], v189, s[32:35], s47 offen sc1
    s_add_u32 s47, s47, 6144
    v_mov_b32 v97, 0
    buffer_load_dwordx4 v[40:43], v188, s[32:35], s47 offen sc1
    v_mov_b32 v98, 0
    buffer_load_dwordx2 v[160:161], v189, s[32:35], s47 offen sc1
    s_add_u32 s47, s47, 6144
    v_mov_b32 v99, 0
    buffer_load_dwordx4 v[44:47], v188, s[32:35], s47 offen sc1
    v_cvt_pk_bf16_f32 v101, v100, v100
    buffer_load_dwordx2 v[162:163], v189, s[32:35], s47 offen sc1
    s_add_u32 s47, s47, 6144
    v_and_b32 v101, 0xffff0000, v101
    buffer_load_dwordx4 v[48:51], v188, s[32:35], s47 offen sc1
    v_sub_f32 v100, v100, v101
    buffer_load_dwordx2 v[164:165], v189, s[32:35], s47 offen sc1
    s_add_u32 s47, s47, 6144
    v_cvt_pk_bf16_f32 v100, v101, v100
    buffer_load_dwordx4 v[52:55], v188, s[32:35], s47 offen sc1
    v_mov_b32 v101, 0
    buffer_load_dwordx2 v[166:167], v189, s[32:35], s47 offen sc1
    s_add_u32 s47, s47, 6144
    v_mov_b32 v102, 0
    buffer_load_dwordx4 v[56:59], v188, s[32:35], s47 offen sc1
    v_mov_b32 v103, 0
    buffer_load_dwordx2 v[168:169], v189, s[32:35], s47 offen sc1
    s_add_u32 s47, s47, 6144
    v_cvt_pk_bf16_f32 v105, v104, v104
    buffer_load_dwordx4 v[60:63], v188, s[32:35], s47 offen sc1
    v_and_b32 v105, 0xffff0000, v105
    buffer_load_dwordx2 v[170:171], v189, s[32:35], s47 offen sc1
    s_add_u32 s47, s47, 6144
    v_sub_f32 v104, v104, v105
    buffer_load_dwordx4 v[64:67], v188, s[32:35], s47 offen sc1
    v_cvt_pk_bf16_f32 v104, v105, v104
    buffer_load_dwordx2 v[172:173], v189, s[32:35], s47 offen sc1
    s_add_u32 s47, s47, 6144
    v_mov_b32 v105, 0
    buffer_load_dwordx4 v[68:71], v188, s[32:35], s47 offen sc1
    v_mov_b32 v106, 0
    buffer_load_dwordx2 v[174:175], v189, s[32:35], s47 offen sc1
    s_add_u32 s47, s47, 6144
    v_mov_b32 v107, 0
    buffer_load_dwordx4 v[108:111], v188, s[32:35], s47 offen sc1
    s_nop 1
    buffer_load_dwordx2 v[176:177], v189, s[32:35], s47 offen sc1
    s_add_u32 s47, s47, 6144
    v_mfma_f32_16x16x32_bf16 v[72:75], v[96:99], v[240:243], v[72:75]
    buffer_load_dwordx4 v[112:115], v188, s[32:35], s47 offen sc1
    v_mfma_f32_16x16x32_bf16 v[76:79], v[96:99], v[244:247], v[76:79]
    buffer_load_dwordx2 v[178:179], v189, s[32:35], s47 offen sc1
    s_add_u32 s47, s47, 6144
    v_mfma_f32_16x16x32_bf16 v[80:83], v[100:103], v[240:243], v[80:83]
    buffer_load_dwordx4 v[116:119], v188, s[32:35], s47 offen sc1
    v_mfma_f32_16x16x32_bf16 v[84:87], v[100:103], v[244:247], v[84:87]
    buffer_load_dwordx2 v[180:181], v189, s[32:35], s47 offen sc1
    s_add_u32 s47, s47, 6144
    v_mfma_f32_16x16x32_bf16 v[88:91], v[104:107], v[240:243], v[88:91]
    buffer_load_dwordx4 v[120:123], v188, s[32:35], s47 offen sc1
    v_mfma_f32_16x16x32_bf16 v[92:95], v[104:107], v[244:247], v[92:95]
    buffer_load_dwordx2 v[182:183], v189, s[32:35], s47 offen sc1
    s_add_u32 s47, s47, 6144
    s_nop 4
    buffer_load_dwordx4 v[124:127], v188, s[32:35], s47 offen sc1
    v_cvt_pk_bf16_f32 v132, v72, v73
    buffer_load_dwordx2 v[184:185], v189, s[32:35], s47 offen sc1
    s_add_u32 s47, s47, 6144
    v_cvt_pk_bf16_f32 v133, v74, v75
    buffer_load_dwordx4 v[128:131], v188, s[32:35], s47 offen sc1
    v_cvt_pk_bf16_f32 v134, v76, v77
    buffer_load_dwordx2 v[186:187], v189, s[32:35], s47 offen sc1
    v_mov_b32 v4, 0
    v_cvt_pk_bf16_f32 v135, v78, v79
    buffer_load_dwordx2 a[212:213], v4, s[60:63], 0 offen sc1
    v_cvt_pk_bf16_f32 v136, v80, v81
    v_cvt_pk_bf16_f32 v137, v82, v83
    v_cvt_pk_bf16_f32 v138, v84, v85
    s_add_u32 m0, s66, 73728
    s_add_u32 s67, s64, 0
    v_cvt_pk_bf16_f32 v139, v86, v87
    v_cvt_pk_bf16_f32 v140, v88, v89
    v_cvt_pk_bf16_f32 v141, v90, v91
    v_cvt_pk_bf16_f32 v142, v92, v93
    buffer_load_dwordx4 v203, s[24:27], s67 offen offset:0 lds
    v_cvt_pk_bf16_f32 v143, v94, v95
    s_nop 0
    v_permlane32_swap_b32 v132, v134
    v_permlane32_swap_b32 v133, v135
    buffer_load_dwordx4 v204, s[24:27], s67 offen offset:1024 lds
    v_permlane32_swap_b32 v136, v138
    v_permlane32_swap_b32 v137, v139
    v_permlane32_swap_b32 v140, v142
    v_permlane32_swap_b32 v141, v143
    buffer_load_dwordx4 v205, s[24:27], s67 offen offset:2048 lds
    s_nop 1
    v_mfma_f32_16x16x32_bf16 v[72:75], a[144:147], v[132:135], 0
    v_mfma_f32_16x16x32_bf16 v[76:79], a[148:151], v[132:135], 0
    v_mfma_f32_16x16x32_bf16 v[80:83], a[152:155], v[132:135], 0
    buffer_load_dwordx4 v206, s[24:27], s67 offen offset:3072 lds
    v_mfma_f32_16x16x32_bf16 v[84:87], a[156:159], v[132:135], 0
    v_mfma_f32_16x16x32_bf16 v[88:91], a[160:163], v[132:135], 0
    v_mfma_f32_16x16x32_bf16 v[72:75], a[164:167], v[136:139], v[72:75]
    v_mfma_f32_16x16x32_bf16 v[76:79], a[168:171], v[136:139], v[76:79]
    s_add_u32 m0, s66, 77824
    s_add_u32 s67, s64, 36864
    v_mfma_f32_16x16x32_bf16 v[80:83], a[172:175], v[136:139], v[80:83]
    v_mfma_f32_16x16x32_bf16 v[84:87], a[176:179], v[136:139], v[84:87]
    v_mfma_f32_16x16x32_bf16 v[88:91], a[180:183], v[136:139], v[88:91]
    v_mfma_f32_16x16x32_bf16 v[72:75], a[184:187], v[140:143], v[72:75]
    buffer_load_dwordx4 v203, s[24:27], s67 offen offset:0 lds
    v_mfma_f32_16x16x32_bf16 v[76:79], a[188:191], v[140:143], v[76:79]
    v_mfma_f32_16x16x32_bf16 v[80:83], a[192:195], v[140:143], v[80:83]
    v_mfma_f32_16x16x32_bf16 v[84:87], a[196:199], v[140:143], v[84:87]
    v_mfma_f32_16x16x32_bf16 v[88:91], a[200:203], v[140:143], v[88:91]
    buffer_load_dwordx4 v204, s[24:27], s67 offen offset:1024 lds
    s_nop 4
    v_max3_f32 v96, v72, v73, v74
    v_min3_f32 v98, v72, v73, v74
    v_max3_f32 v97, v75, v76, v77
    buffer_load_dwordx4 v205, s[24:27], s67 offen offset:2048 lds
    v_min3_f32 v99, v75, v76, v77
    v_max3_f32 v96, v96, v78, v79
    v_min3_f32 v98, v98, v78, v79
    v_max3_f32 v97, v97, v80, v81
    buffer_load_dwordx4 v206, s[24:27], s67 offen offset:3072 lds
    v_min3_f32 v99, v99, v80, v81
    v_max3_f32 v96, v96, v82, v83
    v_min3_f32 v98, v98, v82, v83
    v_max3_f32 v97, v97, v84, v85
    s_add_u32 m0, s66, 81920
    s_add_u32 s67, s64, 73728
    v_min3_f32 v99, v99, v84, v85
    v_max3_f32 v96, v96, v86, v87
    v_min3_f32 v98, v98, v86, v87
    v_max3_f32 v97, v97, v88, v89
    buffer_load_dwordx4 v203, s[24:27], s67 offen offset:0 lds
    v_min3_f32 v99, v99, v88, v89
    v_max_f32 v96, v96, v97
    v_min_f32 v98, v98, v99
    v_mul_f32 v97, v218, v96
    buffer_load_dwordx4 v204, s[24:27], s67 offen offset:1024 lds
    v_mul_f32 v99, v218, v98
    v_mul_f32 v96, v218, v96
    v_mul_f32 v98, v218, v98
    v_pk_fma_f32 v[220:221], v[72:73], v[218:219], v[98:99] neg_lo:[1,0,0] neg_hi:[1,0,0]
    buffer_load_dwordx4 v205, s[24:27], s67 offen offset:2048 lds
    v_pk_fma_f32 v[72:73], v[72:73], v[218:219], v[96:97] neg_lo:[0,0,1] neg_hi:[0,0,1]
    v_pk_fma_f32 v[222:223], v[74:75], v[218:219], v[98:99] neg_lo:[1,0,0] neg_hi:[1,0,0]
    v_pk_fma_f32 v[74:75], v[74:75], v[218:219], v[96:97] neg_lo:[0,0,1] neg_hi:[0,0,1]
    v_pk_fma_f32 v[224:225], v[76:77], v[218:219], v[98:99] neg_lo:[1,0,0] neg_hi:[1,0,0]
    buffer_load_dwordx4 v206, s[24:27], s67 offen offset:3072 lds
    v_pk_fma_f32 v[76:77], v[76:77], v[218:219], v[96:97] neg_lo:[0,0,1] neg_hi:[0,0,1]
    v_pk_fma_f32 v[226:227], v[78:79], v[218:219], v[98:99] neg_lo:[1,0,0] neg_hi:[1,0,0]
    v_pk_fma_f32 v[78:79], v[78:79], v[218:219], v[96:97] neg_lo:[0,0,1] neg_hi:[0,0,1]
    v_pk_fma_f32 v[228:229], v[80:81], v[218:219], v[98:99] neg_lo:[1,0,0] neg_hi:[1,0,0]
    s_add_u32 m0, s66, 86016
    s_add_u32 s67, s64, 110592
    v_pk_fma_f32 v[80:81], v[80:81], v[218:219], v[96:97] neg_lo:[0,0,1] neg_hi:[0,0,1]
    v_pk_fma_f32 v[230:231], v[82:83], v[218:219], v[98:99] neg_lo:[1,0,0] neg_hi:[1,0,0]
    v_pk_fma_f32 v[82:83], v[82:83], v[218:219], v[96:97] neg_lo:[0,0,1] neg_hi:[0,0,1]
    v_pk_fma_f32 v[232:233], v[84:85], v[218:219], v[98:99] neg_lo:[1,0,0] neg_hi:[1,0,0]
    buffer_load_dwordx4 v203, s[24:27], s67 offen offset:0 lds
    v_pk_fma_f32 v[84:85], v[84:85], v[218:219], v[96:97] neg_lo:[0,0,1] neg_hi:[0,0,1]
    v_pk_fma_f32 v[234:235], v[86:87], v[218:219], v[98:99] neg_lo:[1,0,0] neg_hi:[1,0,0]
    v_pk_fma_f32 v[86:87], v[86:87], v[218:219], v[96:97] neg_lo:[0,0,1] neg_hi:[0,0,1]
    v_pk_fma_f32 v[236:237], v[88:89], v[218:219], v[98:99] neg_lo:[1,0,0] neg_hi:[1,0,0]
    buffer_load_dwordx4 v204, s[24:27], s67 offen offset:1024 lds
    v_pk_fma_f32 v[88:89], v[88:89], v[218:219], v[96:97] neg_lo:[0,0,1] neg_hi:[0,0,1]
    v_exp_f32 v220, v220
    v_exp_f32 v72, v72
    v_exp_f32 v221, v221
    buffer_load_dwordx4 v205, s[24:27], s67 offen offset:2048 lds
    v_exp_f32 v73, v73
    v_exp_f32 v222, v222
    v_exp_f32 v74, v74
    v_exp_f32 v223, v223
    buffer_load_dwordx4 v206, s[24:27], s67 offen offset:3072 lds
    v_exp_f32 v75, v75
    v_exp_f32 v224, v224
    v_exp_f32 v76, v76
    v_exp_f32 v225, v225
    s_add_u32 m0, s66, 90112
    s_add_u32 s67, s64, 147456
    v_exp_f32 v77, v77
    v_exp_f32 v226, v226
    v_exp_f32 v78, v78
    v_exp_f32 v227, v227
    buffer_load_dwordx4 v203, s[24:27], s67 offen offset:0 lds
    v_exp_f32 v79, v79
    v_exp_f32 v228, v228
    v_exp_f32 v80, v80
    v_exp_f32 v229, v229
    buffer_load_dwordx4 v204, s[24:27], s67 offen offset:1024 lds
    v_exp_f32 v81, v81
    v_exp_f32 v230, v230
    v_exp_f32 v82, v82
    v_exp_f32 v231, v231
    s_mov_b32 m0, s52
    s_mov_b32 s12, s4
    s_mov_b32 s13, s5
    s_mov_b32 s14, 0x240000
    v_exp_f32 v83, v83
    v_exp_f32 v232, v232
    v_exp_f32 v84, v84
    v_exp_f32 v233, v233
    buffer_load_dwordx4 v8, s[12:15], s65 offen offset:0 lds
    v_exp_f32 v85, v85
    v_exp_f32 v234, v234
    v_exp_f32 v86, v86
    v_exp_f32 v235, v235
    buffer_load_dwordx4 v9, s[12:15], s65 offen offset:1024 lds
    v_exp_f32 v87, v87
    v_exp_f32 v236, v236
    v_exp_f32 v88, v88
    v_exp_f32 v237, v237
    buffer_load_dwordx4 v10, s[12:15], s65 offen offset:2048 lds
    v_exp_f32 v89, v89
    v_pk_add_f32 v[98:99], v[220:221], v[222:223]
    v_pk_add_f32 v[96:97], v[72:73], v[74:75]
    v_pk_add_f32 v[98:99], v[98:99], v[224:225]
    buffer_load_dwordx4 v11, s[12:15], s65 offen offset:3072 lds
    v_pk_add_f32 v[96:97], v[96:97], v[76:77]
    v_pk_add_f32 v[98:99], v[98:99], v[226:227]
    v_pk_add_f32 v[96:97], v[96:97], v[78:79]
    v_pk_add_f32 v[98:99], v[98:99], v[228:229]
    v_pk_add_f32 v[96:97], v[96:97], v[80:81]
    v_pk_add_f32 v[98:99], v[98:99], v[230:231]
    v_pk_add_f32 v[96:97], v[96:97], v[82:83]
    v_pk_add_f32 v[98:99], v[98:99], v[232:233]
    v_pk_add_f32 v[96:97], v[96:97], v[84:85]
    v_pk_add_f32 v[98:99], v[98:99], v[234:235]
    v_pk_add_f32 v[96:97], v[96:97], v[86:87]
    v_pk_add_f32 v[98:99], v[98:99], v[236:237]
    v_pk_add_f32 v[96:97], v[96:97], v[88:89]
    v_add_f32 v96, v96, v97
    v_add_f32 v98, v98, v99
    v_rcp_f32 v97, v96
    v_rcp_f32 v99, v98
    v_rcp_f32 v96, v96
    v_rcp_f32 v98, v98
    v_mov_b32 v150, 0
    v_mov_b32 v151, 0
    v_pk_mul_f32 v[72:73], v[72:73], v[96:97]
    v_pk_mul_f32 v[220:221], v[220:221], v[98:99]
    v_pk_mul_f32 v[74:75], v[74:75], v[96:97]
    v_pk_mul_f32 v[222:223], v[222:223], v[98:99]
    v_pk_mul_f32 v[76:77], v[76:77], v[96:97]
    v_pk_mul_f32 v[224:225], v[224:225], v[98:99]
    v_pk_mul_f32 v[78:79], v[78:79], v[96:97]
    v_pk_mul_f32 v[226:227], v[226:227], v[98:99]
    v_pk_mul_f32 v[80:81], v[80:81], v[96:97]
    v_pk_mul_f32 v[228:229], v[228:229], v[98:99]
    v_pk_mul_f32 v[82:83], v[82:83], v[96:97]
    v_pk_mul_f32 v[230:231], v[230:231], v[98:99]
    v_pk_mul_f32 v[84:85], v[84:85], v[96:97]
    v_pk_mul_f32 v[232:233], v[232:233], v[98:99]
    v_pk_mul_f32 v[86:87], v[86:87], v[96:97]
    v_pk_mul_f32 v[234:235], v[234:235], v[98:99]
    v_pk_mul_f32 v[88:89], v[88:89], v[96:97]
    v_pk_mul_f32 v[236:237], v[236:237], v[98:99]
    v_cvt_pk_bf16_f32 v132, v72, v73
    v_cvt_pk_bf16_f32 v133, v74, v75
    v_cvt_pk_bf16_f32 v134, v76, v77
    v_cvt_pk_bf16_f32 v135, v78, v79
    v_cvt_pk_bf16_f32 v136, v80, v81
    v_cvt_pk_bf16_f32 v137, v82, v83
    v_cvt_pk_bf16_f32 v138, v84, v85
    v_cvt_pk_bf16_f32 v139, v86, v87
    v_cvt_pk_bf16_f32 v140, v88, v89
    v_cvt_pk_bf16_f32 v141, v220, v221
    v_cvt_pk_bf16_f32 v142, v222, v223
    v_cvt_pk_bf16_f32 v143, v224, v225
    v_cvt_pk_bf16_f32 v144, v226, v227
    v_cvt_pk_bf16_f32 v145, v228, v229
    v_cvt_pk_bf16_f32 v146, v230, v231
    v_cvt_pk_bf16_f32 v147, v232, v233
    v_cvt_pk_bf16_f32 v148, v234, v235
    v_cvt_pk_bf16_f32 v149, v236, v237
L_k1_red:
    v_and_b32 v3, 1, v0
    v_cmp_eq_u32 vcc, 0, v3
    v_mov_b32 v4, s72
    v_mov_b32 v5, s73
    v_mov_b32 v2, s70
    v_mov_b32 v3, s71
    v_cndmask_b32 v4, v4, v2, vcc
    v_cndmask_b32 v5, v5, v3, vcc
    v_cmp_gt_u32 vcc, 248, v0
    v_mov_b32 v2, 0
    v_mov_b32 v3, 0
    s_waitcnt vmcnt(47)
    v_xor_b32 v32, s70, v32
    v_xor_b32 v33, s71, v33
    v_xor_b32 v34, s72, v34
    v_xor_b32 v35, s73, v35
    v_xor_b32 v156, v4, v156
    v_xor_b32 v157, v5, v157
    v_or3_b32 v2, v2, v32, v33
    v_or3_b32 v2, v2, v34, v35
    v_or3_b32 v3, v3, v156, v157
    v_xor_b32 v36, s70, v36
    v_xor_b32 v37, s71, v37
    v_xor_b32 v38, s72, v38
    v_xor_b32 v39, s73, v39
    v_xor_b32 v158, v4, v158
    v_xor_b32 v159, v5, v159
    v_or3_b32 v2, v2, v36, v37
    v_or3_b32 v2, v2, v38, v39
    v_or3_b32 v3, v3, v158, v159
    v_pk_add_f32 v[32:33], v[32:33], v[36:37]
    v_pk_add_f32 v[34:35], v[34:35], v[38:39]
    v_pk_add_f32 v[156:157], v[156:157], v[158:159]
    v_xor_b32 v40, s70, v40
    v_xor_b32 v41, s71, v41
    v_xor_b32 v42, s72, v42
    v_xor_b32 v43, s73, v43
    v_xor_b32 v160, v4, v160
    v_xor_b32 v161, v5, v161
    v_or3_b32 v2, v2, v40, v41
    v_or3_b32 v2, v2, v42, v43
    v_or3_b32 v3, v3, v160, v161
    v_pk_add_f32 v[32:33], v[32:33], v[40:41]
    v_pk_add_f32 v[34:35], v[34:35], v[42:43]
    v_pk_add_f32 v[156:157], v[156:157], v[160:161]
    v_xor_b32 v44, s70, v44
    v_xor_b32 v45, s71, v45
    v_xor_b32 v46, s72, v46
    v_xor_b32 v47, s73, v47
    v_xor_b32 v162, v4, v162
    v_xor_b32 v163, v5, v163
    v_or3_b32 v2, v2, v44, v45
    v_or3_b32 v2, v2, v46, v47
    v_or3_b32 v3, v3, v162, v163
    v_pk_add_f32 v[32:33], v[32:33], v[44:45]
    v_pk_add_f32 v[34:35], v[34:35], v[46:47]
    v_pk_add_f32 v[156:157], v[156:157], v[162:163]
    s_waitcnt vmcnt(39)
    v_xor_b32 v48, s70, v48
    v_xor_b32 v49, s71, v49
    v_xor_b32 v50, s72, v50
    v_xor_b32 v51, s73, v51
    v_xor_b32 v164, v4, v164
    v_xor_b32 v165, v5, v165
    v_or3_b32 v2, v2, v48, v49
    v_or3_b32 v2, v2, v50, v51
    v_or3_b32 v3, v3, v164, v165
    v_pk_add_f32 v[32:33], v[32:33], v[48:49]
    v_pk_add_f32 v[34:35], v[34:35], v[50:51]
    v_pk_add_f32 v[156:157], v[156:157], v[164:165]
    v_xor_b32 v52, s70, v52
    v_xor_b32 v53, s71, v53
    v_xor_b32 v54, s72, v54
    v_xor_b32 v55, s73, v55
    v_xor_b32 v166, v4, v166
    v_xor_b32 v167, v5, v167
    v_or3_b32 v2, v2, v52, v53
    v_or3_b32 v2, v2, v54, v55
    v_or3_b32 v3, v3, v166, v167
    v_pk_add_f32 v[32:33], v[32:33], v[52:53]
    v_pk_add_f32 v[34:35], v[34:35], v[54:55]
    v_pk_add_f32 v[156:157], v[156:157], v[166:167]
    v_xor_b32 v56, s70, v56
    v_xor_b32 v57, s71, v57
    v_xor_b32 v58, s72, v58
    v_xor_b32 v59, s73, v59
    v_xor_b32 v168, v4, v168
    v_xor_b32 v169, v5, v169
    v_or3_b32 v2, v2, v56, v57
    v_or3_b32 v2, v2, v58, v59
    v_or3_b32 v3, v3, v168, v169
    v_pk_add_f32 v[32:33], v[32:33], v[56:57]
    v_pk_add_f32 v[34:35], v[34:35], v[58:59]
    v_pk_add_f32 v[156:157], v[156:157], v[168:169]
    v_xor_b32 v60, s70, v60
    v_xor_b32 v61, s71, v61
    v_xor_b32 v62, s72, v62
    v_xor_b32 v63, s73, v63
    v_xor_b32 v170, v4, v170
    v_xor_b32 v171, v5, v171
    v_or3_b32 v2, v2, v60, v61
    v_or3_b32 v2, v2, v62, v63
    v_or3_b32 v3, v3, v170, v171
    v_pk_add_f32 v[32:33], v[32:33], v[60:61]
    v_pk_add_f32 v[34:35], v[34:35], v[62:63]
    v_pk_add_f32 v[156:157], v[156:157], v[170:171]
    s_waitcnt vmcnt(31)
    v_xor_b32 v64, s70, v64
    v_xor_b32 v65, s71, v65
    v_xor_b32 v66, s72, v66
    v_xor_b32 v67, s73, v67
    v_xor_b32 v172, v4, v172
    v_xor_b32 v173, v5, v173
    v_or3_b32 v2, v2, v64, v65
    v_or3_b32 v2, v2, v66, v67
    v_or3_b32 v3, v3, v172, v173
    v_pk_add_f32 v[32:33], v[32:33], v[64:65]
    v_pk_add_f32 v[34:35], v[34:35], v[66:67]
    v_pk_add_f32 v[156:157], v[156:157], v[172:173]
    v_xor_b32 v68, s70, v68
    v_xor_b32 v69, s71, v69
    v_xor_b32 v70, s72, v70
    v_xor_b32 v71, s73, v71
    v_xor_b32 v174, v4, v174
    v_xor_b32 v175, v5, v175
    v_or3_b32 v2, v2, v68, v69
    v_or3_b32 v2, v2, v70, v71
    v_or3_b32 v3, v3, v174, v175
    v_pk_add_f32 v[32:33], v[32:33], v[68:69]
    v_pk_add_f32 v[34:35], v[34:35], v[70:71]
    v_pk_add_f32 v[156:157], v[156:157], v[174:175]
    v_xor_b32 v108, s70, v108
    v_xor_b32 v109, s71, v109
    v_xor_b32 v110, s72, v110
    v_xor_b32 v111, s73, v111
    v_xor_b32 v176, v4, v176
    v_xor_b32 v177, v5, v177
    v_or3_b32 v2, v2, v108, v109
    v_or3_b32 v2, v2, v110, v111
    v_or3_b32 v3, v3, v176, v177
    v_pk_add_f32 v[32:33], v[32:33], v[108:109]
    v_pk_add_f32 v[34:35], v[34:35], v[110:111]
    v_pk_add_f32 v[156:157], v[156:157], v[176:177]
    v_xor_b32 v112, s70, v112
    v_xor_b32 v113, s71, v113
    v_xor_b32 v114, s72, v114
    v_xor_b32 v115, s73, v115
    v_xor_b32 v178, v4, v178
    v_xor_b32 v179, v5, v179
    v_or3_b32 v2, v2, v112, v113
    v_or3_b32 v2, v2, v114, v115
    v_or3_b32 v3, v3, v178, v179
    v_pk_add_f32 v[32:33], v[32:33], v[112:113]
    v_pk_add_f32 v[34:35], v[34:35], v[114:115]
    v_pk_add_f32 v[156:157], v[156:157], v[178:179]
    s_waitcnt vmcnt(23)
    v_xor_b32 v116, s70, v116
    v_xor_b32 v117, s71, v117
    v_xor_b32 v118, s72, v118
    v_xor_b32 v119, s73, v119
    v_xor_b32 v180, v4, v180
    v_xor_b32 v181, v5, v181
    v_or3_b32 v2, v2, v116, v117
    v_or3_b32 v2, v2, v118, v119
    v_or3_b32 v3, v3, v180, v181
    v_pk_add_f32 v[32:33], v[32:33], v[116:117]
    v_pk_add_f32 v[34:35], v[34:35], v[118:119]
    v_pk_add_f32 v[156:157], v[156:157], v[180:181]
    v_xor_b32 v120, s70, v120
    v_xor_b32 v121, s71, v121
    v_xor_b32 v122, s72, v122
    v_xor_b32 v123, s73, v123
    v_xor_b32 v182, v4, v182
    v_xor_b32 v183, v5, v183
    v_or3_b32 v2, v2, v120, v121
    v_or3_b32 v2, v2, v122, v123
    v_or3_b32 v3, v3, v182, v183
    v_pk_add_f32 v[32:33], v[32:33], v[120:121]
    v_pk_add_f32 v[34:35], v[34:35], v[122:123]
    v_pk_add_f32 v[156:157], v[156:157], v[182:183]
    v_xor_b32 v124, s70, v124
    v_xor_b32 v125, s71, v125
    v_xor_b32 v126, s72, v126
    v_xor_b32 v127, s73, v127
    v_xor_b32 v184, v4, v184
    v_xor_b32 v185, v5, v185
    v_or3_b32 v2, v2, v124, v125
    v_or3_b32 v2, v2, v126, v127
    v_or3_b32 v3, v3, v184, v185
    v_pk_add_f32 v[32:33], v[32:33], v[124:125]
    v_pk_add_f32 v[34:35], v[34:35], v[126:127]
    v_pk_add_f32 v[156:157], v[156:157], v[184:185]
    v_xor_b32 v128, s70, v128
    v_xor_b32 v129, s71, v129
    v_xor_b32 v130, s72, v130
    v_xor_b32 v131, s73, v131
    v_xor_b32 v186, v4, v186
    v_xor_b32 v187, v5, v187
    v_or3_b32 v2, v2, v128, v129
    v_or3_b32 v2, v2, v130, v131
    v_or3_b32 v3, v3, v186, v187
    v_pk_add_f32 v[32:33], v[32:33], v[128:129]
    v_pk_add_f32 v[34:35], v[34:35], v[130:131]
    v_pk_add_f32 v[156:157], v[156:157], v[186:187]
    v_cndmask_b32 v3, 0, v3, vcc
    v_cvt_pk_bf16_f32 v32, v32, v33
    v_cvt_pk_bf16_f32 v33, v34, v35
    v_cvt_pk_bf16_f32 v156, v156, v157
    v_or_b32 v2, v2, v3
    ds_write_b64 v190, v[32:33]
    ds_write_b32 v191, v156
    v_and_b32 v2, 0xfff, v2
    v_cmp_ne_u32 vcc, 0, v2
    s_add_u32 s54, s54, 1
    s_cmp_ge_u32 s54, 0x40000
    s_cbranch_scc1 L_k1_ok
    s_nop 2
    s_cbranch_vccz L_k1_ok
    s_waitcnt lgkmcnt(0)
    s_mov_b32 s47, s53
    buffer_load_dwordx4 v[32:35], v188, s[32:35], s47 offen sc1
    buffer_load_dwordx2 v[156:157], v189, s[32:35], s47 offen sc1
    s_add_u32 s47, s47, 6144
    buffer_load_dwordx4 v[36:39], v188, s[32:35], s47 offen sc1
    buffer_load_dwordx2 v[158:159], v189, s[32:35], s47 offen sc1
    s_add_u32 s47, s47, 6144
    buffer_load_dwordx4 v[40:43], v188, s[32:35], s47 offen sc1
    buffer_load_dwordx2 v[160:161], v189, s[32:35], s47 offen sc1
    s_add_u32 s47, s47, 6144
    buffer_load_dwordx4 v[44:47], v188, s[32:35], s47 offen sc1
    buffer_load_dwordx2 v[162:163], v189, s[32:35], s47 offen sc1
    s_add_u32 s47, s47, 6144
    buffer_load_dwordx4 v[48:51], v188, s[32:35], s47 offen sc1
    buffer_load_dwordx2 v[164:165], v189, s[32:35], s47 offen sc1
    s_add_u32 s47, s47, 6144
    buffer_load_dwordx4 v[52:55], v188, s[32:35], s47 offen sc1
    buffer_load_dwordx2 v[166:167], v189, s[32:35], s47 offen sc1
    s_add_u32 s47, s47, 6144
    buffer_load_dwordx4 v[56:59], v188, s[32:35], s47 offen sc1
    buffer_load_dwordx2 v[168:169], v189, s[32:35], s47 offen sc1
    s_add_u32 s47, s47, 6144
    buffer_load_dwordx4 v[60:63], v188, s[32:35], s47 offen sc1
    buffer_load_dwordx2 v[170:171], v189, s[32:35], s47 offen sc1
    s_add_u32 s47, s47, 6144
    buffer_load_dwordx4 v[64:67], v188, s[32:35], s47 offen sc1
    buffer_load_dwordx2 v[172:173], v189, s[32:35], s47 offen sc1
    s_add_u32 s47, s47, 6144
    buffer_load_dwordx4 v[68:71], v188, s[32:35], s47 offen sc1
    buffer_load_dwordx2 v[174:175], v189, s[32:35], s47 offen sc1
    s_add_u32 s47, s47, 6144
    buffer_load_dwordx4 v[108:111], v188, s[32:35], s47 offen sc1
    buffer_load_dwordx2 v[176:177], v189, s[32:35], s47 offen sc1
    s_add_u32 s47, s47, 6144
    buffer_load_dwordx4 v[112:115], v188, s[32:35], s47 offen sc1
    buffer_load_dwordx2 v[178:179], v189, s[32:35], s47 offen sc1
    s_add_u32 s47, s47, 6144
    buffer_load_dwordx4 v[116:119], v188, s[32:35], s47 offen sc1
    buffer_load_dwordx2 v[180:181], v189, s[32:35], s47 offen sc1
    s_add_u32 s47, s47, 6144
    buffer_load_dwordx4 v[120:123], v188, s[32:35], s47 offen sc1
    buffer_load_dwordx2 v[182:183], v189, s[32:35], s47 offen sc1
    s_add_u32 s47, s47, 6144
    buffer_load_dwordx4 v[124:127], v188, s[32:35], s47 offen sc1
    buffer_load_dwordx2 v[184:185], v189, s[32:35], s47 offen sc1
    s_add_u32 s47, s47, 6144
    buffer_load_dwordx4 v[128:131], v188, s[32:35], s47 offen sc1
    buffer_load_dwordx2 v[186:187], v189, s[32:35], s47 offen sc1
    s_waitcnt vmcnt(0)
    s_branch L_k1_red
L_k1_ok:
    s_waitcnt lgkmcnt(0)
    s_barrier
    ds_read_b128 a[0:3], v192 offset:0
    ds_read_b128 a[4:7], v192 offset:16
    ds_read_b128 a[8:11], v192 offset:32
    ds_read_b128 a[12:15], v192 offset:48
    ds_read_b128 a[16:19], v192 offset:64
    ds_read_b128 a[20:23], v193 offset:0
    ds_read_b128 a[24:27], v193 offset:16
    ds_read_b128 a[28:31], v193 offset:32
    ds_read_b128 a[32:35], v193 offset:48
    ds_read_b128 a[36:39], v193 offset:64
    ds_read_b128 a[40:43], v194 offset:0
    ds_read_b128 a[44:47], v194 offset:16
    ds_read_b128 a[48:51], v194 offset:32
    ds_read_b128 a[52:55], v194 offset:48
    ds_read_b128 a[56:59], v194 offset:64
    s_waitcnt lgkmcnt(14)
    ds_read_b128 a[60:63], v195 offset:0
    s_waitcnt lgkmcnt(14)
    ds_read_b128 a[64:67], v195 offset:16
    s_waitcnt lgkmcnt(14)
    ds_read_b128 a[68:71], v195 offset:32
    s_waitcnt lgkmcnt(14)
    ds_read_b128 a[72:75], v195 offset:48
    s_waitcnt lgkmcnt(14)
    ds_read_b128 a[76:79], v195 offset:64
    s_waitcnt lgkmcnt(14)
    ds_read_b128 a[80:83], v196 offset:0
    s_waitcnt lgkmcnt(14)
    ds_read_b128 a[84:87], v196 offset:16
    s_waitcnt lgkmcnt(14)
    ds_read_b128 a[88:91], v196 offset:32
    s_waitcnt lgkmcnt(14)
    ds_read_b128 a[92:95], v196 offset:48
    s_waitcnt lgkmcnt(14)
    ds_read_b128 a[96:99], v196 offset:64
    s_waitcnt lgkmcnt(14)
    ds_read_b128 a[100:103], v197 offset:0
    s_waitcnt lgkmcnt(14)
    ds_read_b128 a[104:107], v197 offset:16
    s_waitcnt lgkmcnt(14)
    ds_read_b128 a[108:111], v197 offset:32
    s_waitcnt lgkmcnt(14)
    ds_read_b128 a[112:115], v197 offset:48
    s_waitcnt lgkmcnt(14)
    ds_read_b128 a[116:119], v197 offset:64
    v_and_b32 v6, 1, v23
    v_cmp_eq_u32 s[50:51], 0, v6
    v_mfma_f32_16x16x32_bf16 v[72:75], a[0:3], v[132:135], 0
    v_mfma_f32_16x16x32_bf16 v[72:75], a[4:7], v[136:139], v[72:75]
    v_mfma_f32_16x16x32_bf16 v[72:75], a[8:11], v[140:143], v[72:75]
    v_mfma_f32_16x16x32_bf16 v[72:75], a[12:15], v[144:147], v[72:75]
    v_mfma_f32_16x16x32_bf16 v[72:75], a[16:19], v[148:151], v[72:75]
    v_mfma_f32_16x16x32_bf16 v[76:79], a[20:23], v[132:135], 0
    v_mfma_f32_16x16x32_bf16 v[76:79], a[24:27], v[136:139], v[76:79]
    v_mfma_f32_16x16x32_bf16 v[76:79], a[28:31], v[140:143], v[76:79]
    v_mfma_f32_16x16x32_bf16 v[76:79], a[32:35], v[144:147], v[76:79]
    v_mfma_f32_16x16x32_bf16 v[76:79], a[36:39], v[148:151], v[76:79]
    v_mfma_f32_16x16x32_bf16 v[80:83], a[40:43], v[132:135], 0
    v_mfma_f32_16x16x32_bf16 v[80:83], a[44:47], v[136:139], v[80:83]
    v_mfma_f32_16x16x32_bf16 v[80:83], a[48:51], v[140:143], v[80:83]
    v_mfma_f32_16x16x32_bf16 v[80:83], a[52:55], v[144:147], v[80:83]
    v_mfma_f32_16x16x32_bf16 v[80:83], a[56:59], v[148:151], v[80:83]
    s_waitcnt lgkmcnt(10)
    v_mfma_f32_16x16x32_bf16 v[84:87], a[60:63], v[132:135], 0
    v_mfma_f32_16x16x32_bf16 v[84:87], a[64:67], v[136:139], v[84:87]
    v_mfma_f32_16x16x32_bf16 v[84:87], a[68:71], v[140:143], v[84:87]
    v_mfma_f32_16x16x32_bf16 v[84:87], a[72:75], v[144:147], v[84:87]
    v_mfma_f32_16x16x32_bf16 v[84:87], a[76:79], v[148:151], v[84:87]
    s_waitcnt lgkmcnt(5)
    v_mfma_f32_16x16x32_bf16 v[88:91], a[80:83], v[132:135], 0
    v_mfma_f32_16x16x32_bf16 v[88:91], a[84:87], v[136:139], v[88:91]
    v_mfma_f32_16x16x32_bf16 v[88:91], a[88:91], v[140:143], v[88:91]
    v_mfma_f32_16x16x32_bf16 v[88:91], a[92:95], v[144:147], v[88:91]
    v_mfma_f32_16x16x32_bf16 v[88:91], a[96:99], v[148:151], v[88:91]
    s_waitcnt lgkmcnt(0)
    v_mfma_f32_16x16x32_bf16 v[92:95], a[100:103], v[132:135], 0
    v_mfma_f32_16x16x32_bf16 v[92:95], a[104:107], v[136:139], v[92:95]
    v_mfma_f32_16x16x32_bf16 v[92:95], a[108:111], v[140:143], v[92:95]
    v_mfma_f32_16x16x32_bf16 v[92:95], a[112:115], v[144:147], v[92:95]
    v_mfma_f32_16x16x32_bf16 v[92:95], a[116:119], v[148:151], v[92:95]
    s_waitcnt vmcnt(22)
    v_accvgpr_read_b32 v2, a212
    v_accvgpr_read_b32 v3, a213
    v_add_f32 v72, 0x358637bd, v72
    v_add_f32 v73, 0x358637bd, v73
    s_mov_b32 s54, 0
L_f_gn:
    v_readfirstlane_b32 s100, v2
    v_readfirstlane_b32 s101, v3
    s_add_u32 s54, s54, 1
    s_cmp_lg_u32 s100, 0
    s_cbranch_scc1 L_f_gn_ok
    s_cmp_ge_u32 s54, 0x40000
    s_cbranch_scc1 L_f_gn_ok
    v_mov_b32 v5, 0
    buffer_load_dwordx2 v[2:3], v5, s[60:63], 0 offen sc1
    s_waitcnt vmcnt(0)
    s_branch L_f_gn
L_f_gn_ok:
    v_rcp_f32 v72, v72
    v_rcp_f32 v73, v73
    s_nop 0
    v_cndmask_b32 v74, v73, v72, s[50:51]
    v_mul_f32 v76, v72, v76
    v_mul_f32 v77, v72, v77
    v_mul_f32 v78, v72, v78
    v_mul_f32 v79, v72, v79
    v_cvt_pk_bf16_f32 v96, v76, v77
    v_cvt_pk_bf16_f32 v97, v78, v79
    buffer_store_dwordx2 v[96:97], v198, s[36:39], s22 offen offset:0 sc1
    v_mul_f32 v80, v72, v80
    v_mul_f32 v81, v72, v81
    v_mul_f32 v82, v72, v82
    v_mul_f32 v83, v72, v83
    v_cvt_pk_bf16_f32 v98, v80, v81
    v_cvt_pk_bf16_f32 v99, v82, v83
    buffer_store_dwordx2 v[98:99], v198, s[36:39], s22 offen offset:256 sc1
    v_mul_f32 v84, v74, v84
    v_mul_f32 v85, v74, v85
    v_mul_f32 v86, v73, v86
    v_mul_f32 v87, v73, v87
    v_cvt_pk_bf16_f32 v100, v84, v85
    v_cvt_pk_bf16_f32 v101, v86, v87
    buffer_store_dwordx2 v[100:101], v198, s[36:39], s22 offen offset:512 sc1
    v_mul_f32 v88, v73, v88
    v_mul_f32 v89, v73, v89
    v_mul_f32 v90, v73, v90
    v_mul_f32 v91, v73, v91
    v_cvt_pk_bf16_f32 v102, v88, v89
    v_cvt_pk_bf16_f32 v103, v90, v91
    buffer_store_dwordx2 v[102:103], v198, s[36:39], s22 offen offset:768 sc1
    v_mul_f32 v92, v73, v92
    v_mul_f32 v93, v73, v93
    v_mul_f32 v94, v73, v94
    v_mul_f32 v95, v73, v95
    v_cvt_pk_bf16_f32 v104, v92, v93
    v_cvt_pk_bf16_f32 v105, v94, v95
    buffer_store_dwordx2 v[104:105], v199, s[36:39], s22 offen offset:1024 sc1
    s_mov_b64 exec, -1
    s_mov_b32 s76, s68
    s_mov_b32 s77, s69
L_k1_last:
    s_load_dwordx4 s[4:7], s[0:1], 40
    s_lshl_b32 s75, s21, 7
    s_lshl_b32 s10, s10, 3
    s_add_u32 s75, s75, s10
    s_add_u32 s75, s75, 131072
    s_bfe_u32 s10, s2, 0x10003
    s_and_b32 s3, s2, 3
    s_lshl_b32 s3, s3, 1
    s_bfe_u32 s21, s2, 0x10004
    s_add_u32 s3, s3, s21
    s_lshr_b32 s11, s2, 5
    s_and_b32 s21, s2, 4
    s_lshl_b32 s21, s21, 1
    s_add_u32 s11, s11, s21
    s_mul_i32 s21, s10, 320
    s_lshl_b32 s22, s10, 5
    s_add_u32 s22, s22, 256
    s_sub_u32 s23, 320, s21
    s_sub_u32 s44, 544, s22
    s_mul_i32 s46, s20, 9216
    v_lshrrev_b32 v3, 3, v1
    v_and_b32 v4, 6, v3
    v_and_b32 v7, 7, v1
    v_xor_b32 v4, v4, v7
    v_lshlrev_b32 v4, 4, v4
    s_movk_i32 s47, 9216
    v_mul_lo_u32 v8, v3, s47
    v_add_u32 v8, v8, v4
    s_mul_i32 s48, s20, 72 * 9216
    v_add_u32 v16, s48, v8
    v_add_u32 v17, 0x12000, v16
    v_add_u32 v18, 0x24000, v16
    v_add_u32 v19, 0x36000, v16
    v_add_u32 v20, 0x48000, v16
    v_add_u32 v21, 0x5a000, v16
    v_add_u32 v22, 0x6c000, v16
    v_add_u32 v23, 0x7e000, v16
    v_add_u32 v24, 0x90000, v16
    v_lshlrev_b32 v81, 4, v1
    s_mul_i32 s49, s3, 1152
    s_lshl_b32 s50, s21, 1
    s_add_u32 s50, s50, s49
    s_lshl_b32 s54, s11, 3
    s_lshl_b32 s55, s20, 1
    s_add_u32 s54, s54, s55
    s_mul_i32 s55, s54, 18432
    s_add_u32 s56, s55, 18432
    s_waitcnt lgkmcnt(0)
    s_mov_b32 s12, s4
    s_mov_b32 s13, s5
    s_mov_b32 s14, 0x510000
    s_mov_b32 s15, 0x20000
    s_add_u32 s24, s8, 0x240000
    s_addc_u32 s25, s9, 0
    s_mov_b32 s26, 0x240000
    s_mov_b32 s27, 0x20000
    s_add_u32 s28, s8, 0x480000
    s_addc_u32 s29, s9, 0
    s_mov_b32 s30, 0x28000
    s_mov_b32 s31, 0x20000
    s_add_u32 s32, s8, 0x4b0000
    s_addc_u32 s33, s9, 0
    s_mov_b32 s34, 0xd800
    s_mov_b32 s35, 0x20000
    v_add_u32 v116, 4096, v81
    v_add_u32 v117, 8192, v81
    v_add_u32 v118, 12288, v81
    v_add_u32 v119, 16384, v81
    v_add_u32 v124, 20480, v81
    v_add_u32 v125, 24576, v81
    s_add_u32 s60, s8, 0x640000
    s_addc_u32 s61, s9, 0
    s_mov_b32 s62, 0x28000
    s_mov_b32 s63, 0x20000
    v_mov_b32 v82, 0
    v_mov_b32 v84, s100
    v_mov_b32 v85, s101
    s_waitcnt vmcnt(0)
    buffer_store_dwordx2 v[84:85], v82, s[60:63], s75 offen sc1
    s_mov_b32 s16, s6
    s_mov_b32 s17, s7
    s_mov_b32 s18, 0x510000
    s_mov_b32 s19, 0x20000
    v_mov_b32 v14, v3
    v_mov_b32 v15, v4
    s_lshr_b32 s58, s2, 3
    s_cmp_ge_u32 s58, 18
    s_cbranch_scc0 L_f_role
    s_barrier
    s_lshr_b32 s58, s2, 3
    s_sub_u32 s58, s58, 18
    s_lshl_b32 s58, s58, 3
    s_and_b32 s59, s2, 7
    s_add_u32 s58, s58, s59
    v_lshrrev_b32 v2, 3, v1
    v_and_b32 v3, 7, v1
    s_movk_i32 s59, 9216
    v_mul_lo_u32 v2, v2, s59
    v_lshl_add_u32 v2, v3, 4, v2
    s_add_u32 s59, s58, 0
    s_mul_hi_u32 s64, s59, 0x038e38e4
    s_mul_i32 s65, s64, 72
    s_sub_u32 s65, s59, s65
    s_mul_i32 s74, s64, 18432
    s_lshl_b32 s75, s65, 8
    s_add_u32 s76, s74, s75
    s_mul_i32 s64, s64, 192
    s_mul_i32 s74, s20, 48
    s_add_u32 s64, s64, s74
    s_mul_i32 s64, s64, 9216
    s_lshl_b32 s65, s65, 7
    s_add_u32 s64, s64, s65
    s_add_u32 s65, s64, 0
    buffer_load_dwordx4 v[128:131], v2, s[12:15], s65 offen
    s_add_u32 s65, s64, 73728
    buffer_load_dwordx4 v[132:135], v2, s[12:15], s65 offen
    s_add_u32 s65, s64, 147456
    buffer_load_dwordx4 v[136:139], v2, s[12:15], s65 offen
    s_add_u32 s65, s64, 221184
    buffer_load_dwordx4 v[140:143], v2, s[12:15], s65 offen
    s_add_u32 s65, s64, 294912
    buffer_load_dwordx4 v[144:147], v2, s[12:15], s65 offen
    s_add_u32 s65, s64, 368640
    buffer_load_dwordx4 v[148:151], v2, s[12:15], s65 offen
    s_add_u32 s59, s58, 112
    s_mul_hi_u32 s64, s59, 0x038e38e4
    s_mul_i32 s65, s64, 72
    s_sub_u32 s65, s59, s65
    s_mul_i32 s74, s64, 18432
    s_lshl_b32 s75, s65, 8
    s_add_u32 s77, s74, s75
    s_mul_i32 s64, s64, 192
    s_mul_i32 s74, s20, 48
    s_add_u32 s64, s64, s74
    s_mul_i32 s64, s64, 9216
    s_lshl_b32 s65, s65, 7
    s_add_u32 s64, s64, s65
    s_add_u32 s65, s64, 0
    buffer_load_dwordx4 v[152:155], v2, s[12:15], s65 offen
    s_add_u32 s65, s64, 73728
    buffer_load_dwordx4 v[156:159], v2, s[12:15], s65 offen
    s_add_u32 s65, s64, 147456
    buffer_load_dwordx4 v[160:163], v2, s[12:15], s65 offen
    s_add_u32 s65, s64, 221184
    buffer_load_dwordx4 v[164:167], v2, s[12:15], s65 offen
    s_add_u32 s65, s64, 294912
    buffer_load_dwordx4 v[168:171], v2, s[12:15], s65 offen
    s_add_u32 s65, s64, 368640
    buffer_load_dwordx4 v[172:175], v2, s[12:15], s65 offen
    s_mov_b32 s45, s58
    s_add_u32 s57, s50, 0x0
    s_add_u32 m0, s46, 0
    s_nop 0
    buffer_load_dwordx4 v16, s[12:15], s57 offen lds
    s_add_u32 m0, s46, 1024
    s_nop 0
    buffer_load_dwordx4 v17, s[12:15], s57 offen lds
    s_add_u32 m0, s46, 2048
    s_nop 0
    buffer_load_dwordx4 v18, s[12:15], s57 offen lds
    s_add_u32 m0, s46, 3072
    s_nop 0
    buffer_load_dwordx4 v19, s[12:15], s57 offen lds
    s_add_u32 m0, s46, 4096
    s_nop 0
    buffer_load_dwordx4 v20, s[12:15], s57 offen lds
    s_add_u32 m0, s46, 5120
    s_nop 0
    buffer_load_dwordx4 v21, s[12:15], s57 offen lds
    s_add_u32 m0, s46, 6144
    s_nop 0
    buffer_load_dwordx4 v22, s[12:15], s57 offen lds
    s_add_u32 m0, s46, 7168
    s_nop 0
    buffer_load_dwordx4 v23, s[12:15], s57 offen lds
    s_add_u32 m0, s46, 8192
    s_nop 0
    buffer_load_dwordx4 v24, s[12:15], s57 offen lds
    s_add_u32 s73, s50, 0x288000
    s_add_u32 m0, s46, 36864
    s_nop 0
    buffer_load_dwordx4 v16, s[12:15], s73 offen lds
    s_add_u32 m0, s46, 37888
    s_nop 0
    buffer_load_dwordx4 v17, s[12:15], s73 offen lds
    s_add_u32 m0, s46, 38912
    s_nop 0
    buffer_load_dwordx4 v18, s[12:15], s73 offen lds
    s_add_u32 m0, s46, 39936
    s_nop 0
    buffer_load_dwordx4 v19, s[12:15], s73 offen lds
    s_add_u32 m0, s46, 40960
    s_nop 0
    buffer_load_dwordx4 v20, s[12:15], s73 offen lds
    s_add_u32 m0, s46, 41984
    s_nop 0
    buffer_load_dwordx4 v21, s[12:15], s73 offen lds
    s_add_u32 m0, s46, 43008
    s_nop 0
    buffer_load_dwordx4 v22, s[12:15], s73 offen lds
    s_add_u32 m0, s46, 44032
    s_nop 0
    buffer_load_dwordx4 v23, s[12:15], s73 offen lds
    s_add_u32 m0, s46, 45056
    s_nop 0
    buffer_load_dwordx4 v24, s[12:15], s73 offen lds
    s_mov_b32 s58, 0x00003f80
    s_mov_b32 s59, 0x3f800000
    v_mov_b32 v192, 0
    v_mov_b32 v193, 0
    v_mov_b32 v194, 0
    v_mov_b32 v195, 0
    v_mov_b32 v196, 0
    v_mov_b32 v197, 0
    v_mov_b32 v198, 0
    v_mov_b32 v199, 0
    v_mov_b32 v200, 0
    v_mov_b32 v201, 0
    v_mov_b32 v202, 0
    v_mov_b32 v203, 0
    v_mov_b32 v204, 0
    v_mov_b32 v205, 0
    v_mov_b32 v206, 0
    v_mov_b32 v207, 0
    s_waitcnt vmcnt(24)
    v_dot2c_f32_bf16 v192, s58, v128
    v_dot2c_f32_bf16 v193, s59, v128
    v_dot2c_f32_bf16 v194, s58, v129
    v_dot2c_f32_bf16 v195, s59, v129
    v_dot2c_f32_bf16 v196, s58, v130
    v_dot2c_f32_bf16 v197, s59, v130
    v_dot2c_f32_bf16 v198, s58, v131
    v_dot2c_f32_bf16 v199, s59, v131
    v_dot2c_f32_bf16 v192, s58, v132
    v_dot2c_f32_bf16 v193, s59, v132
    v_dot2c_f32_bf16 v194, s58, v133
    v_dot2c_f32_bf16 v195, s59, v133
    v_dot2c_f32_bf16 v196, s58, v134
    v_dot2c_f32_bf16 v197, s59, v134
    v_dot2c_f32_bf16 v198, s58, v135
    v_dot2c_f32_bf16 v199, s59, v135
    v_dot2c_f32_bf16 v192, s58, v136
    v_dot2c_f32_bf16 v193, s59, v136
    v_dot2c_f32_bf16 v194, s58, v137
    v_dot2c_f32_bf16 v195, s59, v137
    v_dot2c_f32_bf16 v196, s58, v138
    v_dot2c_f32_bf16 v197, s59, v138
    v_dot2c_f32_bf16 v198, s58, v139
    v_dot2c_f32_bf16 v199, s59, v139
    v_dot2c_f32_bf16 v192, s58, v140
    v_dot2c_f32_bf16 v193, s59, v140
    v_dot2c_f32_bf16 v194, s58, v141
    v_dot2c_f32_bf16 v195, s59, v141
    v_dot2c_f32_bf16 v196, s58, v142
    v_dot2c_f32_bf16 v197, s59, v142
    v_dot2c_f32_bf16 v198, s58, v143
    v_dot2c_f32_bf16 v199, s59, v143
    v_dot2c_f32_bf16 v192, s58, v144
    v_dot2c_f32_bf16 v193, s59, v144
    v_dot2c_f32_bf16 v194, s58, v145
    v_dot2c_f32_bf16 v195, s59, v145
    v_dot2c_f32_bf16 v196, s58, v146
    v_dot2c_f32_bf16 v197, s59, v146
    v_dot2c_f32_bf16 v198, s58, v147
    v_dot2c_f32_bf16 v199, s59, v147
    v_dot2c_f32_bf16 v192, s58, v148
    v_dot2c_f32_bf16 v193, s59, v148
    v_dot2c_f32_bf16 v194, s58, v149
    v_dot2c_f32_bf16 v195, s59, v149
    v_dot2c_f32_bf16 v196, s58, v150
    v_dot2c_f32_bf16 v197, s59, v150
    v_dot2c_f32_bf16 v198, s58, v151
    v_dot2c_f32_bf16 v199, s59, v151
    s_waitcnt vmcnt(18)
    v_dot2c_f32_bf16 v200, s58, v152
    v_dot2c_f32_bf16 v201, s59, v152
    v_dot2c_f32_bf16 v202, s58, v153
    v_dot2c_f32_bf16 v203, s59, v153
    v_dot2c_f32_bf16 v204, s58, v154
    v_dot2c_f32_bf16 v205, s59, v154
    v_dot2c_f32_bf16 v206, s58, v155
    v_dot2c_f32_bf16 v207, s59, v155
    v_dot2c_f32_bf16 v200, s58, v156
    v_dot2c_f32_bf16 v201, s59, v156
    v_dot2c_f32_bf16 v202, s58, v157
    v_dot2c_f32_bf16 v203, s59, v157
    v_dot2c_f32_bf16 v204, s58, v158
    v_dot2c_f32_bf16 v205, s59, v158
    v_dot2c_f32_bf16 v206, s58, v159
    v_dot2c_f32_bf16 v207, s59, v159
    v_dot2c_f32_bf16 v200, s58, v160
    v_dot2c_f32_bf16 v201, s59, v160
    v_dot2c_f32_bf16 v202, s58, v161
    v_dot2c_f32_bf16 v203, s59, v161
    v_dot2c_f32_bf16 v204, s58, v162
    v_dot2c_f32_bf16 v205, s59, v162
    v_dot2c_f32_bf16 v206, s58, v163
    v_dot2c_f32_bf16 v207, s59, v163
    v_dot2c_f32_bf16 v200, s58, v164
    v_dot2c_f32_bf16 v201, s59, v164
    v_dot2c_f32_bf16 v202, s58, v165
    v_dot2c_f32_bf16 v203, s59, v165
    v_dot2c_f32_bf16 v204, s58, v166
    v_dot2c_f32_bf16 v205, s59, v166
    v_dot2c_f32_bf16 v206, s58, v167
    v_dot2c_f32_bf16 v207, s59, v167
    v_dot2c_f32_bf16 v200, s58, v168
    v_dot2c_f32_bf16 v201, s59, v168
    v_dot2c_f32_bf16 v202, s58, v169
    v_dot2c_f32_bf16 v203, s59, v169
    v_dot2c_f32_bf16 v204, s58, v170
    v_dot2c_f32_bf16 v205, s59, v170
    v_dot2c_f32_bf16 v206, s58, v171
    v_dot2c_f32_bf16 v207, s59, v171
    v_dot2c_f32_bf16 v200, s58, v172
    v_dot2c_f32_bf16 v201, s59, v172
    v_dot2c_f32_bf16 v202, s58, v173
    v_dot2c_f32_bf16 v203, s59, v173
    v_dot2c_f32_bf16 v204, s58, v174
    v_dot2c_f32_bf16 v205, s59, v174
    v_dot2c_f32_bf16 v206, s58, v175
    v_dot2c_f32_bf16 v207, s59, v175
    s_nop 2
    v_add_f32_dpp v192, v192, v192 row_ror:8 row_mask:0xf bank_mask:0xf
    v_add_f32_dpp v193, v193, v193 row_ror:8 row_mask:0xf bank_mask:0xf
    v_add_f32_dpp v194, v194, v194 row_ror:8 row_mask:0xf bank_mask:0xf
    v_add_f32_dpp v195, v195, v195 row_ror:8 row_mask:0xf bank_mask:0xf
    v_add_f32_dpp v196, v196, v196 row_ror:8 row_mask:0xf bank_mask:0xf
    v_add_f32_dpp v197, v197, v197 row_ror:8 row_mask:0xf bank_mask:0xf
    v_add_f32_dpp v198, v198, v198 row_ror:8 row_mask:0xf bank_mask:0xf
    v_add_f32_dpp v199, v199, v199 row_ror:8 row_mask:0xf bank_mask:0xf
    v_add_f32_dpp v200, v200, v200 row_ror:8 row_mask:0xf bank_mask:0xf
    v_add_f32_dpp v201, v201, v201 row_ror:8 row_mask:0xf bank_mask:0xf
    v_add_f32_dpp v202, v202, v202 row_ror:8 row_mask:0xf bank_mask:0xf
    v_add_f32_dpp v203, v203, v203 row_ror:8 row_mask:0xf bank_mask:0xf
    v_add_f32_dpp v204, v204, v204 row_ror:8 row_mask:0xf bank_mask:0xf
    v_add_f32_dpp v205, v205, v205 row_ror:8 row_mask:0xf bank_mask:0xf
    v_add_f32_dpp v206, v206, v206 row_ror:8 row_mask:0xf bank_mask:0xf
    v_add_f32_dpp v207, v207, v207 row_ror:8 row_mask:0xf bank_mask:0xf
    v_mov_b32 v208, v192
    v_mov_b32 v209, v193
    v_mov_b32 v210, v194
    v_mov_b32 v211, v195
    v_mov_b32 v212, v196
    v_mov_b32 v213, v197
    v_mov_b32 v214, v198
    v_mov_b32 v215, v199
    v_mov_b32 v216, v200
    v_mov_b32 v217, v201
    v_mov_b32 v218, v202
    v_mov_b32 v219, v203
    v_mov_b32 v220, v204
    v_mov_b32 v221, v205
    v_mov_b32 v222, v206
    v_mov_b32 v223, v207
    v_permlane32_swap_b32 v192, v208
    v_permlane32_swap_b32 v193, v209
    v_permlane32_swap_b32 v194, v210
    v_permlane32_swap_b32 v195, v211
    v_permlane32_swap_b32 v196, v212
    v_permlane32_swap_b32 v197, v213
    v_permlane32_swap_b32 v198, v214
    v_permlane32_swap_b32 v199, v215
    v_permlane32_swap_b32 v200, v216
    v_permlane32_swap_b32 v201, v217
    v_permlane32_swap_b32 v202, v218
    v_permlane32_swap_b32 v203, v219
    v_permlane32_swap_b32 v204, v220
    v_permlane32_swap_b32 v205, v221
    v_permlane32_swap_b32 v206, v222
    v_permlane32_swap_b32 v207, v223
    v_add_f32 v192, v192, v208
    v_add_f32 v193, v193, v209
    v_add_f32 v194, v194, v210
    v_add_f32 v195, v195, v211
    v_add_f32 v196, v196, v212
    v_add_f32 v197, v197, v213
    v_add_f32 v198, v198, v214
    v_add_f32 v199, v199, v215
    v_add_f32 v200, v200, v216
    v_add_f32 v201, v201, v217
    v_add_f32 v202, v202, v218
    v_add_f32 v203, v203, v219
    v_add_f32 v204, v204, v220
    v_add_f32 v205, v205, v221
    v_add_f32 v206, v206, v222
    v_add_f32 v207, v207, v223
    v_mov_b32 v208, v192
    v_mov_b32 v209, v193
    v_mov_b32 v210, v194
    v_mov_b32 v211, v195
    v_mov_b32 v212, v196
    v_mov_b32 v213, v197
    v_mov_b32 v214, v198
    v_mov_b32 v215, v199
    v_mov_b32 v216, v200
    v_mov_b32 v217, v201
    v_mov_b32 v218, v202
    v_mov_b32 v219, v203
    v_mov_b32 v220, v204
    v_mov_b32 v221, v205
    v_mov_b32 v222, v206
    v_mov_b32 v223, v207
    v_permlane16_swap_b32 v192, v208
    v_permlane16_swap_b32 v193, v209
    v_permlane16_swap_b32 v194, v210
    v_permlane16_swap_b32 v195, v211
    v_permlane16_swap_b32 v196, v212
    v_permlane16_swap_b32 v197, v213
    v_permlane16_swap_b32 v198, v214
    v_permlane16_swap_b32 v199, v215
    v_permlane16_swap_b32 v200, v216
    v_permlane16_swap_b32 v201, v217
    v_permlane16_swap_b32 v202, v218
    v_permlane16_swap_b32 v203, v219
    v_permlane16_swap_b32 v204, v220
    v_permlane16_swap_b32 v205, v221
    v_permlane16_swap_b32 v206, v222
    v_permlane16_swap_b32 v207, v223
    v_add_f32 v192, v192, v208
    v_add_f32 v193, v193, v209
    v_add_f32 v194, v194, v210
    v_add_f32 v195, v195, v211
    v_add_f32 v196, v196, v212
    v_add_f32 v197, v197, v213
    v_add_f32 v198, v198, v214
    v_add_f32 v199, v199, v215
    v_add_f32 v200, v200, v216
    v_add_f32 v201, v201, v217
    v_add_f32 v202, v202, v218
    v_add_f32 v203, v203, v219
    v_add_f32 v204, v204, v220
    v_add_f32 v205, v205, v221
    v_add_f32 v206, v206, v222
    v_add_f32 v207, v207, v223
    v_lshlrev_b32 v2, 5, v3
    s_lshl_b32 s64, s20, 9
    s_add_u32 s64, s64, 151552
    v_add_u32 v2, s64, v2
    ds_write_b128 v2, v[192:195] offset:0
    ds_write_b128 v2, v[196:199] offset:16
    ds_write_b128 v2, v[200:203] offset:256
    ds_write_b128 v2, v[204:207] offset:272
    s_waitcnt lgkmcnt(0)
    s_barrier
    v_lshlrev_b32 v4, 2, v1
    s_and_b32 s64, s20, 1
    s_lshl_b32 s65, s64, 8
    s_add_u32 s65, s65, 151552
    v_add_u32 v2, s65, v4
    ds_read_b32 v128, v2 offset:0
    ds_read_b32 v129, v2 offset:512
    ds_read_b32 v130, v2 offset:1024
    ds_read_b32 v131, v2 offset:1536
    s_cmp_eq_u32 s64, 0
    s_cselect_b32 s65, s76, s77
    s_cmp_lt_u32 s20, 2
    s_cselect_b32 s65, s65, 0x7fff0000
    v_and_b32 v5, 3, v1
    v_mul_u32_u24 v5, 12, v5
    v_lshrrev_b64 v[6:7], v5, s[100:101]
    v_mov_b32 v7, 0xfff
    s_waitcnt lgkmcnt(0)
    v_add_f32 v128, v128, v129
    v_add_f32 v128, v128, v130
    v_add_f32 v128, v128, v131
    v_bfi_b32 v128, v7, v6, v128
    buffer_store_dword v128, v4, s[32:35], s65 offen sc1
    v_lshlrev_b32 v4, 20, v1
    v_min_u32 v4, 0x2affffc, v4
    global_load_dword v226, v4, s[8:9]
    s_branch L_f_norole
L_f_role:
    s_add_u32 s4, s8, 0x0
    s_addc_u32 s5, s9, 0
    s_mov_b32 s6, 0x240000
    s_mov_b32 s7, 0x20000
    v_lshrrev_b32 v2, 4, v1
    v_bfe_u32 v3, v1, 2, 2
    v_lshl_add_u32 v4, v2, 3, v3
    v_lshlrev_b32 v4, 7, v4
    v_lshrrev_b32 v5, 1, v3
    v_and_b32 v6, 1, v2
    v_lshl_or_b32 v5, v6, 1, v5
    v_lshl_add_u32 v4, v5, 5, v4
    v_and_b32 v5, 3, v1
    v_lshl_add_u32 v4, v5, 3, v4
    v_xor_b32 v5, 0, v4
    v_add_u32 v160, 73728, v5
    v_add_u32 v164, 110592, v5
    v_xor_b32 v5, 32, v4
    v_add_u32 v161, 73728, v5
    v_add_u32 v165, 110592, v5
    v_xor_b32 v5, 64, v4
    v_add_u32 v162, 73728, v5
    v_add_u32 v166, 110592, v5
    v_xor_b32 v5, 96, v4
    v_add_u32 v163, 73728, v5
    v_add_u32 v167, 110592, v5
    v_and_b32 v5, 15, v1
    v_lshrrev_b32 v7, 1, v5
    v_lshrrev_b32 v4, 5, v1
    v_xor_b32 v7, v7, v4
    v_lshlrev_b32 v7, 4, v7
    v_lshl_add_u32 v7, v5, 7, v7
    v_lshl_add_u32 v7, v6, 3, v7
    s_lshl_b32 s58, s20, 12
    s_add_u32 s58, s58, 147456
    v_add_u32 v168, s58, v7
    v_xor_b32 v169, 32, v168
    v_xor_b32 v170, 64, v168
    v_xor_b32 v171, 96, v168
    v_lshlrev_b32 v228, 3, v5
    s_mul_i32 s58, s76, 36864
    s_add_u32 s59, s58, 18432
    s_lshl_b32 s64, s76, 7
    s_add_u32 s65, s64, 131072
    v_min_u32 v190, 15, v1
    v_lshlrev_b32 v190, 3, v190
    s_mov_b32 s74, 0
L_f_o_spin:
    buffer_load_dwordx2 v[188:189], v190, s[60:63], s65 offen sc1
    s_add_u32 s74, s74, 1
    s_waitcnt vmcnt(0)
    v_xor_b32 v188, v188, v84
    v_xor_b32 v189, v189, v85
    v_or_b32 v188, v188, v189
    v_cmp_ne_u32 vcc, 0, v188
    s_cmp_ge_u32 s74, 0x40000
    s_cbranch_scc1 L_f_o_go
    s_nop 3
    s_cbranch_vccz L_f_o_go
    s_sleep 1
    s_branch L_f_o_spin
L_f_o_go:
    buffer_load_dwordx4 a[0:3], v81, s[4:7], s58 offen offset:0 sc1
    buffer_load_dwordx4 a[72:75], v81, s[4:7], s59 offen offset:0 sc1
    buffer_load_dwordx4 a[4:7], v81, s[4:7], s58 offen offset:1024 sc1
    buffer_load_dwordx4 a[76:79], v81, s[4:7], s59 offen offset:1024 sc1
    buffer_load_dwordx4 a[8:11], v81, s[4:7], s58 offen offset:2048 sc1
    buffer_load_dwordx4 a[80:83], v81, s[4:7], s59 offen offset:2048 sc1
    buffer_load_dwordx4 a[12:15], v81, s[4:7], s58 offen offset:3072 sc1
    buffer_load_dwordx4 a[84:87], v81, s[4:7], s59 offen offset:3072 sc1
    buffer_load_dwordx4 a[16:19], v116, s[4:7], s58 offen offset:0 sc1
    buffer_load_dwordx4 a[88:91], v116, s[4:7], s59 offen offset:0 sc1
    buffer_load_dwordx4 a[20:23], v116, s[4:7], s58 offen offset:1024 sc1
    buffer_load_dwordx4 a[92:95], v116, s[4:7], s59 offen offset:1024 sc1
    buffer_load_dwordx4 a[24:27], v116, s[4:7], s58 offen offset:2048 sc1
    buffer_load_dwordx4 a[96:99], v116, s[4:7], s59 offen offset:2048 sc1
    buffer_load_dwordx4 a[28:31], v116, s[4:7], s58 offen offset:3072 sc1
    buffer_load_dwordx4 a[100:103], v116, s[4:7], s59 offen offset:3072 sc1
    buffer_load_dwordx4 a[32:35], v117, s[4:7], s58 offen offset:0 sc1
    buffer_load_dwordx4 a[104:107], v117, s[4:7], s59 offen offset:0 sc1
    buffer_load_dwordx4 a[36:39], v117, s[4:7], s58 offen offset:1024 sc1
    buffer_load_dwordx4 a[108:111], v117, s[4:7], s59 offen offset:1024 sc1
    buffer_load_dwordx4 a[40:43], v117, s[4:7], s58 offen offset:2048 sc1
    buffer_load_dwordx4 a[112:115], v117, s[4:7], s59 offen offset:2048 sc1
    buffer_load_dwordx4 a[44:47], v117, s[4:7], s58 offen offset:3072 sc1
    buffer_load_dwordx4 a[116:119], v117, s[4:7], s59 offen offset:3072 sc1
    buffer_load_dwordx4 a[48:51], v118, s[4:7], s58 offen offset:0 sc1
    buffer_load_dwordx4 a[120:123], v118, s[4:7], s59 offen offset:0 sc1
    buffer_load_dwordx4 a[52:55], v118, s[4:7], s58 offen offset:1024 sc1
    buffer_load_dwordx4 a[124:127], v118, s[4:7], s59 offen offset:1024 sc1
    buffer_load_dwordx4 a[56:59], v118, s[4:7], s58 offen offset:2048 sc1
    buffer_load_dwordx4 a[128:131], v118, s[4:7], s59 offen offset:2048 sc1
    buffer_load_dwordx4 a[60:63], v118, s[4:7], s58 offen offset:3072 sc1
    buffer_load_dwordx4 a[132:135], v118, s[4:7], s59 offen offset:3072 sc1
    buffer_load_dwordx4 a[64:67], v119, s[4:7], s58 offen offset:0 sc1
    buffer_load_dwordx4 a[136:139], v119, s[4:7], s59 offen offset:0 sc1
    buffer_load_dwordx4 a[68:71], v119, s[4:7], s58 offen offset:1024 sc1
    buffer_load_dwordx4 a[140:143], v119, s[4:7], s59 offen offset:1024 sc1
    s_barrier
    ds_read_b64 v[172:173], v168 offset:0
    ds_read_b64 v[174:175], v169 offset:0
    ds_read_b64 v[176:177], v170 offset:0
    ds_read_b64 v[178:179], v171 offset:0
    ds_read_b64 v[180:181], v168 offset:2048
    ds_read_b64 v[182:183], v169 offset:2048
    ds_read_b64 v[184:185], v170 offset:2048
    ds_read_b64 v[186:187], v171 offset:2048
    s_waitcnt lgkmcnt(0)
    ds_read_b64_tr_b16 a[216:217], v160 offset:0
    ds_read_b64_tr_b16 a[218:219], v160 offset:512
    ds_read_b64_tr_b16 a[220:221], v161 offset:0
    ds_read_b64_tr_b16 a[222:223], v161 offset:512
    ds_read_b64_tr_b16 a[224:225], v162 offset:0
    ds_read_b64_tr_b16 a[226:227], v162 offset:512
    ds_read_b64_tr_b16 a[228:229], v163 offset:0
    ds_read_b64_tr_b16 a[230:231], v163 offset:512
    ds_read_b64_tr_b16 a[232:233], v160 offset:4096
    ds_read_b64_tr_b16 a[234:235], v160 offset:4608
    s_waitcnt vmcnt(34)
    s_waitcnt lgkmcnt(6)
    v_mfma_f32_16x16x32_bf16 v[128:131], a[216:219], a[0:3], 0
    ds_read_b64_tr_b16 a[236:237], v161 offset:4096
    v_mfma_f32_16x16x32_bf16 v[132:135], a[216:219], a[72:75], 0
    ds_read_b64_tr_b16 a[238:239], v161 offset:4608
    v_mfma_f32_16x16x32_bf16 v[136:139], a[220:223], a[0:3], 0
    ds_read_b64_tr_b16 a[216:217], v162 offset:4096
    v_mfma_f32_16x16x32_bf16 v[140:143], a[220:223], a[72:75], 0
    ds_read_b64_tr_b16 a[218:219], v162 offset:4608
    s_waitcnt lgkmcnt(6)
    v_mfma_f32_16x16x32_bf16 v[144:147], a[224:227], a[0:3], 0
    ds_read_b64_tr_b16 a[220:221], v163 offset:4096
    v_mfma_f32_16x16x32_bf16 v[148:151], a[224:227], a[72:75], 0
    ds_read_b64_tr_b16 a[222:223], v163 offset:4608
    v_mfma_f32_16x16x32_bf16 v[152:155], a[228:231], a[0:3], 0
    ds_read_b64_tr_b16 a[224:225], v160 offset:8192
    v_mfma_f32_16x16x32_bf16 v[156:159], a[228:231], a[72:75], 0
    ds_read_b64_tr_b16 a[226:227], v160 offset:8704
    s_waitcnt vmcnt(32)
    s_waitcnt lgkmcnt(6)
    v_mfma_f32_16x16x32_bf16 v[128:131], a[232:235], a[4:7], v[128:131]
    ds_read_b64_tr_b16 a[228:229], v161 offset:8192
    v_mfma_f32_16x16x32_bf16 v[132:135], a[232:235], a[76:79], v[132:135]
    ds_read_b64_tr_b16 a[230:231], v161 offset:8704
    v_mfma_f32_16x16x32_bf16 v[136:139], a[236:239], a[4:7], v[136:139]
    ds_read_b64_tr_b16 a[232:233], v162 offset:8192
    v_mfma_f32_16x16x32_bf16 v[140:143], a[236:239], a[76:79], v[140:143]
    ds_read_b64_tr_b16 a[234:235], v162 offset:8704
    s_waitcnt lgkmcnt(6)
    v_mfma_f32_16x16x32_bf16 v[144:147], a[216:219], a[4:7], v[144:147]
    ds_read_b64_tr_b16 a[236:237], v163 offset:8192
    v_mfma_f32_16x16x32_bf16 v[148:151], a[216:219], a[76:79], v[148:151]
    ds_read_b64_tr_b16 a[238:239], v163 offset:8704
    v_mfma_f32_16x16x32_bf16 v[152:155], a[220:223], a[4:7], v[152:155]
    ds_read_b64_tr_b16 a[216:217], v160 offset:12288
    v_mfma_f32_16x16x32_bf16 v[156:159], a[220:223], a[76:79], v[156:159]
    ds_read_b64_tr_b16 a[218:219], v160 offset:12800
    s_waitcnt vmcnt(30)
    s_waitcnt lgkmcnt(6)
    v_mfma_f32_16x16x32_bf16 v[128:131], a[224:227], a[8:11], v[128:131]
    ds_read_b64_tr_b16 a[220:221], v161 offset:12288
    v_mfma_f32_16x16x32_bf16 v[132:135], a[224:227], a[80:83], v[132:135]
    ds_read_b64_tr_b16 a[222:223], v161 offset:12800
    v_mfma_f32_16x16x32_bf16 v[136:139], a[228:231], a[8:11], v[136:139]
    ds_read_b64_tr_b16 a[224:225], v162 offset:12288
    v_mfma_f32_16x16x32_bf16 v[140:143], a[228:231], a[80:83], v[140:143]
    ds_read_b64_tr_b16 a[226:227], v162 offset:12800
    s_waitcnt lgkmcnt(6)
    v_mfma_f32_16x16x32_bf16 v[144:147], a[232:235], a[8:11], v[144:147]
    ds_read_b64_tr_b16 a[228:229], v163 offset:12288
    v_mfma_f32_16x16x32_bf16 v[148:151], a[232:235], a[80:83], v[148:151]
    ds_read_b64_tr_b16 a[230:231], v163 offset:12800
    v_mfma_f32_16x16x32_bf16 v[152:155], a[236:239], a[8:11], v[152:155]
    ds_read_b64_tr_b16 a[232:233], v160 offset:16384
    v_mfma_f32_16x16x32_bf16 v[156:159], a[236:239], a[80:83], v[156:159]
    ds_read_b64_tr_b16 a[234:235], v160 offset:16896
    s_waitcnt vmcnt(28)
    s_waitcnt lgkmcnt(6)
    v_mfma_f32_16x16x32_bf16 v[128:131], a[216:219], a[12:15], v[128:131]
    ds_read_b64_tr_b16 a[236:237], v161 offset:16384
    v_mfma_f32_16x16x32_bf16 v[132:135], a[216:219], a[84:87], v[132:135]
    ds_read_b64_tr_b16 a[238:239], v161 offset:16896
    v_mfma_f32_16x16x32_bf16 v[136:139], a[220:223], a[12:15], v[136:139]
    ds_read_b64_tr_b16 a[216:217], v162 offset:16384
    v_mfma_f32_16x16x32_bf16 v[140:143], a[220:223], a[84:87], v[140:143]
    ds_read_b64_tr_b16 a[218:219], v162 offset:16896
    s_waitcnt lgkmcnt(6)
    v_mfma_f32_16x16x32_bf16 v[144:147], a[224:227], a[12:15], v[144:147]
    ds_read_b64_tr_b16 a[220:221], v163 offset:16384
    v_mfma_f32_16x16x32_bf16 v[148:151], a[224:227], a[84:87], v[148:151]
    ds_read_b64_tr_b16 a[222:223], v163 offset:16896
    v_mfma_f32_16x16x32_bf16 v[152:155], a[228:231], a[12:15], v[152:155]
    ds_read_b64_tr_b16 a[224:225], v160 offset:20480
    v_mfma_f32_16x16x32_bf16 v[156:159], a[228:231], a[84:87], v[156:159]
    ds_read_b64_tr_b16 a[226:227], v160 offset:20992
    s_waitcnt vmcnt(26)
    s_waitcnt lgkmcnt(6)
    v_mfma_f32_16x16x32_bf16 v[128:131], a[232:235], a[16:19], v[128:131]
    ds_read_b64_tr_b16 a[228:229], v161 offset:20480
    v_mfma_f32_16x16x32_bf16 v[132:135], a[232:235], a[88:91], v[132:135]
    ds_read_b64_tr_b16 a[230:231], v161 offset:20992
    v_mfma_f32_16x16x32_bf16 v[136:139], a[236:239], a[16:19], v[136:139]
    ds_read_b64_tr_b16 a[232:233], v162 offset:20480
    v_mfma_f32_16x16x32_bf16 v[140:143], a[236:239], a[88:91], v[140:143]
    ds_read_b64_tr_b16 a[234:235], v162 offset:20992
    s_waitcnt lgkmcnt(6)
    v_mfma_f32_16x16x32_bf16 v[144:147], a[216:219], a[16:19], v[144:147]
    ds_read_b64_tr_b16 a[236:237], v163 offset:20480
    v_mfma_f32_16x16x32_bf16 v[148:151], a[216:219], a[88:91], v[148:151]
    ds_read_b64_tr_b16 a[238:239], v163 offset:20992
    v_mfma_f32_16x16x32_bf16 v[152:155], a[220:223], a[16:19], v[152:155]
    ds_read_b64_tr_b16 a[216:217], v160 offset:24576
    v_mfma_f32_16x16x32_bf16 v[156:159], a[220:223], a[88:91], v[156:159]
    ds_read_b64_tr_b16 a[218:219], v160 offset:25088
    s_waitcnt vmcnt(24)
    s_waitcnt lgkmcnt(6)
    v_mfma_f32_16x16x32_bf16 v[128:131], a[224:227], a[20:23], v[128:131]
    ds_read_b64_tr_b16 a[220:221], v161 offset:24576
    v_mfma_f32_16x16x32_bf16 v[132:135], a[224:227], a[92:95], v[132:135]
    ds_read_b64_tr_b16 a[222:223], v161 offset:25088
    v_mfma_f32_16x16x32_bf16 v[136:139], a[228:231], a[20:23], v[136:139]
    ds_read_b64_tr_b16 a[224:225], v162 offset:24576
    v_mfma_f32_16x16x32_bf16 v[140:143], a[228:231], a[92:95], v[140:143]
    ds_read_b64_tr_b16 a[226:227], v162 offset:25088
    s_waitcnt lgkmcnt(6)
    v_mfma_f32_16x16x32_bf16 v[144:147], a[232:235], a[20:23], v[144:147]
    ds_read_b64_tr_b16 a[228:229], v163 offset:24576
    v_mfma_f32_16x16x32_bf16 v[148:151], a[232:235], a[92:95], v[148:151]
    ds_read_b64_tr_b16 a[230:231], v163 offset:25088
    v_mfma_f32_16x16x32_bf16 v[152:155], a[236:239], a[20:23], v[152:155]
    ds_read_b64_tr_b16 a[232:233], v160 offset:28672
    v_mfma_f32_16x16x32_bf16 v[156:159], a[236:239], a[92:95], v[156:159]
    ds_read_b64_tr_b16 a[234:235], v160 offset:29184
    s_waitcnt vmcnt(22)
    s_waitcnt lgkmcnt(6)
    v_mfma_f32_16x16x32_bf16 v[128:131], a[216:219], a[24:27], v[128:131]
    ds_read_b64_tr_b16 a[236:237], v161 offset:28672
    v_mfma_f32_16x16x32_bf16 v[132:135], a[216:219], a[96:99], v[132:135]
    ds_read_b64_tr_b16 a[238:239], v161 offset:29184
    s_add_u32 s57, s50, 0x0
    v_mfma_f32_16x16x32_bf16 v[136:139], a[220:223], a[24:27], v[136:139]
    ds_read_b64_tr_b16 a[216:217], v162 offset:28672
    v_mfma_f32_16x16x32_bf16 v[140:143], a[220:223], a[96:99], v[140:143]
    ds_read_b64_tr_b16 a[218:219], v162 offset:29184
    s_waitcnt lgkmcnt(6)
    v_mfma_f32_16x16x32_bf16 v[144:147], a[224:227], a[24:27], v[144:147]
    ds_read_b64_tr_b16 a[220:221], v163 offset:28672
    v_mfma_f32_16x16x32_bf16 v[148:151], a[224:227], a[96:99], v[148:151]
    ds_read_b64_tr_b16 a[222:223], v163 offset:29184
    s_add_u32 m0, s46, 0
    s_nop 0
    buffer_load_dwordx4 v16, s[12:15], s57 offen lds
    v_mfma_f32_16x16x32_bf16 v[152:155], a[228:231], a[24:27], v[152:155]
    ds_read_b64_tr_b16 a[224:225], v160 offset:32768
    v_mfma_f32_16x16x32_bf16 v[156:159], a[228:231], a[96:99], v[156:159]
    ds_read_b64_tr_b16 a[226:227], v160 offset:33280
    s_waitcnt vmcnt(21)
    s_waitcnt lgkmcnt(6)
    v_mfma_f32_16x16x32_bf16 v[128:131], a[232:235], a[28:31], v[128:131]
    ds_read_b64_tr_b16 a[228:229], v161 offset:32768
    v_mfma_f32_16x16x32_bf16 v[132:135], a[232:235], a[100:103], v[132:135]
    ds_read_b64_tr_b16 a[230:231], v161 offset:33280
    s_add_u32 m0, s46, 1024
    s_nop 0
    buffer_load_dwordx4 v17, s[12:15], s57 offen lds
    v_mfma_f32_16x16x32_bf16 v[136:139], a[236:239], a[28:31], v[136:139]
    ds_read_b64_tr_b16 a[232:233], v162 offset:32768
    v_mfma_f32_16x16x32_bf16 v[140:143], a[236:239], a[100:103], v[140:143]
    ds_read_b64_tr_b16 a[234:235], v162 offset:33280
    s_waitcnt lgkmcnt(6)
    v_mfma_f32_16x16x32_bf16 v[144:147], a[216:219], a[28:31], v[144:147]
    ds_read_b64_tr_b16 a[236:237], v163 offset:32768
    v_mfma_f32_16x16x32_bf16 v[148:151], a[216:219], a[100:103], v[148:151]
    ds_read_b64_tr_b16 a[238:239], v163 offset:33280
    s_add_u32 m0, s46, 2048
    s_nop 0
    buffer_load_dwordx4 v18, s[12:15], s57 offen lds
    v_mfma_f32_16x16x32_bf16 v[152:155], a[220:223], a[28:31], v[152:155]
    ds_read_b64_tr_b16 a[216:217], v164 offset:0
    v_mfma_f32_16x16x32_bf16 v[156:159], a[220:223], a[100:103], v[156:159]
    ds_read_b64_tr_b16 a[218:219], v164 offset:512
    s_waitcnt vmcnt(21)
    s_waitcnt lgkmcnt(6)
    v_mfma_f32_16x16x32_bf16 v[128:131], a[224:227], a[32:35], v[128:131]
    ds_read_b64_tr_b16 a[220:221], v165 offset:0
    v_mfma_f32_16x16x32_bf16 v[132:135], a[224:227], a[104:107], v[132:135]
    ds_read_b64_tr_b16 a[222:223], v165 offset:512
    s_add_u32 m0, s46, 3072
    s_nop 0
    buffer_load_dwordx4 v19, s[12:15], s57 offen lds
    v_mfma_f32_16x16x32_bf16 v[136:139], a[228:231], a[32:35], v[136:139]
    ds_read_b64_tr_b16 a[224:225], v166 offset:0
    v_mfma_f32_16x16x32_bf16 v[140:143], a[228:231], a[104:107], v[140:143]
    ds_read_b64_tr_b16 a[226:227], v166 offset:512
    s_waitcnt lgkmcnt(6)
    v_mfma_f32_16x16x32_bf16 v[144:147], a[232:235], a[32:35], v[144:147]
    ds_read_b64_tr_b16 a[228:229], v167 offset:0
    v_mfma_f32_16x16x32_bf16 v[148:151], a[232:235], a[104:107], v[148:151]
    ds_read_b64_tr_b16 a[230:231], v167 offset:512
    s_add_u32 m0, s46, 4096
    s_nop 0
    buffer_load_dwordx4 v20, s[12:15], s57 offen lds
    v_mfma_f32_16x16x32_bf16 v[152:155], a[236:239], a[32:35], v[152:155]
    ds_read_b64_tr_b16 a[232:233], v164 offset:4096
    v_mfma_f32_16x16x32_bf16 v[156:159], a[236:239], a[104:107], v[156:159]
    ds_read_b64_tr_b16 a[234:235], v164 offset:4608
    s_waitcnt vmcnt(21)
    s_waitcnt lgkmcnt(6)
    v_mfma_f32_16x16x32_bf16 v[128:131], a[216:219], a[36:39], v[128:131]
    ds_read_b64_tr_b16 a[236:237], v165 offset:4096
    v_mfma_f32_16x16x32_bf16 v[132:135], a[216:219], a[108:111], v[132:135]
    ds_read_b64_tr_b16 a[238:239], v165 offset:4608
    s_add_u32 m0, s46, 5120
    s_nop 0
    buffer_load_dwordx4 v21, s[12:15], s57 offen lds
    v_mfma_f32_16x16x32_bf16 v[136:139], a[220:223], a[36:39], v[136:139]
    ds_read_b64_tr_b16 a[216:217], v166 offset:4096
    v_mfma_f32_16x16x32_bf16 v[140:143], a[220:223], a[108:111], v[140:143]
    ds_read_b64_tr_b16 a[218:219], v166 offset:4608
    s_waitcnt lgkmcnt(6)
    v_mfma_f32_16x16x32_bf16 v[144:147], a[224:227], a[36:39], v[144:147]
    ds_read_b64_tr_b16 a[220:221], v167 offset:4096
    v_mfma_f32_16x16x32_bf16 v[148:151], a[224:227], a[108:111], v[148:151]
    ds_read_b64_tr_b16 a[222:223], v167 offset:4608
    s_add_u32 m0, s46, 6144
    s_nop 0
    buffer_load_dwordx4 v22, s[12:15], s57 offen lds
    v_mfma_f32_16x16x32_bf16 v[152:155], a[228:231], a[36:39], v[152:155]
    ds_read_b64_tr_b16 a[224:225], v164 offset:8192
    v_mfma_f32_16x16x32_bf16 v[156:159], a[228:231], a[108:111], v[156:159]
    ds_read_b64_tr_b16 a[226:227], v164 offset:8704
    s_waitcnt vmcnt(21)
    s_waitcnt lgkmcnt(6)
    v_mfma_f32_16x16x32_bf16 v[128:131], a[232:235], a[40:43], v[128:131]
    ds_read_b64_tr_b16 a[228:229], v165 offset:8192
    v_mfma_f32_16x16x32_bf16 v[132:135], a[232:235], a[112:115], v[132:135]
    ds_read_b64_tr_b16 a[230:231], v165 offset:8704
    s_add_u32 m0, s46, 7168
    s_nop 0
    buffer_load_dwordx4 v23, s[12:15], s57 offen lds
    v_mfma_f32_16x16x32_bf16 v[136:139], a[236:239], a[40:43], v[136:139]
    ds_read_b64_tr_b16 a[232:233], v166 offset:8192
    v_mfma_f32_16x16x32_bf16 v[140:143], a[236:239], a[112:115], v[140:143]
    ds_read_b64_tr_b16 a[234:235], v166 offset:8704
    s_waitcnt lgkmcnt(6)
    v_mfma_f32_16x16x32_bf16 v[144:147], a[216:219], a[40:43], v[144:147]
    ds_read_b64_tr_b16 a[236:237], v167 offset:8192
    v_mfma_f32_16x16x32_bf16 v[148:151], a[216:219], a[112:115], v[148:151]
    ds_read_b64_tr_b16 a[238:239], v167 offset:8704
    s_add_u32 m0, s46, 8192
    s_nop 0
    buffer_load_dwordx4 v24, s[12:15], s57 offen lds
    v_mfma_f32_16x16x32_bf16 v[152:155], a[220:223], a[40:43], v[152:155]
    ds_read_b64_tr_b16 a[216:217], v164 offset:12288
    v_mfma_f32_16x16x32_bf16 v[156:159], a[220:223], a[112:115], v[156:159]
    ds_read_b64_tr_b16 a[218:219], v164 offset:12800
    s_waitcnt vmcnt(21)
    s_waitcnt lgkmcnt(6)
    v_mfma_f32_16x16x32_bf16 v[128:131], a[224:227], a[44:47], v[128:131]
    ds_read_b64_tr_b16 a[220:221], v165 offset:12288
    v_mfma_f32_16x16x32_bf16 v[132:135], a[224:227], a[116:119], v[132:135]
    ds_read_b64_tr_b16 a[222:223], v165 offset:12800
    s_add_u32 s73, s50, 0x288000
    v_mfma_f32_16x16x32_bf16 v[136:139], a[228:231], a[44:47], v[136:139]
    ds_read_b64_tr_b16 a[224:225], v166 offset:12288
    v_mfma_f32_16x16x32_bf16 v[140:143], a[228:231], a[116:119], v[140:143]
    ds_read_b64_tr_b16 a[226:227], v166 offset:12800
    s_waitcnt lgkmcnt(6)
    v_mfma_f32_16x16x32_bf16 v[144:147], a[232:235], a[44:47], v[144:147]
    ds_read_b64_tr_b16 a[228:229], v167 offset:12288
    v_mfma_f32_16x16x32_bf16 v[148:151], a[232:235], a[116:119], v[148:151]
    ds_read_b64_tr_b16 a[230:231], v167 offset:12800
    s_add_u32 m0, s46, 36864
    s_nop 0
    buffer_load_dwordx4 v16, s[12:15], s73 offen lds
    v_mfma_f32_16x16x32_bf16 v[152:155], a[236:239], a[44:47], v[152:155]
    ds_read_b64_tr_b16 a[232:233], v164 offset:16384
    v_mfma_f32_16x16x32_bf16 v[156:159], a[236:239], a[116:119], v[156:159]
    ds_read_b64_tr_b16 a[234:235], v164 offset:16896
    s_waitcnt vmcnt(20)
    s_waitcnt lgkmcnt(6)
    v_mfma_f32_16x16x32_bf16 v[128:131], a[216:219], a[48:51], v[128:131]
    ds_read_b64_tr_b16 a[236:237], v165 offset:16384
    v_mfma_f32_16x16x32_bf16 v[132:135], a[216:219], a[120:123], v[132:135]
    ds_read_b64_tr_b16 a[238:239], v165 offset:16896
    s_add_u32 m0, s46, 37888
    s_nop 0
    buffer_load_dwordx4 v17, s[12:15], s73 offen lds
    v_mfma_f32_16x16x32_bf16 v[136:139], a[220:223], a[48:51], v[136:139]
    ds_read_b64_tr_b16 a[216:217], v166 offset:16384
    v_mfma_f32_16x16x32_bf16 v[140:143], a[220:223], a[120:123], v[140:143]
    ds_read_b64_tr_b16 a[218:219], v166 offset:16896
    s_waitcnt lgkmcnt(6)
    v_mfma_f32_16x16x32_bf16 v[144:147], a[224:227], a[48:51], v[144:147]
    ds_read_b64_tr_b16 a[220:221], v167 offset:16384
    v_mfma_f32_16x16x32_bf16 v[148:151], a[224:227], a[120:123], v[148:151]
    ds_read_b64_tr_b16 a[222:223], v167 offset:16896
    s_add_u32 m0, s46, 38912
    s_nop 0
    buffer_load_dwordx4 v18, s[12:15], s73 offen lds
    v_mfma_f32_16x16x32_bf16 v[152:155], a[228:231], a[48:51], v[152:155]
    ds_read_b64_tr_b16 a[224:225], v164 offset:20480
    v_mfma_f32_16x16x32_bf16 v[156:159], a[228:231], a[120:123], v[156:159]
    ds_read_b64_tr_b16 a[226:227], v164 offset:20992
    s_waitcnt vmcnt(20)
    s_waitcnt lgkmcnt(6)
    v_mfma_f32_16x16x32_bf16 v[128:131], a[232:235], a[52:55], v[128:131]
    ds_read_b64_tr_b16 a[228:229], v165 offset:20480
    v_mfma_f32_16x16x32_bf16 v[132:135], a[232:235], a[124:127], v[132:135]
    ds_read_b64_tr_b16 a[230:231], v165 offset:20992
    s_add_u32 m0, s46, 39936
    s_nop 0
    buffer_load_dwordx4 v19, s[12:15], s73 offen lds
    v_mfma_f32_16x16x32_bf16 v[136:139], a[236:239], a[52:55], v[136:139]
    ds_read_b64_tr_b16 a[232:233], v166 offset:20480
    v_mfma_f32_16x16x32_bf16 v[140:143], a[236:239], a[124:127], v[140:143]
    ds_read_b64_tr_b16 a[234:235], v166 offset:20992
    s_waitcnt lgkmcnt(6)
    v_mfma_f32_16x16x32_bf16 v[144:147], a[216:219], a[52:55], v[144:147]
    ds_read_b64_tr_b16 a[236:237], v167 offset:20480
    v_mfma_f32_16x16x32_bf16 v[148:151], a[216:219], a[124:127], v[148:151]
    ds_read_b64_tr_b16 a[238:239], v167 offset:20992
    s_add_u32 m0, s46, 40960
    s_nop 0
    buffer_load_dwordx4 v20, s[12:15], s73 offen lds
    v_mfma_f32_16x16x32_bf16 v[152:155], a[220:223], a[52:55], v[152:155]
    ds_read_b64_tr_b16 a[216:217], v164 offset:24576
    v_mfma_f32_16x16x32_bf16 v[156:159], a[220:223], a[124:127], v[156:159]
    ds_read_b64_tr_b16 a[218:219], v164 offset:25088
    s_waitcnt vmcnt(20)
    s_waitcnt lgkmcnt(6)
    v_mfma_f32_16x16x32_bf16 v[128:131], a[224:227], a[56:59], v[128:131]
    ds_read_b64_tr_b16 a[220:221], v165 offset:24576
    v_mfma_f32_16x16x32_bf16 v[132:135], a[224:227], a[128:131], v[132:135]
    ds_read_b64_tr_b16 a[222:223], v165 offset:25088
    s_add_u32 m0, s46, 41984
    s_nop 0
    buffer_load_dwordx4 v21, s[12:15], s73 offen lds
    v_mfma_f32_16x16x32_bf16 v[136:139], a[228:231], a[56:59], v[136:139]
    ds_read_b64_tr_b16 a[224:225], v166 offset:24576
    v_mfma_f32_16x16x32_bf16 v[140:143], a[228:231], a[128:131], v[140:143]
    ds_read_b64_tr_b16 a[226:227], v166 offset:25088
    s_waitcnt lgkmcnt(6)
    v_mfma_f32_16x16x32_bf16 v[144:147], a[232:235], a[56:59], v[144:147]
    ds_read_b64_tr_b16 a[228:229], v167 offset:24576
    v_mfma_f32_16x16x32_bf16 v[148:151], a[232:235], a[128:131], v[148:151]
    ds_read_b64_tr_b16 a[230:231], v167 offset:25088
    s_add_u32 m0, s46, 43008
    s_nop 0
    buffer_load_dwordx4 v22, s[12:15], s73 offen lds
    v_mfma_f32_16x16x32_bf16 v[152:155], a[236:239], a[56:59], v[152:155]
    ds_read_b64_tr_b16 a[232:233], v164 offset:28672
    v_mfma_f32_16x16x32_bf16 v[156:159], a[236:239], a[128:131], v[156:159]
    ds_read_b64_tr_b16 a[234:235], v164 offset:29184
    s_waitcnt vmcnt(20)
    s_waitcnt lgkmcnt(6)
    v_mfma_f32_16x16x32_bf16 v[128:131], a[216:219], a[60:63], v[128:131]
    ds_read_b64_tr_b16 a[236:237], v165 offset:28672
    v_mfma_f32_16x16x32_bf16 v[132:135], a[216:219], a[132:135], v[132:135]
    ds_read_b64_tr_b16 a[238:239], v165 offset:29184
    s_add_u32 m0, s46, 44032
    s_nop 0
    buffer_load_dwordx4 v23, s[12:15], s73 offen lds
    v_mfma_f32_16x16x32_bf16 v[136:139], a[220:223], a[60:63], v[136:139]
    ds_read_b64_tr_b16 a[216:217], v166 offset:28672
    v_mfma_f32_16x16x32_bf16 v[140:143], a[220:223], a[132:135], v[140:143]
    ds_read_b64_tr_b16 a[218:219], v166 offset:29184
    s_waitcnt lgkmcnt(6)
    v_mfma_f32_16x16x32_bf16 v[144:147], a[224:227], a[60:63], v[144:147]
    ds_read_b64_tr_b16 a[220:221], v167 offset:28672
    v_mfma_f32_16x16x32_bf16 v[148:151], a[224:227], a[132:135], v[148:151]
    ds_read_b64_tr_b16 a[222:223], v167 offset:29184
    s_add_u32 m0, s46, 45056
    s_nop 0
    buffer_load_dwordx4 v24, s[12:15], s73 offen lds
    v_mfma_f32_16x16x32_bf16 v[152:155], a[228:231], a[60:63], v[152:155]
    ds_read_b64_tr_b16 a[224:225], v164 offset:32768
    v_mfma_f32_16x16x32_bf16 v[156:159], a[228:231], a[132:135], v[156:159]
    ds_read_b64_tr_b16 a[226:227], v164 offset:33280
    s_waitcnt vmcnt(20)
    s_waitcnt lgkmcnt(6)
    v_mfma_f32_16x16x32_bf16 v[128:131], a[232:235], a[64:67], v[128:131]
    ds_read_b64_tr_b16 a[228:229], v165 offset:32768
    v_mfma_f32_16x16x32_bf16 v[132:135], a[232:235], a[136:139], v[132:135]
    ds_read_b64_tr_b16 a[230:231], v165 offset:33280
    v_mfma_f32_16x16x32_bf16 v[136:139], a[236:239], a[64:67], v[136:139]
    ds_read_b64_tr_b16 a[232:233], v166 offset:32768
    v_mfma_f32_16x16x32_bf16 v[140:143], a[236:239], a[136:139], v[140:143]
    ds_read_b64_tr_b16 a[234:235], v166 offset:33280
    s_waitcnt lgkmcnt(6)
    v_mfma_f32_16x16x32_bf16 v[144:147], a[216:219], a[64:67], v[144:147]
    ds_read_b64_tr_b16 a[236:237], v167 offset:32768
    v_mfma_f32_16x16x32_bf16 v[148:151], a[216:219], a[136:139], v[148:151]
    ds_read_b64_tr_b16 a[238:239], v167 offset:33280
    v_mfma_f32_16x16x32_bf16 v[152:155], a[220:223], a[64:67], v[152:155]
    v_mfma_f32_16x16x32_bf16 v[156:159], a[220:223], a[136:139], v[156:159]
    s_waitcnt vmcnt(18)
    s_waitcnt lgkmcnt(4)
    v_mfma_f32_16x16x32_bf16 v[128:131], a[224:227], a[68:71], v[128:131]
    v_mfma_f32_16x16x32_bf16 v[132:135], a[224:227], a[140:143], v[132:135]
    v_mfma_f32_16x16x32_bf16 v[136:139], a[228:231], a[68:71], v[136:139]
    v_mfma_f32_16x16x32_bf16 v[140:143], a[228:231], a[140:143], v[140:143]
    s_waitcnt lgkmcnt(0)
    v_mfma_f32_16x16x32_bf16 v[144:147], a[232:235], a[68:71], v[144:147]
    v_mfma_f32_16x16x32_bf16 v[148:151], a[232:235], a[140:143], v[148:151]
    v_mfma_f32_16x16x32_bf16 v[152:155], a[236:239], a[68:71], v[152:155]
    v_mfma_f32_16x16x32_bf16 v[156:159], a[236:239], a[140:143], v[156:159]
    s_lshl_b32 s65, s77, 11
    s_add_u32 s58, s58, s65
    s_add_u32 s59, s59, s65
    s_mul_i32 s65, s76, 2560
    s_lshl_b32 s74, s77, 8
    s_add_u32 s65, s65, s74
    s_nop 2
    v_lshlrev_b32 v2, 16, v172
    v_and_b32 v3, 0xffff0000, v172
    v_pk_add_f32 v[2:3], v[2:3], v[128:129]
    v_cvt_pk_bf16_f32 v188, v2, v3
    v_lshlrev_b32 v2, 16, v173
    v_and_b32 v3, 0xffff0000, v173
    v_pk_add_f32 v[2:3], v[2:3], v[130:131]
    v_cvt_pk_bf16_f32 v189, v2, v3
    v_lshlrev_b32 v2, 16, v174
    v_and_b32 v3, 0xffff0000, v174
    v_pk_add_f32 v[2:3], v[2:3], v[136:137]
    v_cvt_pk_bf16_f32 v190, v2, v3
    v_lshlrev_b32 v2, 16, v175
    v_and_b32 v3, 0xffff0000, v175
    v_pk_add_f32 v[2:3], v[2:3], v[138:139]
    v_cvt_pk_bf16_f32 v191, v2, v3
    v_lshlrev_b32 v2, 16, v176
    v_and_b32 v3, 0xffff0000, v176
    v_pk_add_f32 v[2:3], v[2:3], v[144:145]
    v_cvt_pk_bf16_f32 v192, v2, v3
    v_lshlrev_b32 v2, 16, v177
    v_and_b32 v3, 0xffff0000, v177
    v_pk_add_f32 v[2:3], v[2:3], v[146:147]
    v_cvt_pk_bf16_f32 v193, v2, v3
    v_lshlrev_b32 v2, 16, v178
    v_and_b32 v3, 0xffff0000, v178
    v_pk_add_f32 v[2:3], v[2:3], v[152:153]
    v_cvt_pk_bf16_f32 v194, v2, v3
    v_lshlrev_b32 v2, 16, v179
    v_and_b32 v3, 0xffff0000, v179
    v_pk_add_f32 v[2:3], v[2:3], v[154:155]
    v_cvt_pk_bf16_f32 v195, v2, v3
    buffer_store_dwordx4 v[188:191], v81, s[24:27], s58 offen sc1
    buffer_store_dwordx4 v[192:195], v81, s[24:27], s58 offen offset:1024 sc1
    v_lshlrev_b32 v2, 16, v180
    v_and_b32 v3, 0xffff0000, v180
    v_pk_add_f32 v[2:3], v[2:3], v[132:133]
    v_cvt_pk_bf16_f32 v196, v2, v3
    v_lshlrev_b32 v2, 16, v181
    v_and_b32 v3, 0xffff0000, v181
    v_pk_add_f32 v[2:3], v[2:3], v[134:135]
    v_cvt_pk_bf16_f32 v197, v2, v3
    v_lshlrev_b32 v2, 16, v182
    v_and_b32 v3, 0xffff0000, v182
    v_pk_add_f32 v[2:3], v[2:3], v[140:141]
    v_cvt_pk_bf16_f32 v198, v2, v3
    v_lshlrev_b32 v2, 16, v183
    v_and_b32 v3, 0xffff0000, v183
    v_pk_add_f32 v[2:3], v[2:3], v[142:143]
    v_cvt_pk_bf16_f32 v199, v2, v3
    v_lshlrev_b32 v2, 16, v184
    v_and_b32 v3, 0xffff0000, v184
    v_pk_add_f32 v[2:3], v[2:3], v[148:149]
    v_cvt_pk_bf16_f32 v200, v2, v3
    v_lshlrev_b32 v2, 16, v185
    v_and_b32 v3, 0xffff0000, v185
    v_pk_add_f32 v[2:3], v[2:3], v[150:151]
    v_cvt_pk_bf16_f32 v201, v2, v3
    v_lshlrev_b32 v2, 16, v186
    v_and_b32 v3, 0xffff0000, v186
    v_pk_add_f32 v[2:3], v[2:3], v[156:157]
    v_cvt_pk_bf16_f32 v202, v2, v3
    v_lshlrev_b32 v2, 16, v187
    v_and_b32 v3, 0xffff0000, v187
    v_pk_add_f32 v[2:3], v[2:3], v[158:159]
    v_cvt_pk_bf16_f32 v203, v2, v3
    buffer_store_dwordx4 v[196:199], v81, s[24:27], s59 offen sc1
    buffer_store_dwordx4 v[200:203], v81, s[24:27], s59 offen offset:1024 sc1
    v_lshlrev_b32 v128, 16, v188
    v_and_b32 v129, 0xffff0000, v188
    v_lshlrev_b32 v130, 16, v189
    v_and_b32 v131, 0xffff0000, v189
    v_lshlrev_b32 v132, 16, v190
    v_and_b32 v133, 0xffff0000, v190
    v_lshlrev_b32 v134, 16, v191
    v_and_b32 v135, 0xffff0000, v191
    v_lshlrev_b32 v136, 16, v192
    v_and_b32 v137, 0xffff0000, v192
    v_lshlrev_b32 v138, 16, v193
    v_and_b32 v139, 0xffff0000, v193
    v_lshlrev_b32 v140, 16, v194
    v_and_b32 v141, 0xffff0000, v194
    v_lshlrev_b32 v142, 16, v195
    v_and_b32 v143, 0xffff0000, v195
    v_lshlrev_b32 v144, 16, v196
    v_and_b32 v145, 0xffff0000, v196
    v_lshlrev_b32 v146, 16, v197
    v_and_b32 v147, 0xffff0000, v197
    v_lshlrev_b32 v148, 16, v198
    v_and_b32 v149, 0xffff0000, v198
    v_lshlrev_b32 v150, 16, v199
    v_and_b32 v151, 0xffff0000, v199
    v_lshlrev_b32 v152, 16, v200
    v_and_b32 v153, 0xffff0000, v200
    v_lshlrev_b32 v154, 16, v201
    v_and_b32 v155, 0xffff0000, v201
    v_lshlrev_b32 v156, 16, v202
    v_and_b32 v157, 0xffff0000, v202
    v_lshlrev_b32 v158, 16, v203
    v_and_b32 v159, 0xffff0000, v203
    v_pk_add_f32 v[208:209], v[128:129], v[130:131]
    v_pk_add_f32 v[212:213], v[144:145], v[146:147]
    v_pk_add_f32 v[208:209], v[208:209], v[132:133]
    v_pk_add_f32 v[212:213], v[212:213], v[148:149]
    v_pk_add_f32 v[208:209], v[208:209], v[134:135]
    v_pk_add_f32 v[212:213], v[212:213], v[150:151]
    v_pk_add_f32 v[208:209], v[208:209], v[136:137]
    v_pk_add_f32 v[212:213], v[212:213], v[152:153]
    v_pk_add_f32 v[208:209], v[208:209], v[138:139]
    v_pk_add_f32 v[212:213], v[212:213], v[154:155]
    v_pk_add_f32 v[208:209], v[208:209], v[140:141]
    v_pk_add_f32 v[212:213], v[212:213], v[156:157]
    v_pk_add_f32 v[208:209], v[208:209], v[142:143]
    v_pk_add_f32 v[212:213], v[212:213], v[158:159]
    v_add_f32 v208, v208, v209
    v_add_f32 v212, v212, v213
    v_mov_b32 v2, v208
    v_mov_b32 v3, v212
    s_nop 1
    v_permlane32_swap_b32 v208, v2
    v_permlane32_swap_b32 v212, v3
    s_nop 0
    v_add_f32 v208, v208, v2
    v_add_f32 v212, v212, v3
    v_mov_b32 v2, v208
    v_mov_b32 v3, v212
    s_nop 1
    v_permlane16_swap_b32 v208, v2
    v_permlane16_swap_b32 v212, v3
    s_nop 0
    v_add_f32 v208, v208, v2
    v_add_f32 v212, v212, v3
    v_mul_f32 v208, 0x3c800000, v208
    v_mov_b32 v209, v208
    v_mul_f32 v212, 0x3c800000, v212
    v_mov_b32 v213, v212
    v_pk_add_f32 v[128:129], v[128:129], v[208:209] neg_lo:[0,1] neg_hi:[0,1]
    v_pk_add_f32 v[144:145], v[144:145], v[212:213] neg_lo:[0,1] neg_hi:[0,1]
    v_pk_add_f32 v[130:131], v[130:131], v[208:209] neg_lo:[0,1] neg_hi:[0,1]
    v_pk_add_f32 v[146:147], v[146:147], v[212:213] neg_lo:[0,1] neg_hi:[0,1]
    v_pk_add_f32 v[132:133], v[132:133], v[208:209] neg_lo:[0,1] neg_hi:[0,1]
    v_pk_add_f32 v[148:149], v[148:149], v[212:213] neg_lo:[0,1] neg_hi:[0,1]
    v_pk_add_f32 v[134:135], v[134:135], v[208:209] neg_lo:[0,1] neg_hi:[0,1]
    v_pk_add_f32 v[150:151], v[150:151], v[212:213] neg_lo:[0,1] neg_hi:[0,1]
    v_pk_add_f32 v[136:137], v[136:137], v[208:209] neg_lo:[0,1] neg_hi:[0,1]
    v_pk_add_f32 v[152:153], v[152:153], v[212:213] neg_lo:[0,1] neg_hi:[0,1]
    v_pk_add_f32 v[138:139], v[138:139], v[208:209] neg_lo:[0,1] neg_hi:[0,1]
    v_pk_add_f32 v[154:155], v[154:155], v[212:213] neg_lo:[0,1] neg_hi:[0,1]
    v_pk_add_f32 v[140:141], v[140:141], v[208:209] neg_lo:[0,1] neg_hi:[0,1]
    v_pk_add_f32 v[156:157], v[156:157], v[212:213] neg_lo:[0,1] neg_hi:[0,1]
    v_pk_add_f32 v[142:143], v[142:143], v[208:209] neg_lo:[0,1] neg_hi:[0,1]
    v_pk_add_f32 v[158:159], v[158:159], v[212:213] neg_lo:[0,1] neg_hi:[0,1]
    v_pk_mul_f32 v[210:211], v[128:129], v[128:129]
    v_pk_mul_f32 v[214:215], v[144:145], v[144:145]
    v_pk_fma_f32 v[210:211], v[130:131], v[130:131], v[210:211]
    v_pk_fma_f32 v[214:215], v[146:147], v[146:147], v[214:215]
    v_pk_fma_f32 v[210:211], v[132:133], v[132:133], v[210:211]
    v_pk_fma_f32 v[214:215], v[148:149], v[148:149], v[214:215]
    v_pk_fma_f32 v[210:211], v[134:135], v[134:135], v[210:211]
    v_pk_fma_f32 v[214:215], v[150:151], v[150:151], v[214:215]
    v_pk_fma_f32 v[210:211], v[136:137], v[136:137], v[210:211]
    v_pk_fma_f32 v[214:215], v[152:153], v[152:153], v[214:215]
    v_pk_fma_f32 v[210:211], v[138:139], v[138:139], v[210:211]
    v_pk_fma_f32 v[214:215], v[154:155], v[154:155], v[214:215]
    v_pk_fma_f32 v[210:211], v[140:141], v[140:141], v[210:211]
    v_pk_fma_f32 v[214:215], v[156:157], v[156:157], v[214:215]
    v_pk_fma_f32 v[210:211], v[142:143], v[142:143], v[210:211]
    v_pk_fma_f32 v[214:215], v[158:159], v[158:159], v[214:215]
    v_add_f32 v209, v210, v211
    v_add_f32 v213, v214, v215
    v_mov_b32 v2, v209
    v_mov_b32 v3, v213
    s_nop 1
    v_permlane32_swap_b32 v209, v2
    v_permlane32_swap_b32 v213, v3
    s_nop 0
    v_add_f32 v209, v209, v2
    v_add_f32 v213, v213, v3
    v_mov_b32 v2, v209
    v_mov_b32 v3, v213
    s_nop 1
    v_permlane16_swap_b32 v209, v2
    v_permlane16_swap_b32 v213, v3
    s_nop 0
    v_add_f32 v209, v209, v2
    v_add_f32 v213, v213, v3
    s_mov_b64 exec, 0xffff
    buffer_store_dwordx2 v[208:209], v228, s[28:31], s65 offen offset:0 sc1
    buffer_store_dwordx2 v[212:213], v228, s[28:31], s65 offen offset:128 sc1
    s_mov_b64 exec, -1
    s_lshl_b32 s65, s77, 3
    s_add_u32 s65, s65, s64
    s_add_u32 s65, s65, 139264
    v_mov_b32 v2, 0
    s_waitcnt vmcnt(0)
    buffer_store_dwordx2 v[84:85], v2, s[60:63], s65 offen sc1
    s_mov_b64 exec, -1
    s_barrier
L_f_norole:
    v_mov_b32 v3, v14
    v_mov_b32 v4, v15
    s_mul_i32 s58, s20, 18
    v_add_u32 v10, s58, v1
    v_lshlrev_b32 v10, 2, v10
    s_sub_u32 s59, s22, 256
    v_mov_b32 v11, s21
    v_mov_b32 v12, s59
    v_cmp_gt_u32 vcc, 256, v10
    s_mul_i32 s58, s3, 576
    v_lshlrev_b32 v13, 2, v10
    v_cndmask_b32 v11, v12, v11, vcc
    v_add3_u32 v11, v11, v10, s58
    v_lshlrev_b32 v11, 2, v11
    v_cmp_gt_u32 vcc, 18, v1
    v_mov_b32 v12, 0x7fffff00
    v_add_u32 v13, 147456, v13
    v_cndmask_b32 v11, v12, v11, vcc
    v_lshlrev_b32 v12, 4, v1
    v_add_u32 v12, 149504, v12
    v_cndmask_b32 v13, v12, v13, vcc
    s_add_u32 s36, s8, 0x700000
    s_addc_u32 s37, s9, 0
    s_mov_b32 s38, 0x1200000
    s_mov_b32 s39, 0x20000
    s_add_u32 s40, s8, 0x1900000
    s_addc_u32 s41, s9, 0
    s_mov_b32 s42, 0x1200000
    s_mov_b32 s43, 0x20000
    s_lshl_b32 s51, s22, 1
    s_add_u32 s51, s51, s49
    s_mul_i32 s49, s3, 576 * 1152
    s_lshl_b32 s52, s21, 1
    s_add_u32 s52, s52, s49
    s_lshl_b32 s53, s22, 1
    s_add_u32 s53, s53, s49
    v_lshrrev_b32 v5, 2, v1
    v_and_b32 v6, 2, v3
    v_and_b32 v7, 3, v1
    v_xor_b32 v6, v6, v7
    v_lshlrev_b32 v6, 4, v6
    v_mul_lo_u32 v8, v5, s47
    v_add_u32 v8, v8, v6
    s_mul_i32 s48, s20, 144 * 9216
    v_add_u32 v25, s48, v8
    v_add_u32 v26, 0x24000, v25
    v_add_u32 v27, 0x48000, v25
    v_add_u32 v28, 0x6c000, v25
    v_add_u32 v29, 0x90000, v25
    v_add_u32 v30, 0xb4000, v25
    v_add_u32 v31, 0xd8000, v25
    v_add_u32 v32, 0xfc000, v25
    v_add_u32 v33, 0x120000, v25
    v_mul_u32_u24 v8, 1152, v3
    v_add_u32 v8, v8, v4
    v_mul_u32_u24 v14, 1152, v5
    v_add_u32 v14, v14, v6
    s_mul_i32 s48, s20, 72
    s_add_u32 s58, s48, s21
    s_mul_i32 s58, s58, 1152
    s_sub_u32 s59, s22, s21
    s_sub_u32 s59, s59, 256
    s_mul_i32 s59, s59, 1152
    s_cmp_eq_u32 s20, 3
    s_cselect_b32 s59, s59, 0
    v_add_u32 v34, s58, v8
    v_add_u32 v2, s59, v34
    v_add_u32 v35, 9216, v34
    v_add_u32 v36, 18432, v34
    v_add_u32 v37, 27648, v34
    v_add_u32 v38, 36864, v34
    v_add_u32 v39, 46080, v2
    v_add_u32 v40, 55296, v2
    v_add_u32 v41, 64512, v2
    v_add_u32 v42, 73728, v2
    s_add_u32 s58, s48, s23
    s_mul_i32 s58, s58, 1152
    s_sub_u32 s59, s44, s23
    s_sub_u32 s59, s59, 256
    s_mul_i32 s59, s59, 1152
    s_cmp_eq_u32 s20, 3
    s_cselect_b32 s59, s59, 0
    v_add_u32 v43, s58, v8
    v_add_u32 v2, s59, v43
    v_add_u32 v44, 9216, v43
    v_add_u32 v45, 18432, v43
    v_add_u32 v46, 27648, v43
    v_add_u32 v47, 36864, v43
    v_add_u32 v48, 46080, v2
    v_add_u32 v49, 55296, v2
    v_add_u32 v50, 64512, v2
    v_add_u32 v51, 73728, v2
    s_cmp_lt_u32 s20, 2
    s_cselect_b32 s58, s21, s23
    s_cselect_b32 s59, s22, s44
    s_sub_u32 s59, s59, s58
    s_sub_u32 s59, s59, 256
    s_and_b32 s64, s20, 1
    s_mul_i32 s59, s59, s64
    s_mul_i32 s59, s59, 1152
    s_mul_i32 s64, s64, 144
    s_add_u32 s58, s58, s64
    s_mul_i32 s58, s58, 1152
    v_add_u32 v52, s58, v14
    v_add_u32 v2, s59, v52
    v_add_u32 v53, 18432, v52
    v_add_u32 v54, 36864, v52
    v_add_u32 v55, 55296, v52
    v_add_u32 v56, 73728, v52
    v_add_u32 v57, 92160, v52
    v_add_u32 v58, 110592, v52
    v_add_u32 v59, 129024, v2
    v_add_u32 v60, 147456, v2
    v_lshrrev_b32 v2, 4, v1
    v_lshrrev_b32 v3, 2, v1
    v_bfe_u32 v4, v1, 3, 2
    v_and_b32 v5, 3, v1
    v_lshlrev_b32 v5, 3, v5
    v_lshl_add_u32 v6, v3, 7, v5
    v_lshl_add_u32 v6, v4, 5, v6
    v_xor_b32 v61, 0, v6
    v_add_u32 v65, 36864, v61
    v_add_u32 v69, 73728, v61
    v_add_u32 v73, 110592, v61
    v_xor_b32 v62, 32, v6
    v_add_u32 v66, 36864, v62
    v_add_u32 v70, 73728, v62
    v_add_u32 v74, 110592, v62
    v_xor_b32 v63, 64, v6
    v_add_u32 v67, 36864, v63
    v_add_u32 v71, 73728, v63
    v_add_u32 v75, 110592, v63
    v_xor_b32 v64, 96, v6
    v_add_u32 v68, 36864, v64
    v_add_u32 v72, 73728, v64
    v_add_u32 v76, 110592, v64
    v_and_b32 v4, 1, v2
    v_lshl_add_u32 v6, v3, 6, v5
    v_lshl_add_u32 v6, v4, 5, v6
    v_xor_b32 v77, 0, v6
    v_add_u32 v79, 36864, v77
    v_xor_b32 v78, 32, v6
    v_add_u32 v80, 36864, v78
    v_and_b32 v7, 15, v1
    v_lshlrev_b32 v88, 2, v7
    v_add_u32 v88, 147456, v88
    s_lshl_b32 s64, s2, 2
    s_add_u32 s64, s64, s20
    s_xor_b32 s65, s64, 32
    s_mul_i32 s66, s64, 18432
    s_mul_i32 s67, s65, 18432
    s_lshl_b32 s68, s64, 7
    s_lshl_b32 s69, s65, 7
    s_mul_i32 s70, s3, 0x240000
    s_mul_i32 s71, s54, 18432
    s_add_u32 s70, s70, s71
    s_lshl_b32 s71, s21, 5
    s_add_u32 s71, s71, s70
    s_lshl_b32 s72, s22, 5
    s_add_u32 s72, s72, s70
    v_mov_b32 v109, 0
    v_mov_b32 v113, 0
    v_accvgpr_write_b32 a241, 0
    v_accvgpr_write_b32 a245, 0
    v_accvgpr_write_b32 a249, 0
    v_accvgpr_write_b32 a253, 0
    v_mov_b32 v110, 0
    v_mov_b32 v114, 0
    v_accvgpr_write_b32 a242, 0
    v_accvgpr_write_b32 a246, 0
    v_accvgpr_write_b32 a250, 0
    v_accvgpr_write_b32 a254, 0
    v_mov_b32 v111, 0
    v_mov_b32 v115, 0
    v_accvgpr_write_b32 a243, 0
    v_accvgpr_write_b32 a247, 0
    v_accvgpr_write_b32 a251, 0
    v_accvgpr_write_b32 a255, 0
    s_and_b32 s76, s100, 0xfff
    s_bfe_u32 s77, s100, 0xc000c
    s_lshr_b64 s[44:45], s[100:101], 24
    s_bfe_u32 s45, s44, 0xc000c
    s_and_b32 s44, s44, 0xfff
    s_movk_i32 s58, 18432
    s_mov_b32 s59, 36864
    buffer_load_dwordx4 v[244:247], v11, s[32:35], 0 offen sc1
    buffer_load_dwordx4 v[248:251], v11, s[32:35], s58 offen sc1
    buffer_load_dwordx4 v[252:255], v11, s[32:35], s59 offen sc1
    s_lshl_b32 s65, s54, 6
    s_add_u32 s65, s65, 139264
    v_min_u32 v4, 8, v1
    v_lshlrev_b32 v4, 3, v4
    s_mov_b32 s74, 0
L_f_h_spin:
    buffer_load_dwordx2 v[2:3], v4, s[60:63], s65 offen sc1
    s_add_u32 s74, s74, 1
    s_waitcnt vmcnt(0)
    v_xor_b32 v2, v2, v84
    v_xor_b32 v3, v3, v85
    v_or_b32 v2, v2, v3
    v_cmp_ne_u32 vcc, 0, v2
    s_cmp_ge_u32 s74, 0x40000
    s_cbranch_scc1 L_f_h_go
    s_nop 3
    s_cbranch_vccz L_f_h_go
    s_sleep 1
    s_branch L_f_h_spin
L_f_h_go:
    v_lshlrev_b32 v9, 3, v1
    s_mul_i32 s58, s54, 1280
    buffer_load_dwordx2 v[232:233], v9, s[28:31], s58 offen offset:0 sc1
    buffer_load_dwordx2 v[234:235], v9, s[28:31], s58 offen offset:512 sc1
    buffer_load_dwordx2 v[236:237], v9, s[28:31], s58 offen offset:1024 sc1
    buffer_load_dwordx2 v[238:239], v9, s[28:31], s58 offen offset:1536 sc1
    buffer_load_dwordx2 v[240:241], v9, s[28:31], s58 offen offset:2048 sc1
    buffer_load_dwordx4 a[0:3], v81, s[24:27], s55 offen offset:0 sc1
    buffer_load_dwordx4 a[72:75], v81, s[24:27], s56 offen offset:0 sc1
    buffer_load_dwordx4 a[4:7], v81, s[24:27], s55 offen offset:1024 sc1
    buffer_load_dwordx4 a[76:79], v81, s[24:27], s56 offen offset:1024 sc1
    buffer_load_dwordx4 a[8:11], v81, s[24:27], s55 offen offset:2048 sc1
    buffer_load_dwordx4 a[80:83], v81, s[24:27], s56 offen offset:2048 sc1
    buffer_load_dwordx4 a[12:15], v81, s[24:27], s55 offen offset:3072 sc1
    buffer_load_dwordx4 a[84:87], v81, s[24:27], s56 offen offset:3072 sc1
    buffer_load_dwordx4 a[16:19], v116, s[24:27], s55 offen offset:0 sc1
    buffer_load_dwordx4 a[88:91], v116, s[24:27], s56 offen offset:0 sc1
    buffer_load_dwordx4 a[20:23], v116, s[24:27], s55 offen offset:1024 sc1
    buffer_load_dwordx4 a[92:95], v116, s[24:27], s56 offen offset:1024 sc1
    buffer_load_dwordx4 a[24:27], v116, s[24:27], s55 offen offset:2048 sc1
    buffer_load_dwordx4 a[96:99], v116, s[24:27], s56 offen offset:2048 sc1
    buffer_load_dwordx4 a[28:31], v116, s[24:27], s55 offen offset:3072 sc1
    buffer_load_dwordx4 a[100:103], v116, s[24:27], s56 offen offset:3072 sc1
    buffer_load_dwordx4 a[32:35], v117, s[24:27], s55 offen offset:0 sc1
    buffer_load_dwordx4 a[104:107], v117, s[24:27], s56 offen offset:0 sc1
    s_barrier
    s_add_u32 s57, s50, 0x80
    ds_read_b64_tr_b16 a[216:217], v61 offset:0
    ds_read_b64_tr_b16 a[218:219], v61 offset:2048
    ds_read_b64_tr_b16 a[220:221], v62 offset:0
    ds_read_b64_tr_b16 a[222:223], v62 offset:2048
    ds_read_b64_tr_b16 a[224:225], v63 offset:0
    ds_read_b64_tr_b16 a[226:227], v63 offset:2048
    ds_read_b64_tr_b16 a[228:229], v64 offset:0
    ds_read_b64_tr_b16 a[230:231], v64 offset:2048
    ds_read_b64_tr_b16 a[232:233], v61 offset:4096
    ds_read_b64_tr_b16 a[234:235], v61 offset:6144
    s_waitcnt vmcnt(16)
    s_waitcnt lgkmcnt(6)
    v_mfma_f32_16x16x32_bf16 v[128:131], a[216:219], a[0:3], 0
    ds_read_b64_tr_b16 a[236:237], v62 offset:4096
    s_add_u32 m0, s46, 73728
    v_mfma_f32_16x16x32_bf16 v[132:135], a[216:219], a[72:75], 0
    ds_read_b64_tr_b16 a[238:239], v62 offset:6144
    buffer_load_dwordx4 v16, s[12:15], s57 offen lds
    v_mfma_f32_16x16x32_bf16 v[136:139], a[220:223], a[0:3], 0
    ds_read_b64_tr_b16 a[216:217], v63 offset:4096
    v_mfma_f32_16x16x32_bf16 v[140:143], a[220:223], a[72:75], 0
    ds_read_b64_tr_b16 a[218:219], v63 offset:6144
    buffer_load_dwordx4 a[36:39], v117, s[24:27], s55 offen offset:1024 sc1
    s_waitcnt lgkmcnt(6)
    v_mfma_f32_16x16x32_bf16 v[144:147], a[224:227], a[0:3], 0
    ds_read_b64_tr_b16 a[220:221], v64 offset:4096
    v_mfma_f32_16x16x32_bf16 v[148:151], a[224:227], a[72:75], 0
    ds_read_b64_tr_b16 a[222:223], v64 offset:6144
    buffer_load_dwordx4 a[108:111], v117, s[24:27], s56 offen offset:1024 sc1
    v_mfma_f32_16x16x32_bf16 v[152:155], a[228:231], a[0:3], 0
    ds_read_b64_tr_b16 a[224:225], v61 offset:8192
    v_mfma_f32_16x16x32_bf16 v[156:159], a[228:231], a[72:75], 0
    ds_read_b64_tr_b16 a[226:227], v61 offset:10240
    buffer_load_dwordx4 a[40:43], v117, s[24:27], s55 offen offset:2048 sc1
    s_waitcnt vmcnt(18)
    s_waitcnt lgkmcnt(6)
    v_mfma_f32_16x16x32_bf16 v[128:131], a[232:235], a[4:7], v[128:131]
    ds_read_b64_tr_b16 a[228:229], v62 offset:8192
    s_add_u32 m0, s46, 74752
    v_mfma_f32_16x16x32_bf16 v[132:135], a[232:235], a[76:79], v[132:135]
    ds_read_b64_tr_b16 a[230:231], v62 offset:10240
    buffer_load_dwordx4 v17, s[12:15], s57 offen lds
    v_mfma_f32_16x16x32_bf16 v[136:139], a[236:239], a[4:7], v[136:139]
    ds_read_b64_tr_b16 a[232:233], v63 offset:8192
    v_mov_b32 v2, 0
    v_xor_b32 v244, s76, v244
    v_xor_b32 v245, s77, v245
    v_xor_b32 v246, s44, v246
    v_mfma_f32_16x16x32_bf16 v[140:143], a[236:239], a[76:79], v[140:143]
    ds_read_b64_tr_b16 a[234:235], v63 offset:10240
    buffer_load_dwordx4 a[112:115], v117, s[24:27], s56 offen offset:2048 sc1
    s_waitcnt lgkmcnt(6)
    v_mfma_f32_16x16x32_bf16 v[144:147], a[216:219], a[4:7], v[144:147]
    ds_read_b64_tr_b16 a[236:237], v64 offset:8192
    v_xor_b32 v247, s45, v247
    v_or3_b32 v2, v2, v244, v245
    v_or3_b32 v2, v2, v246, v247
    v_xor_b32 v248, s76, v248
    v_mfma_f32_16x16x32_bf16 v[148:151], a[216:219], a[76:79], v[148:151]
    ds_read_b64_tr_b16 a[238:239], v64 offset:10240
    buffer_load_dwordx4 a[44:47], v117, s[24:27], s55 offen offset:3072 sc1
    v_mfma_f32_16x16x32_bf16 v[152:155], a[220:223], a[4:7], v[152:155]
    ds_read_b64_tr_b16 a[216:217], v61 offset:12288
    v_xor_b32 v249, s77, v249
    v_xor_b32 v250, s44, v250
    v_xor_b32 v251, s45, v251
    v_or3_b32 v2, v2, v248, v249
    v_mfma_f32_16x16x32_bf16 v[156:159], a[220:223], a[76:79], v[156:159]
    ds_read_b64_tr_b16 a[218:219], v61 offset:14336
    buffer_load_dwordx4 a[116:119], v117, s[24:27], s56 offen offset:3072 sc1
    s_waitcnt vmcnt(20)
    s_waitcnt lgkmcnt(6)
    v_mfma_f32_16x16x32_bf16 v[128:131], a[224:227], a[8:11], v[128:131]
    ds_read_b64_tr_b16 a[220:221], v62 offset:12288
    s_add_u32 m0, s46, 75776
    v_mfma_f32_16x16x32_bf16 v[132:135], a[224:227], a[80:83], v[132:135]
    ds_read_b64_tr_b16 a[222:223], v62 offset:14336
    buffer_load_dwordx4 v18, s[12:15], s57 offen lds
    v_mfma_f32_16x16x32_bf16 v[136:139], a[228:231], a[8:11], v[136:139]
    ds_read_b64_tr_b16 a[224:225], v63 offset:12288
    v_or3_b32 v2, v2, v250, v251
    v_xor_b32 v252, s76, v252
    v_xor_b32 v253, s77, v253
    v_xor_b32 v254, s44, v254
    v_mfma_f32_16x16x32_bf16 v[140:143], a[228:231], a[80:83], v[140:143]
    ds_read_b64_tr_b16 a[226:227], v63 offset:14336
    buffer_load_dwordx4 a[48:51], v118, s[24:27], s55 offen offset:0 sc1
    s_waitcnt lgkmcnt(6)
    v_mfma_f32_16x16x32_bf16 v[144:147], a[232:235], a[8:11], v[144:147]
    ds_read_b64_tr_b16 a[228:229], v64 offset:12288
    v_xor_b32 v255, s45, v255
    v_or3_b32 v2, v2, v252, v253
    v_or3_b32 v2, v2, v254, v255
    v_cmp_gt_u32 vcc, 18, v1
    v_mfma_f32_16x16x32_bf16 v[148:151], a[232:235], a[80:83], v[148:151]
    ds_read_b64_tr_b16 a[230:231], v64 offset:14336
    buffer_load_dwordx4 a[120:123], v118, s[24:27], s56 offen offset:0 sc1
    v_mfma_f32_16x16x32_bf16 v[152:155], a[236:239], a[8:11], v[152:155]
    ds_read_b64_tr_b16 a[232:233], v61 offset:16384
    v_and_b32 v2, 0xfff, v2
    s_nop 0
    v_cndmask_b32 v2, 0, v2, vcc
    v_cmp_ne_u32 vcc, 0, v2
    v_mfma_f32_16x16x32_bf16 v[156:159], a[236:239], a[80:83], v[156:159]
    ds_read_b64_tr_b16 a[234:235], v61 offset:18432
    buffer_load_dwordx4 a[52:55], v118, s[24:27], s55 offen offset:1024 sc1
    s_waitcnt vmcnt(22)
    s_waitcnt lgkmcnt(6)
    v_mfma_f32_16x16x32_bf16 v[128:131], a[216:219], a[12:15], v[128:131]
    ds_read_b64_tr_b16 a[236:237], v62 offset:16384
    s_add_u32 m0, s46, 76800
    v_mfma_f32_16x16x32_bf16 v[132:135], a[216:219], a[84:87], v[132:135]
    ds_read_b64_tr_b16 a[238:239], v62 offset:18432
    buffer_load_dwordx4 v19, s[12:15], s57 offen lds
    v_mfma_f32_16x16x32_bf16 v[136:139], a[220:223], a[12:15], v[136:139]
    ds_read_b64_tr_b16 a[216:217], v63 offset:16384
    s_nop 4
    s_cbranch_vccnz L_f_cs_slow
L_f_cs_ok:
    v_add_f32 v244, v244, v248
    v_mfma_f32_16x16x32_bf16 v[140:143], a[220:223], a[84:87], v[140:143]
    ds_read_b64_tr_b16 a[218:219], v63 offset:18432
    buffer_load_dwordx4 a[124:127], v118, s[24:27], s56 offen offset:1024 sc1
    s_waitcnt lgkmcnt(6)
    v_mfma_f32_16x16x32_bf16 v[144:147], a[224:227], a[12:15], v[144:147]
    ds_read_b64_tr_b16 a[220:221], v64 offset:16384
    v_add_f32 v244, v244, v252
    v_add_f32 v245, v245, v249
    v_add_f32 v245, v245, v253
    v_add_f32 v246, v246, v250
    v_mfma_f32_16x16x32_bf16 v[148:151], a[224:227], a[84:87], v[148:151]
    ds_read_b64_tr_b16 a[222:223], v64 offset:18432
    buffer_load_dwordx4 a[56:59], v118, s[24:27], s55 offen offset:2048 sc1
    v_mfma_f32_16x16x32_bf16 v[152:155], a[228:231], a[12:15], v[152:155]
    ds_read_b64_tr_b16 a[224:225], v61 offset:20480
    v_add_f32 v246, v246, v254
    v_add_f32 v247, v247, v251
    v_add_f32 v247, v247, v255
    v_cvt_pk_bf16_f32 v2, v244, v244
    v_mfma_f32_16x16x32_bf16 v[156:159], a[228:231], a[84:87], v[156:159]
    ds_read_b64_tr_b16 a[226:227], v61 offset:22528
    buffer_load_dwordx4 a[128:131], v118, s[24:27], s56 offen offset:2048 sc1
    s_waitcnt vmcnt(24)
    s_waitcnt lgkmcnt(6)
    v_mfma_f32_16x16x32_bf16 v[128:131], a[232:235], a[16:19], v[128:131]
    ds_read_b64_tr_b16 a[228:229], v62 offset:20480
    s_add_u32 m0, s46, 77824
    v_mfma_f32_16x16x32_bf16 v[132:135], a[232:235], a[88:91], v[132:135]
    ds_read_b64_tr_b16 a[230:231], v62 offset:22528
    buffer_load_dwordx4 v20, s[12:15], s57 offen lds
    v_mfma_f32_16x16x32_bf16 v[136:139], a[236:239], a[16:19], v[136:139]
    ds_read_b64_tr_b16 a[232:233], v63 offset:20480
    v_and_b32 v2, 0xffff0000, v2
    v_sub_f32 v3, v244, v2
    v_cvt_pk_bf16_f32 v244, v2, v3
    v_cvt_pk_bf16_f32 v2, v245, v245
    v_mfma_f32_16x16x32_bf16 v[140:143], a[236:239], a[88:91], v[140:143]
    ds_read_b64_tr_b16 a[234:235], v63 offset:22528
    buffer_load_dwordx4 a[60:63], v118, s[24:27], s55 offen offset:3072 sc1
    s_waitcnt lgkmcnt(6)
    v_mfma_f32_16x16x32_bf16 v[144:147], a[216:219], a[16:19], v[144:147]
    ds_read_b64_tr_b16 a[236:237], v64 offset:20480
    v_and_b32 v2, 0xffff0000, v2
    v_sub_f32 v3, v245, v2
    v_cvt_pk_bf16_f32 v245, v2, v3
    v_cvt_pk_bf16_f32 v2, v246, v246
    v_mfma_f32_16x16x32_bf16 v[148:151], a[216:219], a[88:91], v[148:151]
    ds_read_b64_tr_b16 a[238:239], v64 offset:22528
    buffer_load_dwordx4 a[132:135], v118, s[24:27], s56 offen offset:3072 sc1
    v_mfma_f32_16x16x32_bf16 v[152:155], a[220:223], a[16:19], v[152:155]
    ds_read_b64_tr_b16 a[216:217], v61 offset:24576
    v_and_b32 v2, 0xffff0000, v2
    v_sub_f32 v3, v246, v2
    v_cvt_pk_bf16_f32 v246, v2, v3
    v_cvt_pk_bf16_f32 v2, v247, v247
    v_mfma_f32_16x16x32_bf16 v[156:159], a[220:223], a[88:91], v[156:159]
    ds_read_b64_tr_b16 a[218:219], v61 offset:26624
    buffer_load_dwordx4 a[64:67], v119, s[24:27], s55 offen offset:0 sc1
    s_waitcnt vmcnt(26)
    s_waitcnt lgkmcnt(6)
    v_mfma_f32_16x16x32_bf16 v[128:131], a[224:227], a[20:23], v[128:131]
    ds_read_b64_tr_b16 a[220:221], v62 offset:24576
    s_add_u32 m0, s46, 78848
    v_mfma_f32_16x16x32_bf16 v[132:135], a[224:227], a[92:95], v[132:135]
    ds_read_b64_tr_b16 a[222:223], v62 offset:26624
    buffer_load_dwordx4 v21, s[12:15], s57 offen lds
    v_mfma_f32_16x16x32_bf16 v[136:139], a[228:231], a[20:23], v[136:139]
    ds_read_b64_tr_b16 a[224:225], v63 offset:24576
    v_and_b32 v2, 0xffff0000, v2
    v_sub_f32 v3, v247, v2
    v_cvt_pk_bf16_f32 v247, v2, v3
    ds_write_b128 v13, v[244:247]
    v_mfma_f32_16x16x32_bf16 v[140:143], a[228:231], a[92:95], v[140:143]
    ds_read_b64_tr_b16 a[226:227], v63 offset:26624
    buffer_load_dwordx4 a[136:139], v119, s[24:27], s56 offen offset:0 sc1
    s_waitcnt lgkmcnt(7)
    v_mfma_f32_16x16x32_bf16 v[144:147], a[232:235], a[20:23], v[144:147]
    ds_read_b64_tr_b16 a[228:229], v64 offset:24576
    v_cmp_gt_u32 vcc, 32, v1
    v_add_f32 v2, v232, v234
    v_add_f32 v3, v233, v235
    v_cndmask_b32 v240, 0, v240, vcc
    v_mfma_f32_16x16x32_bf16 v[148:151], a[232:235], a[92:95], v[148:151]
    ds_read_b64_tr_b16 a[230:231], v64 offset:26624
    buffer_load_dwordx4 a[68:71], v119, s[24:27], s55 offen offset:1024 sc1
    v_mfma_f32_16x16x32_bf16 v[152:155], a[236:239], a[20:23], v[152:155]
    ds_read_b64_tr_b16 a[232:233], v61 offset:28672
    v_cndmask_b32 v241, 0, v241, vcc
    v_add_f32 v2, v2, v236
    v_add_f32 v3, v3, v237
    v_add_f32 v2, v2, v238
    v_mfma_f32_16x16x32_bf16 v[156:159], a[236:239], a[92:95], v[156:159]
    ds_read_b64_tr_b16 a[234:235], v61 offset:30720
    buffer_load_dwordx4 a[140:143], v119, s[24:27], s56 offen offset:1024 sc1
    s_waitcnt vmcnt(28)
    s_waitcnt lgkmcnt(7)
    v_mfma_f32_16x16x32_bf16 v[128:131], a[216:219], a[24:27], v[128:131]
    ds_read_b64_tr_b16 a[236:237], v62 offset:28672
    s_add_u32 m0, s46, 79872
    v_mfma_f32_16x16x32_bf16 v[132:135], a[216:219], a[96:99], v[132:135]
    ds_read_b64_tr_b16 a[238:239], v62 offset:30720
    buffer_load_dwordx4 v22, s[12:15], s57 offen lds
    v_mfma_f32_16x16x32_bf16 v[136:139], a[220:223], a[24:27], v[136:139]
    ds_read_b64_tr_b16 a[216:217], v63 offset:28672
    v_add_f32 v3, v3, v239
    v_add_f32 v2, v2, v240
    v_add_f32 v3, v3, v241
    v_mov_b32 v4, v2
    v_mfma_f32_16x16x32_bf16 v[140:143], a[220:223], a[96:99], v[140:143]
    ds_read_b64_tr_b16 a[218:219], v63 offset:30720
    s_waitcnt lgkmcnt(6)
    v_mfma_f32_16x16x32_bf16 v[144:147], a[224:227], a[24:27], v[144:147]
    ds_read_b64_tr_b16 a[220:221], v64 offset:28672
    s_nop 1
    v_permlane32_swap_b32 v2, v4
    s_nop 1
    v_add_f32 v2, v2, v4
    v_mfma_f32_16x16x32_bf16 v[148:151], a[224:227], a[96:99], v[148:151]
    ds_read_b64_tr_b16 a[222:223], v64 offset:30720
    v_mfma_f32_16x16x32_bf16 v[152:155], a[228:231], a[24:27], v[152:155]
    ds_read_b64_tr_b16 a[224:225], v61 offset:32768
    v_mul_f32 v2, 0x3de38e39, v2
    v_cndmask_b32 v240, v2, v240, vcc
    v_sub_f32 v5, v232, v2
    v_mul_f32 v5, v5, v5
    v_mfma_f32_16x16x32_bf16 v[156:159], a[228:231], a[96:99], v[156:159]
    ds_read_b64_tr_b16 a[226:227], v61 offset:34816
    s_waitcnt vmcnt(27)
    s_waitcnt lgkmcnt(6)
    v_mfma_f32_16x16x32_bf16 v[128:131], a[232:235], a[28:31], v[128:131]
    ds_read_b64_tr_b16 a[228:229], v62 offset:32768
    s_add_u32 m0, s46, 80896
    v_mfma_f32_16x16x32_bf16 v[132:135], a[232:235], a[100:103], v[132:135]
    ds_read_b64_tr_b16 a[230:231], v62 offset:34816
    buffer_load_dwordx4 v23, s[12:15], s57 offen lds
    v_mfma_f32_16x16x32_bf16 v[136:139], a[236:239], a[28:31], v[136:139]
    ds_read_b64_tr_b16 a[232:233], v63 offset:32768
    v_fmac_f32 v3, 0x42800000, v5
    v_sub_f32 v5, v234, v2
    v_mul_f32 v5, v5, v5
    v_fmac_f32 v3, 0x42800000, v5
    v_mfma_f32_16x16x32_bf16 v[140:143], a[236:239], a[100:103], v[140:143]
    ds_read_b64_tr_b16 a[234:235], v63 offset:34816
    s_waitcnt lgkmcnt(6)
    v_mfma_f32_16x16x32_bf16 v[144:147], a[216:219], a[28:31], v[144:147]
    ds_read_b64_tr_b16 a[236:237], v64 offset:32768
    v_sub_f32 v5, v236, v2
    v_mul_f32 v5, v5, v5
    v_fmac_f32 v3, 0x42800000, v5
    v_sub_f32 v5, v238, v2
    v_mfma_f32_16x16x32_bf16 v[148:151], a[216:219], a[100:103], v[148:151]
    ds_read_b64_tr_b16 a[238:239], v64 offset:34816
    s_barrier
    v_mfma_f32_16x16x32_bf16 v[152:155], a[220:223], a[28:31], v[152:155]
    ds_read_b64_tr_b16 a[216:217], v65 offset:0
    v_mul_f32 v5, v5, v5
    v_fmac_f32 v3, 0x42800000, v5
    v_sub_f32 v5, v240, v2
    v_mul_f32 v5, v5, v5
    v_mfma_f32_16x16x32_bf16 v[156:159], a[220:223], a[100:103], v[156:159]
    ds_read_b64_tr_b16 a[218:219], v65 offset:2048
    s_waitcnt vmcnt(26)
    s_waitcnt lgkmcnt(6)
    v_mfma_f32_16x16x32_bf16 v[128:131], a[224:227], a[32:35], v[128:131]
    ds_read_b64_tr_b16 a[220:221], v66 offset:0
    s_add_u32 m0, s46, 81920
    v_mfma_f32_16x16x32_bf16 v[132:135], a[224:227], a[104:107], v[132:135]
    ds_read_b64_tr_b16 a[222:223], v66 offset:2048
    buffer_load_dwordx4 v24, s[12:15], s57 offen lds
    v_mfma_f32_16x16x32_bf16 v[136:139], a[228:231], a[32:35], v[136:139]
    ds_read_b64_tr_b16 a[224:225], v67 offset:0
    v_fmac_f32 v3, 0x42800000, v5
    v_mov_b32 v4, v3
    s_nop 1
    v_permlane32_swap_b32 v3, v4
    v_mfma_f32_16x16x32_bf16 v[140:143], a[228:231], a[104:107], v[140:143]
    ds_read_b64_tr_b16 a[226:227], v67 offset:2048
    s_waitcnt lgkmcnt(6)
    v_mfma_f32_16x16x32_bf16 v[144:147], a[232:235], a[32:35], v[144:147]
    ds_read_b64_tr_b16 a[228:229], v68 offset:0
    s_nop 1
    v_add_f32 v3, v3, v4
    v_mul_f32 v3, 0x3ae38e39, v3
    v_cvt_pk_bf16_f32 v2, v2, v3
    v_mfma_f32_16x16x32_bf16 v[148:151], a[232:235], a[104:107], v[148:151]
    ds_read_b64_tr_b16 a[230:231], v68 offset:2048
    v_mfma_f32_16x16x32_bf16 v[152:155], a[236:239], a[32:35], v[152:155]
    ds_read_b64_tr_b16 a[232:233], v65 offset:4096
    s_add_u32 s73, s50, 0x288080
    v_mfma_f32_16x16x32_bf16 v[156:159], a[236:239], a[104:107], v[156:159]
    ds_read_b64_tr_b16 a[234:235], v65 offset:6144
    s_barrier
    s_waitcnt vmcnt(24)
    s_waitcnt lgkmcnt(6)
    v_mfma_f32_16x16x32_bf16 v[128:131], a[216:219], a[36:39], v[128:131]
    ds_read_b64_tr_b16 a[236:237], v66 offset:4096
    s_add_u32 m0, s46, 110592
    v_mfma_f32_16x16x32_bf16 v[132:135], a[216:219], a[108:111], v[132:135]
    ds_read_b64_tr_b16 a[238:239], v66 offset:6144
    buffer_load_dwordx4 v16, s[12:15], s73 offen lds
    v_mfma_f32_16x16x32_bf16 v[136:139], a[220:223], a[36:39], v[136:139]
    ds_read_b64_tr_b16 a[216:217], v67 offset:4096
    s_add_u32 s57, s50, 0x100
    v_mfma_f32_16x16x32_bf16 v[140:143], a[220:223], a[108:111], v[140:143]
    ds_read_b64_tr_b16 a[218:219], v67 offset:6144
    s_waitcnt lgkmcnt(6)
    v_mfma_f32_16x16x32_bf16 v[144:147], a[224:227], a[36:39], v[144:147]
    ds_read_b64_tr_b16 a[220:221], v68 offset:4096
    s_add_u32 m0, s46, 111616
    v_mfma_f32_16x16x32_bf16 v[148:151], a[224:227], a[108:111], v[148:151]
    ds_read_b64_tr_b16 a[222:223], v68 offset:6144
    buffer_load_dwordx4 v17, s[12:15], s73 offen lds
    v_mfma_f32_16x16x32_bf16 v[152:155], a[228:231], a[36:39], v[152:155]
    ds_read_b64_tr_b16 a[224:225], v65 offset:8192
    v_and_b32 v3, 0xffff0000, v2
    v_lshlrev_b32 v2, 16, v2
    v_add_f32 v3, 0x3727c5ac, v3
    v_cvt_pk_bf16_f32 v3, v3, v3
    v_mfma_f32_16x16x32_bf16 v[156:159], a[228:231], a[108:111], v[156:159]
    ds_read_b64_tr_b16 a[226:227], v65 offset:10240
    s_waitcnt vmcnt(23)
    s_waitcnt lgkmcnt(6)
    v_mfma_f32_16x16x32_bf16 v[128:131], a[232:235], a[40:43], v[128:131]
    ds_read_b64_tr_b16 a[228:229], v66 offset:8192
    s_add_u32 m0, s46, 112640
    v_mfma_f32_16x16x32_bf16 v[132:135], a[232:235], a[112:115], v[132:135]
    ds_read_b64_tr_b16 a[230:231], v66 offset:10240
    buffer_load_dwordx4 v18, s[12:15], s73 offen lds
    v_mfma_f32_16x16x32_bf16 v[136:139], a[236:239], a[40:43], v[136:139]
    ds_read_b64_tr_b16 a[232:233], v67 offset:8192
    v_and_b32 v3, 0xffff0000, v3
    v_sqrt_f32 v3, v3
    s_nop 0
    v_cvt_pk_bf16_f32 v3, v3, v3
    v_mfma_f32_16x16x32_bf16 v[140:143], a[236:239], a[112:115], v[140:143]
    ds_read_b64_tr_b16 a[234:235], v67 offset:10240
    s_waitcnt lgkmcnt(6)
    v_mfma_f32_16x16x32_bf16 v[144:147], a[216:219], a[40:43], v[144:147]
    ds_read_b64_tr_b16 a[236:237], v68 offset:8192
    s_add_u32 m0, s46, 113664
    v_mfma_f32_16x16x32_bf16 v[148:151], a[216:219], a[112:115], v[148:151]
    ds_read_b64_tr_b16 a[238:239], v68 offset:10240
    buffer_load_dwordx4 v19, s[12:15], s73 offen lds
    v_mfma_f32_16x16x32_bf16 v[152:155], a[220:223], a[40:43], v[152:155]
    ds_read_b64_tr_b16 a[216:217], v65 offset:12288
    v_and_b32 v3, 0xffff0000, v3
    v_rcp_f32 v3, v3
    v_xor_b32 v2, 0x80000000, v2
    v_lshrrev_b32 v4, 16, v2
    v_mfma_f32_16x16x32_bf16 v[156:159], a[220:223], a[112:115], v[156:159]
    ds_read_b64_tr_b16 a[218:219], v65 offset:14336
    s_waitcnt vmcnt(23)
    s_waitcnt lgkmcnt(6)
    v_mfma_f32_16x16x32_bf16 v[128:131], a[224:227], a[44:47], v[128:131]
    ds_read_b64_tr_b16 a[220:221], v66 offset:12288
    s_add_u32 m0, s46, 114688
    v_mfma_f32_16x16x32_bf16 v[132:135], a[224:227], a[116:119], v[132:135]
    ds_read_b64_tr_b16 a[222:223], v66 offset:14336
    buffer_load_dwordx4 v20, s[12:15], s73 offen lds
    v_mfma_f32_16x16x32_bf16 v[136:139], a[228:231], a[44:47], v[136:139]
    ds_read_b64_tr_b16 a[224:225], v67 offset:12288
    v_or_b32 v108, v2, v4
    v_or_b32 v112, v2, v4
    v_mov_b32 v122, v3
    v_mov_b32 v123, v3
    v_mfma_f32_16x16x32_bf16 v[140:143], a[228:231], a[116:119], v[140:143]
    ds_read_b64_tr_b16 a[226:227], v67 offset:14336
    s_waitcnt lgkmcnt(6)
    v_mfma_f32_16x16x32_bf16 v[144:147], a[232:235], a[44:47], v[144:147]
    ds_read_b64_tr_b16 a[228:229], v68 offset:12288
    s_add_u32 m0, s46, 115712
    v_mfma_f32_16x16x32_bf16 v[148:151], a[232:235], a[116:119], v[148:151]
    ds_read_b64_tr_b16 a[230:231], v68 offset:14336
    buffer_load_dwordx4 v21, s[12:15], s73 offen lds
    v_mfma_f32_16x16x32_bf16 v[152:155], a[236:239], a[44:47], v[152:155]
    ds_read_b64_tr_b16 a[232:233], v65 offset:16384
    s_bitcmp1_b32 s3, 1
    s_cselect_b64 vcc, -1, 0
    v_permlane16_swap_b32 v122, v123
    s_nop 0
    v_mfma_f32_16x16x32_bf16 v[156:159], a[236:239], a[116:119], v[156:159]
    ds_read_b64_tr_b16 a[234:235], v65 offset:18432
    s_waitcnt vmcnt(22)
    s_waitcnt lgkmcnt(6)
    v_mfma_f32_16x16x32_bf16 v[128:131], a[216:219], a[48:51], v[128:131]
    ds_read_b64_tr_b16 a[236:237], v66 offset:16384
    s_add_u32 m0, s46, 116736
    v_mfma_f32_16x16x32_bf16 v[132:135], a[216:219], a[120:123], v[132:135]
    ds_read_b64_tr_b16 a[238:239], v66 offset:18432
    buffer_load_dwordx4 v22, s[12:15], s73 offen lds
    v_mfma_f32_16x16x32_bf16 v[136:139], a[220:223], a[48:51], v[136:139]
    ds_read_b64_tr_b16 a[216:217], v67 offset:16384
    v_cndmask_b32 v122, v122, v123, vcc
    v_permlane16_swap_b32 v108, v112
    v_cmp_gt_u32 vcc, 16, v1
    s_nop 1
    v_mfma_f32_16x16x32_bf16 v[140:143], a[220:223], a[120:123], v[140:143]
    ds_read_b64_tr_b16 a[218:219], v67 offset:18432
    s_waitcnt lgkmcnt(6)
    v_mfma_f32_16x16x32_bf16 v[144:147], a[224:227], a[48:51], v[144:147]
    ds_read_b64_tr_b16 a[220:221], v68 offset:16384
    s_add_u32 m0, s46, 117760
    v_mfma_f32_16x16x32_bf16 v[148:151], a[224:227], a[120:123], v[148:151]
    ds_read_b64_tr_b16 a[222:223], v68 offset:18432
    buffer_load_dwordx4 v23, s[12:15], s73 offen lds
    v_mfma_f32_16x16x32_bf16 v[152:155], a[228:231], a[48:51], v[152:155]
    ds_read_b64_tr_b16 a[224:225], v65 offset:20480
    v_cndmask_b32 v108, 0, v108, vcc
    v_cndmask_b32 v112, 0, v112, vcc
    v_mov_b32 v224, -1
    v_mov_b32 v225, -1
    v_mfma_f32_16x16x32_bf16 v[156:159], a[228:231], a[120:123], v[156:159]
    ds_read_b64_tr_b16 a[226:227], v65 offset:22528
    s_waitcnt vmcnt(21)
    s_waitcnt lgkmcnt(6)
    v_mfma_f32_16x16x32_bf16 v[128:131], a[232:235], a[52:55], v[128:131]
    ds_read_b64_tr_b16 a[228:229], v66 offset:20480
    s_add_u32 m0, s46, 118784
    v_mfma_f32_16x16x32_bf16 v[132:135], a[232:235], a[124:127], v[132:135]
    ds_read_b64_tr_b16 a[230:231], v66 offset:22528
    buffer_load_dwordx4 v24, s[12:15], s73 offen lds
    v_mfma_f32_16x16x32_bf16 v[136:139], a[236:239], a[52:55], v[136:139]
    ds_read_b64_tr_b16 a[232:233], v67 offset:20480
    v_mov_b32 v226, -1
    v_mov_b32 v227, -1
    v_mfma_f32_16x16x32_bf16 v[140:143], a[236:239], a[124:127], v[140:143]
    ds_read_b64_tr_b16 a[234:235], v67 offset:22528
    s_waitcnt lgkmcnt(6)
    v_mfma_f32_16x16x32_bf16 v[144:147], a[216:219], a[52:55], v[144:147]
    ds_read_b64_tr_b16 a[236:237], v68 offset:20480
    s_add_u32 m0, s46, 0
    v_mfma_f32_16x16x32_bf16 v[148:151], a[216:219], a[124:127], v[148:151]
    ds_read_b64_tr_b16 a[238:239], v68 offset:22528
    buffer_load_dwordx4 v16, s[12:15], s57 offen lds
    v_mfma_f32_16x16x32_bf16 v[152:155], a[220:223], a[52:55], v[152:155]
    ds_read_b64_tr_b16 a[216:217], v65 offset:24576
    v_mfma_f32_16x16x32_bf16 v[156:159], a[220:223], a[124:127], v[156:159]
    ds_read_b64_tr_b16 a[218:219], v65 offset:26624
    ds_read_b32 a240, v88 offset:0
    s_waitcnt vmcnt(21)
    s_waitcnt lgkmcnt(7)
    v_mfma_f32_16x16x32_bf16 v[128:131], a[224:227], a[56:59], v[128:131]
    ds_read_b64_tr_b16 a[220:221], v66 offset:24576
    s_add_u32 m0, s46, 1024
    v_mfma_f32_16x16x32_bf16 v[132:135], a[224:227], a[128:131], v[132:135]
    ds_read_b64_tr_b16 a[222:223], v66 offset:26624
    buffer_load_dwordx4 v17, s[12:15], s57 offen lds
    v_mfma_f32_16x16x32_bf16 v[136:139], a[228:231], a[56:59], v[136:139]
    ds_read_b64_tr_b16 a[224:225], v67 offset:24576
    v_mfma_f32_16x16x32_bf16 v[140:143], a[228:231], a[128:131], v[140:143]
    ds_read_b64_tr_b16 a[226:227], v67 offset:26624
    s_waitcnt lgkmcnt(7)
    v_mfma_f32_16x16x32_bf16 v[144:147], a[232:235], a[56:59], v[144:147]
    ds_read_b64_tr_b16 a[228:229], v68 offset:24576
    s_add_u32 m0, s46, 2048
    v_mfma_f32_16x16x32_bf16 v[148:151], a[232:235], a[128:131], v[148:151]
    ds_read_b64_tr_b16 a[230:231], v68 offset:26624
    buffer_load_dwordx4 v18, s[12:15], s57 offen lds
    v_mfma_f32_16x16x32_bf16 v[152:155], a[236:239], a[56:59], v[152:155]
    ds_read_b64_tr_b16 a[232:233], v65 offset:28672
    v_mfma_f32_16x16x32_bf16 v[156:159], a[236:239], a[128:131], v[156:159]
    ds_read_b64_tr_b16 a[234:235], v65 offset:30720
    ds_read_b32 a244, v88 offset:64
    s_waitcnt vmcnt(20)
    s_waitcnt lgkmcnt(7)
    v_mfma_f32_16x16x32_bf16 v[128:131], a[216:219], a[60:63], v[128:131]
    ds_read_b64_tr_b16 a[236:237], v66 offset:28672
    s_add_u32 m0, s46, 3072
    v_mfma_f32_16x16x32_bf16 v[132:135], a[216:219], a[132:135], v[132:135]
    ds_read_b64_tr_b16 a[238:239], v66 offset:30720
    buffer_load_dwordx4 v19, s[12:15], s57 offen lds
    v_mfma_f32_16x16x32_bf16 v[136:139], a[220:223], a[60:63], v[136:139]
    ds_read_b64_tr_b16 a[216:217], v67 offset:28672
    v_mfma_f32_16x16x32_bf16 v[140:143], a[220:223], a[132:135], v[140:143]
    ds_read_b64_tr_b16 a[218:219], v67 offset:30720
    s_waitcnt lgkmcnt(7)
    v_mfma_f32_16x16x32_bf16 v[144:147], a[224:227], a[60:63], v[144:147]
    ds_read_b64_tr_b16 a[220:221], v68 offset:28672
    s_add_u32 m0, s46, 4096
    v_mfma_f32_16x16x32_bf16 v[148:151], a[224:227], a[132:135], v[148:151]
    ds_read_b64_tr_b16 a[222:223], v68 offset:30720
    buffer_load_dwordx4 v20, s[12:15], s57 offen lds
    v_mfma_f32_16x16x32_bf16 v[152:155], a[228:231], a[60:63], v[152:155]
    ds_read_b64_tr_b16 a[224:225], v65 offset:32768
    v_mfma_f32_16x16x32_bf16 v[156:159], a[228:231], a[132:135], v[156:159]
    ds_read_b64_tr_b16 a[226:227], v65 offset:34816
    ds_read_b32 a248, v88 offset:128
    s_waitcnt vmcnt(19)
    s_waitcnt lgkmcnt(7)
    v_mfma_f32_16x16x32_bf16 v[128:131], a[232:235], a[64:67], v[128:131]
    ds_read_b64_tr_b16 a[228:229], v66 offset:32768
    s_add_u32 m0, s46, 5120
    v_mfma_f32_16x16x32_bf16 v[132:135], a[232:235], a[136:139], v[132:135]
    ds_read_b64_tr_b16 a[230:231], v66 offset:34816
    buffer_load_dwordx4 v21, s[12:15], s57 offen lds
    v_mfma_f32_16x16x32_bf16 v[136:139], a[236:239], a[64:67], v[136:139]
    ds_read_b64_tr_b16 a[232:233], v67 offset:32768
    v_mfma_f32_16x16x32_bf16 v[140:143], a[236:239], a[136:139], v[140:143]
    ds_read_b64_tr_b16 a[234:235], v67 offset:34816
    s_waitcnt lgkmcnt(7)
    v_mfma_f32_16x16x32_bf16 v[144:147], a[216:219], a[64:67], v[144:147]
    ds_read_b64_tr_b16 a[236:237], v68 offset:32768
    s_add_u32 m0, s46, 6144
    v_mfma_f32_16x16x32_bf16 v[148:151], a[216:219], a[136:139], v[148:151]
    ds_read_b64_tr_b16 a[238:239], v68 offset:34816
    buffer_load_dwordx4 v22, s[12:15], s57 offen lds
    s_waitcnt vmcnt(16)
    s_barrier
    v_mfma_f32_16x16x32_bf16 v[152:155], a[220:223], a[64:67], v[152:155]
    ds_read_b64_tr_b16 a[216:217], v69 offset:0
    v_mfma_f32_16x16x32_bf16 v[156:159], a[220:223], a[136:139], v[156:159]
    ds_read_b64_tr_b16 a[218:219], v69 offset:2048
    ds_read_b32 a252, v88 offset:192
    s_waitcnt lgkmcnt(7)
    v_mfma_f32_16x16x32_bf16 v[128:131], a[224:227], a[68:71], v[128:131]
    ds_read_b64_tr_b16 a[220:221], v70 offset:0
    s_add_u32 m0, s46, 7168
    v_mfma_f32_16x16x32_bf16 v[132:135], a[224:227], a[140:143], v[132:135]
    ds_read_b64_tr_b16 a[222:223], v70 offset:2048
    buffer_load_dwordx4 v23, s[12:15], s57 offen lds
    v_mfma_f32_16x16x32_bf16 v[136:139], a[228:231], a[68:71], v[136:139]
    ds_read_b64_tr_b16 a[224:225], v71 offset:0
    v_mfma_f32_16x16x32_bf16 v[140:143], a[228:231], a[140:143], v[140:143]
    ds_read_b64_tr_b16 a[226:227], v71 offset:2048
    s_waitcnt lgkmcnt(7)
    v_mfma_f32_16x16x32_bf16 v[144:147], a[232:235], a[68:71], v[144:147]
    ds_read_b64_tr_b16 a[228:229], v72 offset:0
    s_add_u32 m0, s46, 8192
    v_mfma_f32_16x16x32_bf16 v[148:151], a[232:235], a[140:143], v[148:151]
    ds_read_b64_tr_b16 a[230:231], v72 offset:2048
    buffer_load_dwordx4 v24, s[12:15], s57 offen lds
    v_mfma_f32_16x16x32_bf16 v[152:155], a[236:239], a[68:71], v[152:155]
    ds_read_b64_tr_b16 a[232:233], v69 offset:4096
    s_add_u32 s73, s50, 0x288100
    v_mfma_f32_16x16x32_bf16 v[156:159], a[236:239], a[140:143], v[156:159]
    ds_read_b64_tr_b16 a[234:235], v69 offset:6144
    v_mfma_f32_16x16x32_bf16 v[128:131], a[240:243], v[108:111], v[128:131]
    v_mfma_f32_16x16x32_bf16 v[132:135], a[240:243], v[112:115], v[132:135]
    v_mfma_f32_16x16x32_bf16 v[136:139], a[244:247], v[108:111], v[136:139]
    v_mfma_f32_16x16x32_bf16 v[140:143], a[244:247], v[112:115], v[140:143]
    v_mfma_f32_16x16x32_bf16 v[144:147], a[248:251], v[108:111], v[144:147]
    v_mfma_f32_16x16x32_bf16 v[148:151], a[248:251], v[112:115], v[148:151]
    s_waitcnt lgkmcnt(8)
    v_mfma_f32_16x16x32_bf16 v[152:155], a[252:255], v[108:111], v[152:155]
    v_mfma_f32_16x16x32_bf16 v[156:159], a[252:255], v[112:115], v[156:159]
    s_barrier
    s_waitcnt lgkmcnt(6)
    v_mfma_f32_16x16x32_bf16 v[160:163], a[216:219], a[0:3], 0
    ds_read_b64_tr_b16 a[236:237], v70 offset:4096
    s_add_u32 m0, s46, 36864
    v_mfma_f32_16x16x32_bf16 v[164:167], a[216:219], a[72:75], 0
    ds_read_b64_tr_b16 a[238:239], v70 offset:6144
    buffer_load_dwordx4 v16, s[12:15], s73 offen lds
    v_mfma_f32_16x16x32_bf16 v[168:171], a[220:223], a[0:3], 0
    ds_read_b64_tr_b16 a[216:217], v71 offset:4096
    v_mfma_f32_16x16x32_bf16 v[172:175], a[220:223], a[72:75], 0
    ds_read_b64_tr_b16 a[218:219], v71 offset:6144
    s_waitcnt lgkmcnt(6)
    v_mfma_f32_16x16x32_bf16 v[176:179], a[224:227], a[0:3], 0
    ds_read_b64_tr_b16 a[220:221], v72 offset:4096
    v_mfma_f32_16x16x32_bf16 v[180:183], a[224:227], a[72:75], 0
    ds_read_b64_tr_b16 a[222:223], v72 offset:6144
    v_mfma_f32_16x16x32_bf16 v[184:187], a[228:231], a[0:3], 0
    ds_read_b64_tr_b16 a[224:225], v69 offset:8192
    v_cvt_pk_bf16_f32 v90, v128, v129
    v_mfma_f32_16x16x32_bf16 v[188:191], a[228:231], a[72:75], 0
    ds_read_b64_tr_b16 a[226:227], v69 offset:10240
    s_waitcnt lgkmcnt(6)
    v_mfma_f32_16x16x32_bf16 v[160:163], a[232:235], a[4:7], v[160:163]
    ds_read_b64_tr_b16 a[228:229], v70 offset:8192
    s_add_u32 m0, s46, 37888
    v_mfma_f32_16x16x32_bf16 v[164:167], a[232:235], a[76:79], v[164:167]
    ds_read_b64_tr_b16 a[230:231], v70 offset:10240
    buffer_load_dwordx4 v17, s[12:15], s73 offen lds
    v_mfma_f32_16x16x32_bf16 v[168:171], a[236:239], a[4:7], v[168:171]
    ds_read_b64_tr_b16 a[232:233], v71 offset:8192
    v_cvt_pk_bf16_f32 v91, v130, v131
    v_mfma_f32_16x16x32_bf16 v[172:175], a[236:239], a[76:79], v[172:175]
    ds_read_b64_tr_b16 a[234:235], v71 offset:10240
    s_waitcnt lgkmcnt(6)
    v_mfma_f32_16x16x32_bf16 v[176:179], a[216:219], a[4:7], v[176:179]
    ds_read_b64_tr_b16 a[236:237], v72 offset:8192
    v_pk_max_i16 v90, v90, 0
    v_mfma_f32_16x16x32_bf16 v[180:183], a[216:219], a[76:79], v[180:183]
    ds_read_b64_tr_b16 a[238:239], v72 offset:10240
    v_mfma_f32_16x16x32_bf16 v[184:187], a[220:223], a[4:7], v[184:187]
    ds_read_b64_tr_b16 a[216:217], v69 offset:12288
    v_pk_max_i16 v91, v91, 0
    v_mfma_f32_16x16x32_bf16 v[188:191], a[220:223], a[76:79], v[188:191]
    ds_read_b64_tr_b16 a[218:219], v69 offset:14336
    s_waitcnt lgkmcnt(6)
    v_mfma_f32_16x16x32_bf16 v[160:163], a[224:227], a[8:11], v[160:163]
    ds_read_b64_tr_b16 a[220:221], v70 offset:12288
    s_add_u32 m0, s46, 38912
    v_mfma_f32_16x16x32_bf16 v[164:167], a[224:227], a[80:83], v[164:167]
    ds_read_b64_tr_b16 a[222:223], v70 offset:14336
    buffer_load_dwordx4 v18, s[12:15], s73 offen lds
    v_mfma_f32_16x16x32_bf16 v[168:171], a[228:231], a[8:11], v[168:171]
    ds_read_b64_tr_b16 a[224:225], v71 offset:12288
    v_cvt_pk_bf16_f32 v92, v136, v137
    v_mfma_f32_16x16x32_bf16 v[172:175], a[228:231], a[80:83], v[172:175]
    ds_read_b64_tr_b16 a[226:227], v71 offset:14336
    s_waitcnt lgkmcnt(6)
    v_mfma_f32_16x16x32_bf16 v[176:179], a[232:235], a[8:11], v[176:179]
    ds_read_b64_tr_b16 a[228:229], v72 offset:12288
    v_cvt_pk_bf16_f32 v93, v138, v139
    v_mfma_f32_16x16x32_bf16 v[180:183], a[232:235], a[80:83], v[180:183]
    ds_read_b64_tr_b16 a[230:231], v72 offset:14336
    v_mfma_f32_16x16x32_bf16 v[184:187], a[236:239], a[8:11], v[184:187]
    ds_read_b64_tr_b16 a[232:233], v69 offset:16384
    v_pk_max_i16 v92, v92, 0
    v_mfma_f32_16x16x32_bf16 v[188:191], a[236:239], a[80:83], v[188:191]
    ds_read_b64_tr_b16 a[234:235], v69 offset:18432
    s_waitcnt lgkmcnt(6)
    v_mfma_f32_16x16x32_bf16 v[160:163], a[216:219], a[12:15], v[160:163]
    ds_read_b64_tr_b16 a[236:237], v70 offset:16384
    s_add_u32 m0, s46, 39936
    v_mfma_f32_16x16x32_bf16 v[164:167], a[216:219], a[84:87], v[164:167]
    ds_read_b64_tr_b16 a[238:239], v70 offset:18432
    buffer_load_dwordx4 v19, s[12:15], s73 offen lds
    v_mfma_f32_16x16x32_bf16 v[168:171], a[220:223], a[12:15], v[168:171]
    ds_read_b64_tr_b16 a[216:217], v71 offset:16384
    v_pk_max_i16 v93, v93, 0
    v_mfma_f32_16x16x32_bf16 v[172:175], a[220:223], a[84:87], v[172:175]
    ds_read_b64_tr_b16 a[218:219], v71 offset:18432
    s_waitcnt lgkmcnt(6)
    v_mfma_f32_16x16x32_bf16 v[176:179], a[224:227], a[12:15], v[176:179]
    ds_read_b64_tr_b16 a[220:221], v72 offset:16384
    v_accvgpr_write_b32 a144, v90
    v_mfma_f32_16x16x32_bf16 v[180:183], a[224:227], a[84:87], v[180:183]
    ds_read_b64_tr_b16 a[222:223], v72 offset:18432
    buffer_store_dwordx4 v[90:93], v81, s[36:39], s66 offen offset:0 sc1
    v_mfma_f32_16x16x32_bf16 v[184:187], a[228:231], a[12:15], v[184:187]
    ds_read_b64_tr_b16 a[224:225], v69 offset:20480
    v_accvgpr_write_b32 a145, v91
    v_mfma_f32_16x16x32_bf16 v[188:191], a[228:231], a[84:87], v[188:191]
    ds_read_b64_tr_b16 a[226:227], v69 offset:22528
    s_waitcnt lgkmcnt(6)
    v_mfma_f32_16x16x32_bf16 v[160:163], a[232:235], a[16:19], v[160:163]
    ds_read_b64_tr_b16 a[228:229], v70 offset:20480
    s_add_u32 m0, s46, 40960
    v_mfma_f32_16x16x32_bf16 v[164:167], a[232:235], a[88:91], v[164:167]
    ds_read_b64_tr_b16 a[230:231], v70 offset:22528
    buffer_load_dwordx4 v20, s[12:15], s73 offen lds
    v_mfma_f32_16x16x32_bf16 v[168:171], a[236:239], a[16:19], v[168:171]
    ds_read_b64_tr_b16 a[232:233], v71 offset:20480
    v_accvgpr_write_b32 a146, v92
    v_mfma_f32_16x16x32_bf16 v[172:175], a[236:239], a[88:91], v[172:175]
    ds_read_b64_tr_b16 a[234:235], v71 offset:22528
    s_waitcnt lgkmcnt(6)
    v_mfma_f32_16x16x32_bf16 v[176:179], a[216:219], a[16:19], v[176:179]
    ds_read_b64_tr_b16 a[236:237], v72 offset:20480
    v_accvgpr_write_b32 a147, v93
    v_mfma_f32_16x16x32_bf16 v[180:183], a[216:219], a[88:91], v[180:183]
    ds_read_b64_tr_b16 a[238:239], v72 offset:22528
    v_mfma_f32_16x16x32_bf16 v[184:187], a[220:223], a[16:19], v[184:187]
    ds_read_b64_tr_b16 a[216:217], v69 offset:24576
    v_cvt_pk_bf16_f32 v94, v132, v133
    v_mfma_f32_16x16x32_bf16 v[188:191], a[220:223], a[88:91], v[188:191]
    ds_read_b64_tr_b16 a[218:219], v69 offset:26624
    s_waitcnt lgkmcnt(6)
    v_mfma_f32_16x16x32_bf16 v[160:163], a[224:227], a[20:23], v[160:163]
    ds_read_b64_tr_b16 a[220:221], v70 offset:24576
    s_add_u32 m0, s46, 41984
    v_mfma_f32_16x16x32_bf16 v[164:167], a[224:227], a[92:95], v[164:167]
    ds_read_b64_tr_b16 a[222:223], v70 offset:26624
    buffer_load_dwordx4 v21, s[12:15], s73 offen lds
    v_mfma_f32_16x16x32_bf16 v[168:171], a[228:231], a[20:23], v[168:171]
    ds_read_b64_tr_b16 a[224:225], v71 offset:24576
    v_cvt_pk_bf16_f32 v95, v134, v135
    v_mfma_f32_16x16x32_bf16 v[172:175], a[228:231], a[92:95], v[172:175]
    ds_read_b64_tr_b16 a[226:227], v71 offset:26624
    s_waitcnt lgkmcnt(6)
    v_mfma_f32_16x16x32_bf16 v[176:179], a[232:235], a[20:23], v[176:179]
    ds_read_b64_tr_b16 a[228:229], v72 offset:24576
    v_pk_max_i16 v94, v94, 0
    v_mfma_f32_16x16x32_bf16 v[180:183], a[232:235], a[92:95], v[180:183]
    ds_read_b64_tr_b16 a[230:231], v72 offset:26624
    v_mfma_f32_16x16x32_bf16 v[184:187], a[236:239], a[20:23], v[184:187]
    ds_read_b64_tr_b16 a[232:233], v69 offset:28672
    v_pk_max_i16 v95, v95, 0
    v_mfma_f32_16x16x32_bf16 v[188:191], a[236:239], a[92:95], v[188:191]
    ds_read_b64_tr_b16 a[234:235], v69 offset:30720
    s_waitcnt lgkmcnt(6)
    v_mfma_f32_16x16x32_bf16 v[160:163], a[216:219], a[24:27], v[160:163]
    ds_read_b64_tr_b16 a[236:237], v70 offset:28672
    s_add_u32 m0, s46, 43008
    v_mfma_f32_16x16x32_bf16 v[164:167], a[216:219], a[96:99], v[164:167]
    ds_read_b64_tr_b16 a[238:239], v70 offset:30720
    buffer_load_dwordx4 v22, s[12:15], s73 offen lds
    v_mfma_f32_16x16x32_bf16 v[168:171], a[220:223], a[24:27], v[168:171]
    ds_read_b64_tr_b16 a[216:217], v71 offset:28672
    v_cvt_pk_bf16_f32 v96, v140, v141
    v_mfma_f32_16x16x32_bf16 v[172:175], a[220:223], a[96:99], v[172:175]
    ds_read_b64_tr_b16 a[218:219], v71 offset:30720
    s_waitcnt lgkmcnt(6)
    v_mfma_f32_16x16x32_bf16 v[176:179], a[224:227], a[24:27], v[176:179]
    ds_read_b64_tr_b16 a[220:221], v72 offset:28672
    v_cvt_pk_bf16_f32 v97, v142, v143
    v_mfma_f32_16x16x32_bf16 v[180:183], a[224:227], a[96:99], v[180:183]
    ds_read_b64_tr_b16 a[222:223], v72 offset:30720
    v_mfma_f32_16x16x32_bf16 v[184:187], a[228:231], a[24:27], v[184:187]
    ds_read_b64_tr_b16 a[224:225], v69 offset:32768
    v_pk_max_i16 v96, v96, 0
    v_mfma_f32_16x16x32_bf16 v[188:191], a[228:231], a[96:99], v[188:191]
    ds_read_b64_tr_b16 a[226:227], v69 offset:34816
    s_waitcnt lgkmcnt(6)
    v_mfma_f32_16x16x32_bf16 v[160:163], a[232:235], a[28:31], v[160:163]
    ds_read_b64_tr_b16 a[228:229], v70 offset:32768
    s_add_u32 m0, s46, 44032
    v_mfma_f32_16x16x32_bf16 v[164:167], a[232:235], a[100:103], v[164:167]
    ds_read_b64_tr_b16 a[230:231], v70 offset:34816
    buffer_load_dwordx4 v23, s[12:15], s73 offen lds
    v_mfma_f32_16x16x32_bf16 v[168:171], a[236:239], a[28:31], v[168:171]
    ds_read_b64_tr_b16 a[232:233], v71 offset:32768
    v_pk_max_i16 v97, v97, 0
    v_mfma_f32_16x16x32_bf16 v[172:175], a[236:239], a[100:103], v[172:175]
    ds_read_b64_tr_b16 a[234:235], v71 offset:34816
    s_waitcnt lgkmcnt(6)
    v_mfma_f32_16x16x32_bf16 v[176:179], a[216:219], a[28:31], v[176:179]
    ds_read_b64_tr_b16 a[236:237], v72 offset:32768
    v_accvgpr_write_b32 a180, v94
    v_mfma_f32_16x16x32_bf16 v[180:183], a[216:219], a[100:103], v[180:183]
    ds_read_b64_tr_b16 a[238:239], v72 offset:34816
    buffer_store_dwordx4 v[94:97], v117, s[36:39], s66 offen offset:1024 sc1
    s_waitcnt vmcnt(19)
    s_barrier
    v_mfma_f32_16x16x32_bf16 v[184:187], a[220:223], a[28:31], v[184:187]
    ds_read_b64_tr_b16 a[216:217], v73 offset:0
    v_accvgpr_write_b32 a181, v95
    v_mfma_f32_16x16x32_bf16 v[188:191], a[220:223], a[100:103], v[188:191]
    ds_read_b64_tr_b16 a[218:219], v73 offset:2048
    s_waitcnt lgkmcnt(6)
    v_mfma_f32_16x16x32_bf16 v[160:163], a[224:227], a[32:35], v[160:163]
    ds_read_b64_tr_b16 a[220:221], v74 offset:0
    s_add_u32 m0, s46, 45056
    v_mfma_f32_16x16x32_bf16 v[164:167], a[224:227], a[104:107], v[164:167]
    ds_read_b64_tr_b16 a[222:223], v74 offset:2048
    buffer_load_dwordx4 v24, s[12:15], s73 offen lds
    v_mfma_f32_16x16x32_bf16 v[168:171], a[228:231], a[32:35], v[168:171]
    ds_read_b64_tr_b16 a[224:225], v75 offset:0
    v_accvgpr_write_b32 a182, v96
    v_mfma_f32_16x16x32_bf16 v[172:175], a[228:231], a[104:107], v[172:175]
    ds_read_b64_tr_b16 a[226:227], v75 offset:2048
    s_waitcnt lgkmcnt(6)
    v_mfma_f32_16x16x32_bf16 v[176:179], a[232:235], a[32:35], v[176:179]
    ds_read_b64_tr_b16 a[228:229], v76 offset:0
    v_accvgpr_write_b32 a183, v97
    v_mfma_f32_16x16x32_bf16 v[180:183], a[232:235], a[104:107], v[180:183]
    ds_read_b64_tr_b16 a[230:231], v76 offset:2048
    v_mfma_f32_16x16x32_bf16 v[184:187], a[236:239], a[32:35], v[184:187]
    ds_read_b64_tr_b16 a[232:233], v73 offset:4096
    s_add_u32 s57, s50, 0x180
    v_mfma_f32_16x16x32_bf16 v[188:191], a[236:239], a[104:107], v[188:191]
    ds_read_b64_tr_b16 a[234:235], v73 offset:6144
    s_barrier
    s_waitcnt lgkmcnt(6)
    v_mfma_f32_16x16x32_bf16 v[160:163], a[216:219], a[36:39], v[160:163]
    ds_read_b64_tr_b16 a[236:237], v74 offset:4096
    s_add_u32 m0, s46, 73728
    v_mfma_f32_16x16x32_bf16 v[164:167], a[216:219], a[108:111], v[164:167]
    ds_read_b64_tr_b16 a[238:239], v74 offset:6144
    buffer_load_dwordx4 v16, s[12:15], s57 offen lds
    v_mfma_f32_16x16x32_bf16 v[168:171], a[220:223], a[36:39], v[168:171]
    ds_read_b64_tr_b16 a[216:217], v75 offset:4096
    v_cvt_pk_bf16_f32 v98, v144, v145
    v_mfma_f32_16x16x32_bf16 v[172:175], a[220:223], a[108:111], v[172:175]
    ds_read_b64_tr_b16 a[218:219], v75 offset:6144
    s_waitcnt lgkmcnt(6)
    v_mfma_f32_16x16x32_bf16 v[176:179], a[224:227], a[36:39], v[176:179]
    ds_read_b64_tr_b16 a[220:221], v76 offset:4096
    v_cvt_pk_bf16_f32 v99, v146, v147
    v_mfma_f32_16x16x32_bf16 v[180:183], a[224:227], a[108:111], v[180:183]
    ds_read_b64_tr_b16 a[222:223], v76 offset:6144
    buffer_store_dwordx4 v[224:227], v116, s[40:43], s71 offen offset:2048 sc1
    v_mfma_f32_16x16x32_bf16 v[184:187], a[228:231], a[36:39], v[184:187]
    ds_read_b64_tr_b16 a[224:225], v73 offset:8192
    v_pk_max_i16 v98, v98, 0
    v_mfma_f32_16x16x32_bf16 v[188:191], a[228:231], a[108:111], v[188:191]
    ds_read_b64_tr_b16 a[226:227], v73 offset:10240
    s_waitcnt lgkmcnt(6)
    v_mfma_f32_16x16x32_bf16 v[160:163], a[232:235], a[40:43], v[160:163]
    ds_read_b64_tr_b16 a[228:229], v74 offset:8192
    s_add_u32 m0, s46, 74752
    v_mfma_f32_16x16x32_bf16 v[164:167], a[232:235], a[112:115], v[164:167]
    ds_read_b64_tr_b16 a[230:231], v74 offset:10240
    buffer_load_dwordx4 v17, s[12:15], s57 offen lds
    v_mfma_f32_16x16x32_bf16 v[168:171], a[236:239], a[40:43], v[168:171]
    ds_read_b64_tr_b16 a[232:233], v75 offset:8192
    v_pk_max_i16 v99, v99, 0
    v_mfma_f32_16x16x32_bf16 v[172:175], a[236:239], a[112:115], v[172:175]
    ds_read_b64_tr_b16 a[234:235], v75 offset:10240
    s_waitcnt lgkmcnt(6)
    v_mfma_f32_16x16x32_bf16 v[176:179], a[216:219], a[40:43], v[176:179]
    ds_read_b64_tr_b16 a[236:237], v76 offset:8192
    v_cvt_pk_bf16_f32 v100, v152, v153
    v_mfma_f32_16x16x32_bf16 v[180:183], a[216:219], a[112:115], v[180:183]
    ds_read_b64_tr_b16 a[238:239], v76 offset:10240
    v_mfma_f32_16x16x32_bf16 v[184:187], a[220:223], a[40:43], v[184:187]
    ds_read_b64_tr_b16 a[216:217], v73 offset:12288
    v_cvt_pk_bf16_f32 v101, v154, v155
    v_mfma_f32_16x16x32_bf16 v[188:191], a[220:223], a[112:115], v[188:191]
    ds_read_b64_tr_b16 a[218:219], v73 offset:14336
    s_waitcnt lgkmcnt(6)
    v_mfma_f32_16x16x32_bf16 v[160:163], a[224:227], a[44:47], v[160:163]
    ds_read_b64_tr_b16 a[220:221], v74 offset:12288
    s_add_u32 m0, s46, 75776
    v_mfma_f32_16x16x32_bf16 v[164:167], a[224:227], a[116:119], v[164:167]
    ds_read_b64_tr_b16 a[222:223], v74 offset:14336
    buffer_load_dwordx4 v18, s[12:15], s57 offen lds
    v_mfma_f32_16x16x32_bf16 v[168:171], a[228:231], a[44:47], v[168:171]
    ds_read_b64_tr_b16 a[224:225], v75 offset:12288
    v_pk_max_i16 v100, v100, 0
    v_mfma_f32_16x16x32_bf16 v[172:175], a[228:231], a[116:119], v[172:175]
    ds_read_b64_tr_b16 a[226:227], v75 offset:14336
    s_waitcnt lgkmcnt(6)
    v_mfma_f32_16x16x32_bf16 v[176:179], a[232:235], a[44:47], v[176:179]
    ds_read_b64_tr_b16 a[228:229], v76 offset:12288
    v_pk_max_i16 v101, v101, 0
    v_mfma_f32_16x16x32_bf16 v[180:183], a[232:235], a[116:119], v[180:183]
    ds_read_b64_tr_b16 a[230:231], v76 offset:14336
    buffer_store_dwordx4 v[98:101], v81, s[36:39], s66 offen offset:1024 sc1
    v_mfma_f32_16x16x32_bf16 v[184:187], a[236:239], a[44:47], v[184:187]
    ds_read_b64_tr_b16 a[232:233], v73 offset:16384
    v_accvgpr_write_b32 a148, v98
    v_mfma_f32_16x16x32_bf16 v[188:191], a[236:239], a[116:119], v[188:191]
    ds_read_b64_tr_b16 a[234:235], v73 offset:18432
    s_waitcnt lgkmcnt(6)
    v_mfma_f32_16x16x32_bf16 v[160:163], a[216:219], a[48:51], v[160:163]
    ds_read_b64_tr_b16 a[236:237], v74 offset:16384
    s_add_u32 m0, s46, 76800
    v_mfma_f32_16x16x32_bf16 v[164:167], a[216:219], a[120:123], v[164:167]
    ds_read_b64_tr_b16 a[238:239], v74 offset:18432
    buffer_load_dwordx4 v19, s[12:15], s57 offen lds
    v_mfma_f32_16x16x32_bf16 v[168:171], a[220:223], a[48:51], v[168:171]
    ds_read_b64_tr_b16 a[216:217], v75 offset:16384
    v_accvgpr_write_b32 a149, v99
    v_mfma_f32_16x16x32_bf16 v[172:175], a[220:223], a[120:123], v[172:175]
    ds_read_b64_tr_b16 a[218:219], v75 offset:18432
    s_waitcnt lgkmcnt(6)
    v_mfma_f32_16x16x32_bf16 v[176:179], a[224:227], a[48:51], v[176:179]
    ds_read_b64_tr_b16 a[220:221], v76 offset:16384
    v_accvgpr_write_b32 a150, v100
    v_mfma_f32_16x16x32_bf16 v[180:183], a[224:227], a[120:123], v[180:183]
    ds_read_b64_tr_b16 a[222:223], v76 offset:18432
    buffer_store_dwordx4 v[224:227], v116, s[40:43], s71 offen offset:3072 sc1
    v_mfma_f32_16x16x32_bf16 v[184:187], a[228:231], a[48:51], v[184:187]
    ds_read_b64_tr_b16 a[224:225], v73 offset:20480
    v_accvgpr_write_b32 a151, v101
    v_mfma_f32_16x16x32_bf16 v[188:191], a[228:231], a[120:123], v[188:191]
    ds_read_b64_tr_b16 a[226:227], v73 offset:22528
    s_waitcnt lgkmcnt(6)
    v_mfma_f32_16x16x32_bf16 v[160:163], a[232:235], a[52:55], v[160:163]
    ds_read_b64_tr_b16 a[228:229], v74 offset:20480
    s_add_u32 m0, s46, 77824
    v_mfma_f32_16x16x32_bf16 v[164:167], a[232:235], a[124:127], v[164:167]
    ds_read_b64_tr_b16 a[230:231], v74 offset:22528
    buffer_load_dwordx4 v20, s[12:15], s57 offen lds
    v_mfma_f32_16x16x32_bf16 v[168:171], a[236:239], a[52:55], v[168:171]
    ds_read_b64_tr_b16 a[232:233], v75 offset:20480
    v_cvt_pk_bf16_f32 v102, v148, v149
    v_mfma_f32_16x16x32_bf16 v[172:175], a[236:239], a[124:127], v[172:175]
    ds_read_b64_tr_b16 a[234:235], v75 offset:22528
    s_waitcnt lgkmcnt(6)
    v_mfma_f32_16x16x32_bf16 v[176:179], a[216:219], a[52:55], v[176:179]
    ds_read_b64_tr_b16 a[236:237], v76 offset:20480
    v_cvt_pk_bf16_f32 v103, v150, v151
    v_mfma_f32_16x16x32_bf16 v[180:183], a[216:219], a[124:127], v[180:183]
    ds_read_b64_tr_b16 a[238:239], v76 offset:22528
    ds_read_b32 a240, v88 offset:256
    v_mfma_f32_16x16x32_bf16 v[184:187], a[220:223], a[52:55], v[184:187]
    ds_read_b64_tr_b16 a[216:217], v73 offset:24576
    v_pk_max_i16 v102, v102, 0
    v_mfma_f32_16x16x32_bf16 v[188:191], a[220:223], a[124:127], v[188:191]
    ds_read_b64_tr_b16 a[218:219], v73 offset:26624
    s_waitcnt lgkmcnt(7)
    v_mfma_f32_16x16x32_bf16 v[160:163], a[224:227], a[56:59], v[160:163]
    ds_read_b64_tr_b16 a[220:221], v74 offset:24576
    s_add_u32 m0, s46, 78848
    v_mfma_f32_16x16x32_bf16 v[164:167], a[224:227], a[128:131], v[164:167]
    ds_read_b64_tr_b16 a[222:223], v74 offset:26624
    buffer_load_dwordx4 v21, s[12:15], s57 offen lds
    v_mfma_f32_16x16x32_bf16 v[168:171], a[228:231], a[56:59], v[168:171]
    ds_read_b64_tr_b16 a[224:225], v75 offset:24576
    v_pk_max_i16 v103, v103, 0
    v_mfma_f32_16x16x32_bf16 v[172:175], a[228:231], a[128:131], v[172:175]
    ds_read_b64_tr_b16 a[226:227], v75 offset:26624
    s_waitcnt lgkmcnt(7)
    v_mfma_f32_16x16x32_bf16 v[176:179], a[232:235], a[56:59], v[176:179]
    ds_read_b64_tr_b16 a[228:229], v76 offset:24576
    v_cvt_pk_bf16_f32 v104, v156, v157
    v_mfma_f32_16x16x32_bf16 v[180:183], a[232:235], a[128:131], v[180:183]
    ds_read_b64_tr_b16 a[230:231], v76 offset:26624
    ds_read_b32 a244, v88 offset:320
    v_mfma_f32_16x16x32_bf16 v[184:187], a[236:239], a[56:59], v[184:187]
    ds_read_b64_tr_b16 a[232:233], v73 offset:28672
    v_cvt_pk_bf16_f32 v105, v158, v159
    v_mfma_f32_16x16x32_bf16 v[188:191], a[236:239], a[128:131], v[188:191]
    ds_read_b64_tr_b16 a[234:235], v73 offset:30720
    s_waitcnt lgkmcnt(7)
    v_mfma_f32_16x16x32_bf16 v[160:163], a[216:219], a[60:63], v[160:163]
    ds_read_b64_tr_b16 a[236:237], v74 offset:28672
    s_add_u32 m0, s46, 79872
    v_mfma_f32_16x16x32_bf16 v[164:167], a[216:219], a[132:135], v[164:167]
    ds_read_b64_tr_b16 a[238:239], v74 offset:30720
    buffer_load_dwordx4 v22, s[12:15], s57 offen lds
    v_mfma_f32_16x16x32_bf16 v[168:171], a[220:223], a[60:63], v[168:171]
    ds_read_b64_tr_b16 a[216:217], v75 offset:28672
    v_pk_max_i16 v104, v104, 0
    v_mfma_f32_16x16x32_bf16 v[172:175], a[220:223], a[132:135], v[172:175]
    ds_read_b64_tr_b16 a[218:219], v75 offset:30720
    s_waitcnt lgkmcnt(7)
    v_mfma_f32_16x16x32_bf16 v[176:179], a[224:227], a[60:63], v[176:179]
    ds_read_b64_tr_b16 a[220:221], v76 offset:28672
    v_pk_max_i16 v105, v105, 0
    v_mfma_f32_16x16x32_bf16 v[180:183], a[224:227], a[132:135], v[180:183]
    ds_read_b64_tr_b16 a[222:223], v76 offset:30720
    ds_read_b32 a248, v88 offset:384
    v_mfma_f32_16x16x32_bf16 v[184:187], a[228:231], a[60:63], v[184:187]
    ds_read_b64_tr_b16 a[224:225], v73 offset:32768
    v_accvgpr_write_b32 a184, v102
    v_mfma_f32_16x16x32_bf16 v[188:191], a[228:231], a[132:135], v[188:191]
    ds_read_b64_tr_b16 a[226:227], v73 offset:34816
    s_waitcnt lgkmcnt(7)
    v_mfma_f32_16x16x32_bf16 v[160:163], a[232:235], a[64:67], v[160:163]
    ds_read_b64_tr_b16 a[228:229], v74 offset:32768
    s_add_u32 m0, s46, 80896
    v_mfma_f32_16x16x32_bf16 v[164:167], a[232:235], a[136:139], v[164:167]
    ds_read_b64_tr_b16 a[230:231], v74 offset:34816
    buffer_load_dwordx4 v23, s[12:15], s57 offen lds
    v_mfma_f32_16x16x32_bf16 v[168:171], a[236:239], a[64:67], v[168:171]
    ds_read_b64_tr_b16 a[232:233], v75 offset:32768
    v_accvgpr_write_b32 a185, v103
    v_mfma_f32_16x16x32_bf16 v[172:175], a[236:239], a[136:139], v[172:175]
    ds_read_b64_tr_b16 a[234:235], v75 offset:34816
    s_waitcnt lgkmcnt(7)
    v_mfma_f32_16x16x32_bf16 v[176:179], a[216:219], a[64:67], v[176:179]
    ds_read_b64_tr_b16 a[236:237], v76 offset:32768
    v_accvgpr_write_b32 a186, v104
    v_mfma_f32_16x16x32_bf16 v[180:183], a[216:219], a[136:139], v[180:183]
    ds_read_b64_tr_b16 a[238:239], v76 offset:34816
    ds_read_b32 a252, v88 offset:448
    s_waitcnt vmcnt(22)
    s_barrier
    v_mfma_f32_16x16x32_bf16 v[184:187], a[220:223], a[64:67], v[184:187]
    ds_read_b64_tr_b16 a[216:217], v61 offset:0
    v_accvgpr_write_b32 a187, v105
    v_mfma_f32_16x16x32_bf16 v[188:191], a[220:223], a[136:139], v[188:191]
    ds_read_b64_tr_b16 a[218:219], v61 offset:2048
    s_waitcnt lgkmcnt(7)
    v_mfma_f32_16x16x32_bf16 v[160:163], a[224:227], a[68:71], v[160:163]
    ds_read_b64_tr_b16 a[220:221], v62 offset:0
    s_add_u32 m0, s46, 81920
    v_mfma_f32_16x16x32_bf16 v[164:167], a[224:227], a[140:143], v[164:167]
    ds_read_b64_tr_b16 a[222:223], v62 offset:2048
    buffer_load_dwordx4 v24, s[12:15], s57 offen lds
    v_mfma_f32_16x16x32_bf16 v[168:171], a[228:231], a[68:71], v[168:171]
    ds_read_b64_tr_b16 a[224:225], v63 offset:0
    v_mfma_f32_16x16x32_bf16 v[172:175], a[228:231], a[140:143], v[172:175]
    ds_read_b64_tr_b16 a[226:227], v63 offset:2048
    s_waitcnt lgkmcnt(7)
    v_mfma_f32_16x16x32_bf16 v[176:179], a[232:235], a[68:71], v[176:179]
    ds_read_b64_tr_b16 a[228:229], v64 offset:0
    v_mfma_f32_16x16x32_bf16 v[180:183], a[232:235], a[140:143], v[180:183]
    ds_read_b64_tr_b16 a[230:231], v64 offset:2048
    buffer_store_dwordx4 v[102:105], v117, s[36:39], s66 offen offset:2048 sc1
    v_mfma_f32_16x16x32_bf16 v[184:187], a[236:239], a[68:71], v[184:187]
    ds_read_b64_tr_b16 a[232:233], v61 offset:4096
    s_add_u32 s73, s50, 0x288180
    v_mfma_f32_16x16x32_bf16 v[188:191], a[236:239], a[140:143], v[188:191]
    ds_read_b64_tr_b16 a[234:235], v61 offset:6144
    v_mfma_f32_16x16x32_bf16 v[160:163], a[240:243], v[108:111], v[160:163]
    v_mfma_f32_16x16x32_bf16 v[164:167], a[240:243], v[112:115], v[164:167]
    v_mfma_f32_16x16x32_bf16 v[168:171], a[244:247], v[108:111], v[168:171]
    v_mfma_f32_16x16x32_bf16 v[172:175], a[244:247], v[112:115], v[172:175]
    v_mfma_f32_16x16x32_bf16 v[176:179], a[248:251], v[108:111], v[176:179]
    v_mfma_f32_16x16x32_bf16 v[180:183], a[248:251], v[112:115], v[180:183]
    s_waitcnt lgkmcnt(10)
    v_mfma_f32_16x16x32_bf16 v[184:187], a[252:255], v[108:111], v[184:187]
    v_mfma_f32_16x16x32_bf16 v[188:191], a[252:255], v[112:115], v[188:191]
    s_barrier
    s_waitcnt lgkmcnt(6)
    v_mfma_f32_16x16x32_bf16 v[128:131], a[216:219], a[0:3], 0
    ds_read_b64_tr_b16 a[236:237], v62 offset:4096
    s_add_u32 m0, s46, 110592
    v_mfma_f32_16x16x32_bf16 v[132:135], a[216:219], a[72:75], 0
    ds_read_b64_tr_b16 a[238:239], v62 offset:6144
    buffer_load_dwordx4 v16, s[12:15], s73 offen lds
    v_mfma_f32_16x16x32_bf16 v[136:139], a[220:223], a[0:3], 0
    ds_read_b64_tr_b16 a[216:217], v63 offset:4096
    v_mfma_f32_16x16x32_bf16 v[140:143], a[220:223], a[72:75], 0
    ds_read_b64_tr_b16 a[218:219], v63 offset:6144
    s_waitcnt lgkmcnt(6)
    v_mfma_f32_16x16x32_bf16 v[144:147], a[224:227], a[0:3], 0
    ds_read_b64_tr_b16 a[220:221], v64 offset:4096
    v_mfma_f32_16x16x32_bf16 v[148:151], a[224:227], a[72:75], 0
    ds_read_b64_tr_b16 a[222:223], v64 offset:6144
    buffer_store_dwordx4 v[224:227], v81, s[40:43], s72 offen offset:0 sc1
    v_mfma_f32_16x16x32_bf16 v[152:155], a[228:231], a[0:3], 0
    ds_read_b64_tr_b16 a[224:225], v61 offset:8192
    v_cvt_pk_bf16_f32 v90, v160, v161
    v_mfma_f32_16x16x32_bf16 v[156:159], a[228:231], a[72:75], 0
    ds_read_b64_tr_b16 a[226:227], v61 offset:10240
    s_waitcnt lgkmcnt(6)
    v_mfma_f32_16x16x32_bf16 v[128:131], a[232:235], a[4:7], v[128:131]
    ds_read_b64_tr_b16 a[228:229], v62 offset:8192
    s_add_u32 m0, s46, 111616
    v_mfma_f32_16x16x32_bf16 v[132:135], a[232:235], a[76:79], v[132:135]
    ds_read_b64_tr_b16 a[230:231], v62 offset:10240
    buffer_load_dwordx4 v17, s[12:15], s73 offen lds
    v_mfma_f32_16x16x32_bf16 v[136:139], a[236:239], a[4:7], v[136:139]
    ds_read_b64_tr_b16 a[232:233], v63 offset:8192
    v_cvt_pk_bf16_f32 v91, v162, v163
    v_mfma_f32_16x16x32_bf16 v[140:143], a[236:239], a[76:79], v[140:143]
    ds_read_b64_tr_b16 a[234:235], v63 offset:10240
    s_waitcnt lgkmcnt(6)
    v_mfma_f32_16x16x32_bf16 v[144:147], a[216:219], a[4:7], v[144:147]
    ds_read_b64_tr_b16 a[236:237], v64 offset:8192
    v_pk_max_i16 v90, v90, 0
    v_mfma_f32_16x16x32_bf16 v[148:151], a[216:219], a[76:79], v[148:151]
    ds_read_b64_tr_b16 a[238:239], v64 offset:10240
    v_mfma_f32_16x16x32_bf16 v[152:155], a[220:223], a[4:7], v[152:155]
    ds_read_b64_tr_b16 a[216:217], v61 offset:12288
    v_pk_max_i16 v91, v91, 0
    v_mfma_f32_16x16x32_bf16 v[156:159], a[220:223], a[76:79], v[156:159]
    ds_read_b64_tr_b16 a[218:219], v61 offset:14336
    s_waitcnt lgkmcnt(6)
    v_mfma_f32_16x16x32_bf16 v[128:131], a[224:227], a[8:11], v[128:131]
    ds_read_b64_tr_b16 a[220:221], v62 offset:12288
    s_add_u32 m0, s46, 112640
    v_mfma_f32_16x16x32_bf16 v[132:135], a[224:227], a[80:83], v[132:135]
    ds_read_b64_tr_b16 a[222:223], v62 offset:14336
    buffer_load_dwordx4 v18, s[12:15], s73 offen lds
    v_mfma_f32_16x16x32_bf16 v[136:139], a[228:231], a[8:11], v[136:139]
    ds_read_b64_tr_b16 a[224:225], v63 offset:12288
    v_cvt_pk_bf16_f32 v92, v168, v169
    v_mfma_f32_16x16x32_bf16 v[140:143], a[228:231], a[80:83], v[140:143]
    ds_read_b64_tr_b16 a[226:227], v63 offset:14336
    s_waitcnt lgkmcnt(6)
    v_mfma_f32_16x16x32_bf16 v[144:147], a[232:235], a[8:11], v[144:147]
    ds_read_b64_tr_b16 a[228:229], v64 offset:12288
    v_cvt_pk_bf16_f32 v93, v170, v171
    v_mfma_f32_16x16x32_bf16 v[148:151], a[232:235], a[80:83], v[148:151]
    ds_read_b64_tr_b16 a[230:231], v64 offset:14336
    v_mfma_f32_16x16x32_bf16 v[152:155], a[236:239], a[8:11], v[152:155]
    ds_read_b64_tr_b16 a[232:233], v61 offset:16384
    v_pk_max_i16 v92, v92, 0
    v_mfma_f32_16x16x32_bf16 v[156:159], a[236:239], a[80:83], v[156:159]
    ds_read_b64_tr_b16 a[234:235], v61 offset:18432
    s_waitcnt lgkmcnt(6)
    v_mfma_f32_16x16x32_bf16 v[128:131], a[216:219], a[12:15], v[128:131]
    ds_read_b64_tr_b16 a[236:237], v62 offset:16384
    s_add_u32 m0, s46, 113664
    v_mfma_f32_16x16x32_bf16 v[132:135], a[216:219], a[84:87], v[132:135]
    ds_read_b64_tr_b16 a[238:239], v62 offset:18432
    buffer_load_dwordx4 v19, s[12:15], s73 offen lds
    v_mfma_f32_16x16x32_bf16 v[136:139], a[220:223], a[12:15], v[136:139]
    ds_read_b64_tr_b16 a[216:217], v63 offset:16384
    v_pk_max_i16 v93, v93, 0
    v_mfma_f32_16x16x32_bf16 v[140:143], a[220:223], a[84:87], v[140:143]
    ds_read_b64_tr_b16 a[218:219], v63 offset:18432
    s_waitcnt lgkmcnt(6)
    v_mfma_f32_16x16x32_bf16 v[144:147], a[224:227], a[12:15], v[144:147]
    ds_read_b64_tr_b16 a[220:221], v64 offset:16384
    v_accvgpr_write_b32 a152, v90
    v_mfma_f32_16x16x32_bf16 v[148:151], a[224:227], a[84:87], v[148:151]
    ds_read_b64_tr_b16 a[222:223], v64 offset:18432
    buffer_store_dwordx4 v[90:93], v81, s[36:39], s66 offen offset:2048 sc1
    v_mfma_f32_16x16x32_bf16 v[152:155], a[228:231], a[12:15], v[152:155]
    ds_read_b64_tr_b16 a[224:225], v61 offset:20480
    v_accvgpr_write_b32 a153, v91
    v_mfma_f32_16x16x32_bf16 v[156:159], a[228:231], a[84:87], v[156:159]
    ds_read_b64_tr_b16 a[226:227], v61 offset:22528
    s_waitcnt lgkmcnt(6)
    v_mfma_f32_16x16x32_bf16 v[128:131], a[232:235], a[16:19], v[128:131]
    ds_read_b64_tr_b16 a[228:229], v62 offset:20480
    s_add_u32 m0, s46, 114688
    v_mfma_f32_16x16x32_bf16 v[132:135], a[232:235], a[88:91], v[132:135]
    ds_read_b64_tr_b16 a[230:231], v62 offset:22528
    buffer_load_dwordx4 v20, s[12:15], s73 offen lds
    v_mfma_f32_16x16x32_bf16 v[136:139], a[236:239], a[16:19], v[136:139]
    ds_read_b64_tr_b16 a[232:233], v63 offset:20480
    v_accvgpr_write_b32 a154, v92
    v_mfma_f32_16x16x32_bf16 v[140:143], a[236:239], a[88:91], v[140:143]
    ds_read_b64_tr_b16 a[234:235], v63 offset:22528
    s_waitcnt lgkmcnt(6)
    v_mfma_f32_16x16x32_bf16 v[144:147], a[216:219], a[16:19], v[144:147]
    ds_read_b64_tr_b16 a[236:237], v64 offset:20480
    v_accvgpr_write_b32 a155, v93
    v_mfma_f32_16x16x32_bf16 v[148:151], a[216:219], a[88:91], v[148:151]
    ds_read_b64_tr_b16 a[238:239], v64 offset:22528
    v_mfma_f32_16x16x32_bf16 v[152:155], a[220:223], a[16:19], v[152:155]
    ds_read_b64_tr_b16 a[216:217], v61 offset:24576
    v_cvt_pk_bf16_f32 v94, v164, v165
    v_mfma_f32_16x16x32_bf16 v[156:159], a[220:223], a[88:91], v[156:159]
    ds_read_b64_tr_b16 a[218:219], v61 offset:26624
    s_waitcnt lgkmcnt(6)
    v_mfma_f32_16x16x32_bf16 v[128:131], a[224:227], a[20:23], v[128:131]
    ds_read_b64_tr_b16 a[220:221], v62 offset:24576
    s_add_u32 m0, s46, 115712
    v_mfma_f32_16x16x32_bf16 v[132:135], a[224:227], a[92:95], v[132:135]
    ds_read_b64_tr_b16 a[222:223], v62 offset:26624
    buffer_load_dwordx4 v21, s[12:15], s73 offen lds
    v_mfma_f32_16x16x32_bf16 v[136:139], a[228:231], a[20:23], v[136:139]
    ds_read_b64_tr_b16 a[224:225], v63 offset:24576
    v_cvt_pk_bf16_f32 v95, v166, v167
    v_mfma_f32_16x16x32_bf16 v[140:143], a[228:231], a[92:95], v[140:143]
    ds_read_b64_tr_b16 a[226:227], v63 offset:26624
    s_waitcnt lgkmcnt(6)
    v_mfma_f32_16x16x32_bf16 v[144:147], a[232:235], a[20:23], v[144:147]
    ds_read_b64_tr_b16 a[228:229], v64 offset:24576
    v_pk_max_i16 v94, v94, 0
    v_mfma_f32_16x16x32_bf16 v[148:151], a[232:235], a[92:95], v[148:151]
    ds_read_b64_tr_b16 a[230:231], v64 offset:26624
    v_mfma_f32_16x16x32_bf16 v[152:155], a[236:239], a[20:23], v[152:155]
    ds_read_b64_tr_b16 a[232:233], v61 offset:28672
    v_pk_max_i16 v95, v95, 0
    v_mfma_f32_16x16x32_bf16 v[156:159], a[236:239], a[92:95], v[156:159]
    ds_read_b64_tr_b16 a[234:235], v61 offset:30720
    s_waitcnt lgkmcnt(6)
    v_mfma_f32_16x16x32_bf16 v[128:131], a[216:219], a[24:27], v[128:131]
    ds_read_b64_tr_b16 a[236:237], v62 offset:28672
    s_add_u32 m0, s46, 116736
    v_mfma_f32_16x16x32_bf16 v[132:135], a[216:219], a[96:99], v[132:135]
    ds_read_b64_tr_b16 a[238:239], v62 offset:30720
    buffer_load_dwordx4 v22, s[12:15], s73 offen lds
    v_mfma_f32_16x16x32_bf16 v[136:139], a[220:223], a[24:27], v[136:139]
    ds_read_b64_tr_b16 a[216:217], v63 offset:28672
    v_cvt_pk_bf16_f32 v96, v172, v173
    v_mfma_f32_16x16x32_bf16 v[140:143], a[220:223], a[96:99], v[140:143]
    ds_read_b64_tr_b16 a[218:219], v63 offset:30720
    s_waitcnt lgkmcnt(6)
    v_mfma_f32_16x16x32_bf16 v[144:147], a[224:227], a[24:27], v[144:147]
    ds_read_b64_tr_b16 a[220:221], v64 offset:28672
    v_cvt_pk_bf16_f32 v97, v174, v175
    v_mfma_f32_16x16x32_bf16 v[148:151], a[224:227], a[96:99], v[148:151]
    ds_read_b64_tr_b16 a[222:223], v64 offset:30720
    v_mfma_f32_16x16x32_bf16 v[152:155], a[228:231], a[24:27], v[152:155]
    ds_read_b64_tr_b16 a[224:225], v61 offset:32768
    v_pk_max_i16 v96, v96, 0
    v_mfma_f32_16x16x32_bf16 v[156:159], a[228:231], a[96:99], v[156:159]
    ds_read_b64_tr_b16 a[226:227], v61 offset:34816
    s_waitcnt lgkmcnt(6)
    v_mfma_f32_16x16x32_bf16 v[128:131], a[232:235], a[28:31], v[128:131]
    ds_read_b64_tr_b16 a[228:229], v62 offset:32768
    s_add_u32 m0, s46, 117760
    v_mfma_f32_16x16x32_bf16 v[132:135], a[232:235], a[100:103], v[132:135]
    ds_read_b64_tr_b16 a[230:231], v62 offset:34816
    buffer_load_dwordx4 v23, s[12:15], s73 offen lds
    v_mfma_f32_16x16x32_bf16 v[136:139], a[236:239], a[28:31], v[136:139]
    ds_read_b64_tr_b16 a[232:233], v63 offset:32768
    v_pk_max_i16 v97, v97, 0
    v_mfma_f32_16x16x32_bf16 v[140:143], a[236:239], a[100:103], v[140:143]
    ds_read_b64_tr_b16 a[234:235], v63 offset:34816
    s_waitcnt lgkmcnt(6)
    v_mfma_f32_16x16x32_bf16 v[144:147], a[216:219], a[28:31], v[144:147]
    ds_read_b64_tr_b16 a[236:237], v64 offset:32768
    v_accvgpr_write_b32 a188, v94
    v_mfma_f32_16x16x32_bf16 v[148:151], a[216:219], a[100:103], v[148:151]
    ds_read_b64_tr_b16 a[238:239], v64 offset:34816
    buffer_store_dwordx4 v[94:97], v117, s[36:39], s66 offen offset:3072 sc1
    s_waitcnt vmcnt(24)
    s_barrier
    v_mfma_f32_16x16x32_bf16 v[152:155], a[220:223], a[28:31], v[152:155]
    ds_read_b64_tr_b16 a[216:217], v65 offset:0
    v_accvgpr_write_b32 a189, v95
    v_mfma_f32_16x16x32_bf16 v[156:159], a[220:223], a[100:103], v[156:159]
    ds_read_b64_tr_b16 a[218:219], v65 offset:2048
    s_waitcnt lgkmcnt(6)
    v_mfma_f32_16x16x32_bf16 v[128:131], a[224:227], a[32:35], v[128:131]
    ds_read_b64_tr_b16 a[220:221], v66 offset:0
    s_add_u32 m0, s46, 118784
    v_mfma_f32_16x16x32_bf16 v[132:135], a[224:227], a[104:107], v[132:135]
    ds_read_b64_tr_b16 a[222:223], v66 offset:2048
    buffer_load_dwordx4 v24, s[12:15], s73 offen lds
    v_mfma_f32_16x16x32_bf16 v[136:139], a[228:231], a[32:35], v[136:139]
    ds_read_b64_tr_b16 a[224:225], v67 offset:0
    v_accvgpr_write_b32 a190, v96
    v_mfma_f32_16x16x32_bf16 v[140:143], a[228:231], a[104:107], v[140:143]
    ds_read_b64_tr_b16 a[226:227], v67 offset:2048
    s_waitcnt lgkmcnt(6)
    v_mfma_f32_16x16x32_bf16 v[144:147], a[232:235], a[32:35], v[144:147]
    ds_read_b64_tr_b16 a[228:229], v68 offset:0
    v_accvgpr_write_b32 a191, v97
    v_mfma_f32_16x16x32_bf16 v[148:151], a[232:235], a[104:107], v[148:151]
    ds_read_b64_tr_b16 a[230:231], v68 offset:2048
    v_mfma_f32_16x16x32_bf16 v[152:155], a[236:239], a[32:35], v[152:155]
    ds_read_b64_tr_b16 a[232:233], v65 offset:4096
    s_add_u32 s57, s51, 0x0
    v_mfma_f32_16x16x32_bf16 v[156:159], a[236:239], a[104:107], v[156:159]
    ds_read_b64_tr_b16 a[234:235], v65 offset:6144
    s_barrier
    s_waitcnt lgkmcnt(6)
    v_mfma_f32_16x16x32_bf16 v[128:131], a[216:219], a[36:39], v[128:131]
    ds_read_b64_tr_b16 a[236:237], v66 offset:4096
    s_add_u32 m0, s46, 0
    v_mfma_f32_16x16x32_bf16 v[132:135], a[216:219], a[108:111], v[132:135]
    ds_read_b64_tr_b16 a[238:239], v66 offset:6144
    buffer_load_dwordx4 v25, s[12:15], s57 offen lds
    v_mfma_f32_16x16x32_bf16 v[136:139], a[220:223], a[36:39], v[136:139]
    ds_read_b64_tr_b16 a[216:217], v67 offset:4096
    v_cvt_pk_bf16_f32 v98, v176, v177
    v_mfma_f32_16x16x32_bf16 v[140:143], a[220:223], a[108:111], v[140:143]
    ds_read_b64_tr_b16 a[218:219], v67 offset:6144
    s_waitcnt lgkmcnt(6)
    v_mfma_f32_16x16x32_bf16 v[144:147], a[224:227], a[36:39], v[144:147]
    ds_read_b64_tr_b16 a[220:221], v68 offset:4096
    v_cvt_pk_bf16_f32 v99, v178, v179
    v_mfma_f32_16x16x32_bf16 v[148:151], a[224:227], a[108:111], v[148:151]
    ds_read_b64_tr_b16 a[222:223], v68 offset:6144
    buffer_store_dwordx4 v[224:227], v125, s[40:43], s71 offen offset:0 sc1
    v_mfma_f32_16x16x32_bf16 v[152:155], a[228:231], a[36:39], v[152:155]
    ds_read_b64_tr_b16 a[224:225], v65 offset:8192
    v_pk_max_i16 v98, v98, 0
    v_mfma_f32_16x16x32_bf16 v[156:159], a[228:231], a[108:111], v[156:159]
    ds_read_b64_tr_b16 a[226:227], v65 offset:10240
    s_waitcnt lgkmcnt(6)
    v_mfma_f32_16x16x32_bf16 v[128:131], a[232:235], a[40:43], v[128:131]
    ds_read_b64_tr_b16 a[228:229], v66 offset:8192
    s_add_u32 m0, s46, 1024
    v_mfma_f32_16x16x32_bf16 v[132:135], a[232:235], a[112:115], v[132:135]
    ds_read_b64_tr_b16 a[230:231], v66 offset:10240
    buffer_load_dwordx4 v26, s[12:15], s57 offen lds
    v_mfma_f32_16x16x32_bf16 v[136:139], a[236:239], a[40:43], v[136:139]
    ds_read_b64_tr_b16 a[232:233], v67 offset:8192
    v_pk_max_i16 v99, v99, 0
    v_mfma_f32_16x16x32_bf16 v[140:143], a[236:239], a[112:115], v[140:143]
    ds_read_b64_tr_b16 a[234:235], v67 offset:10240
    s_waitcnt lgkmcnt(6)
    v_mfma_f32_16x16x32_bf16 v[144:147], a[216:219], a[40:43], v[144:147]
    ds_read_b64_tr_b16 a[236:237], v68 offset:8192
    v_cvt_pk_bf16_f32 v100, v184, v185
    v_mfma_f32_16x16x32_bf16 v[148:151], a[216:219], a[112:115], v[148:151]
    ds_read_b64_tr_b16 a[238:239], v68 offset:10240
    v_mfma_f32_16x16x32_bf16 v[152:155], a[220:223], a[40:43], v[152:155]
    ds_read_b64_tr_b16 a[216:217], v65 offset:12288
    v_cvt_pk_bf16_f32 v101, v186, v187
    v_mfma_f32_16x16x32_bf16 v[156:159], a[220:223], a[112:115], v[156:159]
    ds_read_b64_tr_b16 a[218:219], v65 offset:14336
    s_waitcnt lgkmcnt(6)
    v_mfma_f32_16x16x32_bf16 v[128:131], a[224:227], a[44:47], v[128:131]
    ds_read_b64_tr_b16 a[220:221], v66 offset:12288
    s_add_u32 m0, s46, 2048
    v_mfma_f32_16x16x32_bf16 v[132:135], a[224:227], a[116:119], v[132:135]
    ds_read_b64_tr_b16 a[222:223], v66 offset:14336
    buffer_load_dwordx4 v27, s[12:15], s57 offen lds
    v_mfma_f32_16x16x32_bf16 v[136:139], a[228:231], a[44:47], v[136:139]
    ds_read_b64_tr_b16 a[224:225], v67 offset:12288
    v_pk_max_i16 v100, v100, 0
    v_mfma_f32_16x16x32_bf16 v[140:143], a[228:231], a[116:119], v[140:143]
    ds_read_b64_tr_b16 a[226:227], v67 offset:14336
    s_waitcnt lgkmcnt(6)
    v_mfma_f32_16x16x32_bf16 v[144:147], a[232:235], a[44:47], v[144:147]
    ds_read_b64_tr_b16 a[228:229], v68 offset:12288
    v_pk_max_i16 v101, v101, 0
    v_mfma_f32_16x16x32_bf16 v[148:151], a[232:235], a[116:119], v[148:151]
    ds_read_b64_tr_b16 a[230:231], v68 offset:14336
    buffer_store_dwordx4 v[98:101], v81, s[36:39], s66 offen offset:3072 sc1
    v_mfma_f32_16x16x32_bf16 v[152:155], a[236:239], a[44:47], v[152:155]
    ds_read_b64_tr_b16 a[232:233], v65 offset:16384
    v_accvgpr_write_b32 a156, v98
    v_mfma_f32_16x16x32_bf16 v[156:159], a[236:239], a[116:119], v[156:159]
    ds_read_b64_tr_b16 a[234:235], v65 offset:18432
    s_waitcnt lgkmcnt(6)
    v_mfma_f32_16x16x32_bf16 v[128:131], a[216:219], a[48:51], v[128:131]
    ds_read_b64_tr_b16 a[236:237], v66 offset:16384
    s_add_u32 m0, s46, 3072
    v_mfma_f32_16x16x32_bf16 v[132:135], a[216:219], a[120:123], v[132:135]
    ds_read_b64_tr_b16 a[238:239], v66 offset:18432
    buffer_load_dwordx4 v28, s[12:15], s57 offen lds
    v_mfma_f32_16x16x32_bf16 v[136:139], a[220:223], a[48:51], v[136:139]
    ds_read_b64_tr_b16 a[216:217], v67 offset:16384
    v_accvgpr_write_b32 a157, v99
    v_mfma_f32_16x16x32_bf16 v[140:143], a[220:223], a[120:123], v[140:143]
    ds_read_b64_tr_b16 a[218:219], v67 offset:18432
    s_waitcnt lgkmcnt(6)
    v_mfma_f32_16x16x32_bf16 v[144:147], a[224:227], a[48:51], v[144:147]
    ds_read_b64_tr_b16 a[220:221], v68 offset:16384
    v_accvgpr_write_b32 a158, v100
    v_mfma_f32_16x16x32_bf16 v[148:151], a[224:227], a[120:123], v[148:151]
    ds_read_b64_tr_b16 a[222:223], v68 offset:18432
    buffer_store_dwordx4 v[224:227], v125, s[40:43], s71 offen offset:1024 sc1
    v_mfma_f32_16x16x32_bf16 v[152:155], a[228:231], a[48:51], v[152:155]
    ds_read_b64_tr_b16 a[224:225], v65 offset:20480
    v_accvgpr_write_b32 a159, v101
    v_mfma_f32_16x16x32_bf16 v[156:159], a[228:231], a[120:123], v[156:159]
    ds_read_b64_tr_b16 a[226:227], v65 offset:22528
    s_waitcnt lgkmcnt(6)
    v_mfma_f32_16x16x32_bf16 v[128:131], a[232:235], a[52:55], v[128:131]
    ds_read_b64_tr_b16 a[228:229], v66 offset:20480
    s_add_u32 m0, s46, 4096
    v_mfma_f32_16x16x32_bf16 v[132:135], a[232:235], a[124:127], v[132:135]
    ds_read_b64_tr_b16 a[230:231], v66 offset:22528
    buffer_load_dwordx4 v29, s[12:15], s57 offen lds
    v_mfma_f32_16x16x32_bf16 v[136:139], a[236:239], a[52:55], v[136:139]
    ds_read_b64_tr_b16 a[232:233], v67 offset:20480
    v_cvt_pk_bf16_f32 v102, v180, v181
    v_mfma_f32_16x16x32_bf16 v[140:143], a[236:239], a[124:127], v[140:143]
    ds_read_b64_tr_b16 a[234:235], v67 offset:22528
    s_waitcnt lgkmcnt(6)
    v_mfma_f32_16x16x32_bf16 v[144:147], a[216:219], a[52:55], v[144:147]
    ds_read_b64_tr_b16 a[236:237], v68 offset:20480
    v_cvt_pk_bf16_f32 v103, v182, v183
    v_mfma_f32_16x16x32_bf16 v[148:151], a[216:219], a[124:127], v[148:151]
    ds_read_b64_tr_b16 a[238:239], v68 offset:22528
    ds_read_b32 a240, v88 offset:512
    v_mfma_f32_16x16x32_bf16 v[152:155], a[220:223], a[52:55], v[152:155]
    ds_read_b64_tr_b16 a[216:217], v65 offset:24576
    v_pk_max_i16 v102, v102, 0
    v_mfma_f32_16x16x32_bf16 v[156:159], a[220:223], a[124:127], v[156:159]
    ds_read_b64_tr_b16 a[218:219], v65 offset:26624
    s_waitcnt lgkmcnt(7)
    v_mfma_f32_16x16x32_bf16 v[128:131], a[224:227], a[56:59], v[128:131]
    ds_read_b64_tr_b16 a[220:221], v66 offset:24576
    s_add_u32 m0, s46, 5120
    v_mfma_f32_16x16x32_bf16 v[132:135], a[224:227], a[128:131], v[132:135]
    ds_read_b64_tr_b16 a[222:223], v66 offset:26624
    buffer_load_dwordx4 v30, s[12:15], s57 offen lds
    v_mfma_f32_16x16x32_bf16 v[136:139], a[228:231], a[56:59], v[136:139]
    ds_read_b64_tr_b16 a[224:225], v67 offset:24576
    v_pk_max_i16 v103, v103, 0
    v_mfma_f32_16x16x32_bf16 v[140:143], a[228:231], a[128:131], v[140:143]
    ds_read_b64_tr_b16 a[226:227], v67 offset:26624
    s_waitcnt lgkmcnt(7)
    v_mfma_f32_16x16x32_bf16 v[144:147], a[232:235], a[56:59], v[144:147]
    ds_read_b64_tr_b16 a[228:229], v68 offset:24576
    v_cvt_pk_bf16_f32 v104, v188, v189
    v_mfma_f32_16x16x32_bf16 v[148:151], a[232:235], a[128:131], v[148:151]
    ds_read_b64_tr_b16 a[230:231], v68 offset:26624
    ds_read_b32 a244, v88 offset:576
    v_mfma_f32_16x16x32_bf16 v[152:155], a[236:239], a[56:59], v[152:155]
    ds_read_b64_tr_b16 a[232:233], v65 offset:28672
    v_cvt_pk_bf16_f32 v105, v190, v191
    v_mfma_f32_16x16x32_bf16 v[156:159], a[236:239], a[128:131], v[156:159]
    ds_read_b64_tr_b16 a[234:235], v65 offset:30720
    s_waitcnt lgkmcnt(7)
    v_mfma_f32_16x16x32_bf16 v[128:131], a[216:219], a[60:63], v[128:131]
    ds_read_b64_tr_b16 a[236:237], v66 offset:28672
    s_add_u32 m0, s46, 6144
    v_mfma_f32_16x16x32_bf16 v[132:135], a[216:219], a[132:135], v[132:135]
    ds_read_b64_tr_b16 a[238:239], v66 offset:30720
    buffer_load_dwordx4 v31, s[12:15], s57 offen lds
    v_mfma_f32_16x16x32_bf16 v[136:139], a[220:223], a[60:63], v[136:139]
    ds_read_b64_tr_b16 a[216:217], v67 offset:28672
    v_pk_max_i16 v104, v104, 0
    v_mfma_f32_16x16x32_bf16 v[140:143], a[220:223], a[132:135], v[140:143]
    ds_read_b64_tr_b16 a[218:219], v67 offset:30720
    s_waitcnt lgkmcnt(7)
    v_mfma_f32_16x16x32_bf16 v[144:147], a[224:227], a[60:63], v[144:147]
    ds_read_b64_tr_b16 a[220:221], v68 offset:28672
    v_pk_max_i16 v105, v105, 0
    v_mfma_f32_16x16x32_bf16 v[148:151], a[224:227], a[132:135], v[148:151]
    ds_read_b64_tr_b16 a[222:223], v68 offset:30720
    ds_read_b32 a248, v88 offset:640
    v_mfma_f32_16x16x32_bf16 v[152:155], a[228:231], a[60:63], v[152:155]
    ds_read_b64_tr_b16 a[224:225], v65 offset:32768
    v_accvgpr_write_b32 a192, v102
    v_mfma_f32_16x16x32_bf16 v[156:159], a[228:231], a[132:135], v[156:159]
    ds_read_b64_tr_b16 a[226:227], v65 offset:34816
    s_waitcnt lgkmcnt(7)
    v_mfma_f32_16x16x32_bf16 v[128:131], a[232:235], a[64:67], v[128:131]
    ds_read_b64_tr_b16 a[228:229], v66 offset:32768
    s_add_u32 m0, s46, 7168
    v_mfma_f32_16x16x32_bf16 v[132:135], a[232:235], a[136:139], v[132:135]
    ds_read_b64_tr_b16 a[230:231], v66 offset:34816
    buffer_load_dwordx4 v32, s[12:15], s57 offen lds
    v_mfma_f32_16x16x32_bf16 v[136:139], a[236:239], a[64:67], v[136:139]
    ds_read_b64_tr_b16 a[232:233], v67 offset:32768
    v_accvgpr_write_b32 a193, v103
    v_mfma_f32_16x16x32_bf16 v[140:143], a[236:239], a[136:139], v[140:143]
    ds_read_b64_tr_b16 a[234:235], v67 offset:34816
    s_waitcnt lgkmcnt(7)
    v_mfma_f32_16x16x32_bf16 v[144:147], a[216:219], a[64:67], v[144:147]
    ds_read_b64_tr_b16 a[236:237], v68 offset:32768
    v_accvgpr_write_b32 a194, v104
    v_mfma_f32_16x16x32_bf16 v[148:151], a[216:219], a[136:139], v[148:151]
    ds_read_b64_tr_b16 a[238:239], v68 offset:34816
    ds_read_b32 a252, v88 offset:704
    s_waitcnt vmcnt(24)
    s_barrier
    v_mfma_f32_16x16x32_bf16 v[152:155], a[220:223], a[64:67], v[152:155]
    ds_read_b64_tr_b16 a[216:217], v69 offset:0
    v_accvgpr_write_b32 a195, v105
    v_mfma_f32_16x16x32_bf16 v[156:159], a[220:223], a[136:139], v[156:159]
    ds_read_b64_tr_b16 a[218:219], v69 offset:2048
    s_waitcnt lgkmcnt(7)
    v_mfma_f32_16x16x32_bf16 v[128:131], a[224:227], a[68:71], v[128:131]
    ds_read_b64_tr_b16 a[220:221], v70 offset:0
    s_add_u32 m0, s46, 8192
    v_mfma_f32_16x16x32_bf16 v[132:135], a[224:227], a[140:143], v[132:135]
    ds_read_b64_tr_b16 a[222:223], v70 offset:2048
    buffer_load_dwordx4 v33, s[12:15], s57 offen lds
    v_mfma_f32_16x16x32_bf16 v[136:139], a[228:231], a[68:71], v[136:139]
    ds_read_b64_tr_b16 a[224:225], v71 offset:0
    v_mfma_f32_16x16x32_bf16 v[140:143], a[228:231], a[140:143], v[140:143]
    ds_read_b64_tr_b16 a[226:227], v71 offset:2048
    s_waitcnt lgkmcnt(7)
    v_mfma_f32_16x16x32_bf16 v[144:147], a[232:235], a[68:71], v[144:147]
    ds_read_b64_tr_b16 a[228:229], v72 offset:0
    v_mfma_f32_16x16x32_bf16 v[148:151], a[232:235], a[140:143], v[148:151]
    ds_read_b64_tr_b16 a[230:231], v72 offset:2048
    buffer_store_dwordx4 v[102:105], v118, s[36:39], s66 offen offset:0 sc1
    v_mfma_f32_16x16x32_bf16 v[152:155], a[236:239], a[68:71], v[152:155]
    ds_read_b64_tr_b16 a[232:233], v69 offset:4096
    s_add_u32 s73, s52, 0x0
    v_mfma_f32_16x16x32_bf16 v[156:159], a[236:239], a[140:143], v[156:159]
    ds_read_b64_tr_b16 a[234:235], v69 offset:6144
    v_mfma_f32_16x16x32_bf16 v[128:131], a[240:243], v[108:111], v[128:131]
    v_mfma_f32_16x16x32_bf16 v[132:135], a[240:243], v[112:115], v[132:135]
    v_mfma_f32_16x16x32_bf16 v[136:139], a[244:247], v[108:111], v[136:139]
    v_mfma_f32_16x16x32_bf16 v[140:143], a[244:247], v[112:115], v[140:143]
    v_mfma_f32_16x16x32_bf16 v[144:147], a[248:251], v[108:111], v[144:147]
    v_mfma_f32_16x16x32_bf16 v[148:151], a[248:251], v[112:115], v[148:151]
    s_waitcnt lgkmcnt(10)
    v_mfma_f32_16x16x32_bf16 v[152:155], a[252:255], v[108:111], v[152:155]
    v_mfma_f32_16x16x32_bf16 v[156:159], a[252:255], v[112:115], v[156:159]
    s_barrier
    s_waitcnt lgkmcnt(6)
    v_mfma_f32_16x16x32_bf16 v[160:163], a[216:219], a[0:3], 0
    ds_read_b64_tr_b16 a[236:237], v70 offset:4096
    s_add_u32 m0, s46, 36864
    v_mfma_f32_16x16x32_bf16 v[164:167], a[216:219], a[72:75], 0
    ds_read_b64_tr_b16 a[238:239], v70 offset:6144
    buffer_load_dwordx4 v34, s[16:19], s73 offen lds
    v_mfma_f32_16x16x32_bf16 v[168:171], a[220:223], a[0:3], 0
    ds_read_b64_tr_b16 a[216:217], v71 offset:4096
    v_mfma_f32_16x16x32_bf16 v[172:175], a[220:223], a[72:75], 0
    ds_read_b64_tr_b16 a[218:219], v71 offset:6144
    s_waitcnt lgkmcnt(6)
    v_mfma_f32_16x16x32_bf16 v[176:179], a[224:227], a[0:3], 0
    ds_read_b64_tr_b16 a[220:221], v72 offset:4096
    v_mfma_f32_16x16x32_bf16 v[180:183], a[224:227], a[72:75], 0
    ds_read_b64_tr_b16 a[222:223], v72 offset:6144
    buffer_store_dwordx4 v[224:227], v119, s[40:43], s72 offen offset:2048 sc1
    v_mfma_f32_16x16x32_bf16 v[184:187], a[228:231], a[0:3], 0
    ds_read_b64_tr_b16 a[224:225], v69 offset:8192
    v_cvt_pk_bf16_f32 v90, v128, v129
    v_mfma_f32_16x16x32_bf16 v[188:191], a[228:231], a[72:75], 0
    ds_read_b64_tr_b16 a[226:227], v69 offset:10240
    s_waitcnt lgkmcnt(6)
    v_mfma_f32_16x16x32_bf16 v[160:163], a[232:235], a[4:7], v[160:163]
    ds_read_b64_tr_b16 a[228:229], v70 offset:8192
    s_add_u32 m0, s46, 37888
    v_mfma_f32_16x16x32_bf16 v[164:167], a[232:235], a[76:79], v[164:167]
    ds_read_b64_tr_b16 a[230:231], v70 offset:10240
    buffer_load_dwordx4 v35, s[16:19], s73 offen lds
    v_mfma_f32_16x16x32_bf16 v[168:171], a[236:239], a[4:7], v[168:171]
    ds_read_b64_tr_b16 a[232:233], v71 offset:8192
    v_cvt_pk_bf16_f32 v91, v130, v131
    v_mfma_f32_16x16x32_bf16 v[172:175], a[236:239], a[76:79], v[172:175]
    ds_read_b64_tr_b16 a[234:235], v71 offset:10240
    s_waitcnt lgkmcnt(6)
    v_mfma_f32_16x16x32_bf16 v[176:179], a[216:219], a[4:7], v[176:179]
    ds_read_b64_tr_b16 a[236:237], v72 offset:8192
    v_pk_max_i16 v90, v90, 0
    v_mfma_f32_16x16x32_bf16 v[180:183], a[216:219], a[76:79], v[180:183]
    ds_read_b64_tr_b16 a[238:239], v72 offset:10240
    v_mfma_f32_16x16x32_bf16 v[184:187], a[220:223], a[4:7], v[184:187]
    ds_read_b64_tr_b16 a[216:217], v69 offset:12288
    v_pk_max_i16 v91, v91, 0
    v_mfma_f32_16x16x32_bf16 v[188:191], a[220:223], a[76:79], v[188:191]
    ds_read_b64_tr_b16 a[218:219], v69 offset:14336
    s_waitcnt lgkmcnt(6)
    v_mfma_f32_16x16x32_bf16 v[160:163], a[224:227], a[8:11], v[160:163]
    ds_read_b64_tr_b16 a[220:221], v70 offset:12288
    s_add_u32 m0, s46, 38912
    v_mfma_f32_16x16x32_bf16 v[164:167], a[224:227], a[80:83], v[164:167]
    ds_read_b64_tr_b16 a[222:223], v70 offset:14336
    buffer_load_dwordx4 v36, s[16:19], s73 offen lds
    v_mfma_f32_16x16x32_bf16 v[168:171], a[228:231], a[8:11], v[168:171]
    ds_read_b64_tr_b16 a[224:225], v71 offset:12288
    v_cvt_pk_bf16_f32 v92, v136, v137
    v_mfma_f32_16x16x32_bf16 v[172:175], a[228:231], a[80:83], v[172:175]
    ds_read_b64_tr_b16 a[226:227], v71 offset:14336
    s_waitcnt lgkmcnt(6)
    v_mfma_f32_16x16x32_bf16 v[176:179], a[232:235], a[8:11], v[176:179]
    ds_read_b64_tr_b16 a[228:229], v72 offset:12288
    v_cvt_pk_bf16_f32 v93, v138, v139
    v_mfma_f32_16x16x32_bf16 v[180:183], a[232:235], a[80:83], v[180:183]
    ds_read_b64_tr_b16 a[230:231], v72 offset:14336
    v_mfma_f32_16x16x32_bf16 v[184:187], a[236:239], a[8:11], v[184:187]
    ds_read_b64_tr_b16 a[232:233], v69 offset:16384
    v_pk_max_i16 v92, v92, 0
    v_mfma_f32_16x16x32_bf16 v[188:191], a[236:239], a[80:83], v[188:191]
    ds_read_b64_tr_b16 a[234:235], v69 offset:18432
    s_waitcnt lgkmcnt(6)
    v_mfma_f32_16x16x32_bf16 v[160:163], a[216:219], a[12:15], v[160:163]
    ds_read_b64_tr_b16 a[236:237], v70 offset:16384
    s_add_u32 m0, s46, 39936
    v_mfma_f32_16x16x32_bf16 v[164:167], a[216:219], a[84:87], v[164:167]
    ds_read_b64_tr_b16 a[238:239], v70 offset:18432
    buffer_load_dwordx4 v37, s[16:19], s73 offen lds
    v_mfma_f32_16x16x32_bf16 v[168:171], a[220:223], a[12:15], v[168:171]
    ds_read_b64_tr_b16 a[216:217], v71 offset:16384
    v_pk_max_i16 v93, v93, 0
    v_mfma_f32_16x16x32_bf16 v[172:175], a[220:223], a[84:87], v[172:175]
    ds_read_b64_tr_b16 a[218:219], v71 offset:18432
    s_waitcnt lgkmcnt(6)
    v_mfma_f32_16x16x32_bf16 v[176:179], a[224:227], a[12:15], v[176:179]
    ds_read_b64_tr_b16 a[220:221], v72 offset:16384
    v_accvgpr_write_b32 a160, v90
    v_mfma_f32_16x16x32_bf16 v[180:183], a[224:227], a[84:87], v[180:183]
    ds_read_b64_tr_b16 a[222:223], v72 offset:18432
    buffer_store_dwordx4 v[90:93], v116, s[36:39], s66 offen offset:0 sc1
    v_mfma_f32_16x16x32_bf16 v[184:187], a[228:231], a[12:15], v[184:187]
    ds_read_b64_tr_b16 a[224:225], v69 offset:20480
    v_accvgpr_write_b32 a161, v91
    v_mfma_f32_16x16x32_bf16 v[188:191], a[228:231], a[84:87], v[188:191]
    ds_read_b64_tr_b16 a[226:227], v69 offset:22528
    s_waitcnt lgkmcnt(6)
    v_mfma_f32_16x16x32_bf16 v[160:163], a[232:235], a[16:19], v[160:163]
    ds_read_b64_tr_b16 a[228:229], v70 offset:20480
    s_add_u32 m0, s46, 40960
    v_mfma_f32_16x16x32_bf16 v[164:167], a[232:235], a[88:91], v[164:167]
    ds_read_b64_tr_b16 a[230:231], v70 offset:22528
    buffer_load_dwordx4 v38, s[16:19], s73 offen lds
    v_mfma_f32_16x16x32_bf16 v[168:171], a[236:239], a[16:19], v[168:171]
    ds_read_b64_tr_b16 a[232:233], v71 offset:20480
    v_accvgpr_write_b32 a162, v92
    v_mfma_f32_16x16x32_bf16 v[172:175], a[236:239], a[88:91], v[172:175]
    ds_read_b64_tr_b16 a[234:235], v71 offset:22528
    s_waitcnt lgkmcnt(6)
    v_mfma_f32_16x16x32_bf16 v[176:179], a[216:219], a[16:19], v[176:179]
    ds_read_b64_tr_b16 a[236:237], v72 offset:20480
    v_accvgpr_write_b32 a163, v93
    v_mfma_f32_16x16x32_bf16 v[180:183], a[216:219], a[88:91], v[180:183]
    ds_read_b64_tr_b16 a[238:239], v72 offset:22528
    v_mfma_f32_16x16x32_bf16 v[184:187], a[220:223], a[16:19], v[184:187]
    ds_read_b64_tr_b16 a[216:217], v69 offset:24576
    v_cvt_pk_bf16_f32 v94, v132, v133
    v_mfma_f32_16x16x32_bf16 v[188:191], a[220:223], a[88:91], v[188:191]
    ds_read_b64_tr_b16 a[218:219], v69 offset:26624
    s_waitcnt lgkmcnt(6)
    v_mfma_f32_16x16x32_bf16 v[160:163], a[224:227], a[20:23], v[160:163]
    ds_read_b64_tr_b16 a[220:221], v70 offset:24576
    s_add_u32 m0, s46, 41984
    v_mfma_f32_16x16x32_bf16 v[164:167], a[224:227], a[92:95], v[164:167]
    ds_read_b64_tr_b16 a[222:223], v70 offset:26624
    buffer_load_dwordx4 v39, s[16:19], s73 offen lds
    v_mfma_f32_16x16x32_bf16 v[168:171], a[228:231], a[20:23], v[168:171]
    ds_read_b64_tr_b16 a[224:225], v71 offset:24576
    v_cvt_pk_bf16_f32 v95, v134, v135
    v_mfma_f32_16x16x32_bf16 v[172:175], a[228:231], a[92:95], v[172:175]
    ds_read_b64_tr_b16 a[226:227], v71 offset:26624
    s_waitcnt lgkmcnt(6)
    v_mfma_f32_16x16x32_bf16 v[176:179], a[232:235], a[20:23], v[176:179]
    ds_read_b64_tr_b16 a[228:229], v72 offset:24576
    v_pk_max_i16 v94, v94, 0
    v_mfma_f32_16x16x32_bf16 v[180:183], a[232:235], a[92:95], v[180:183]
    ds_read_b64_tr_b16 a[230:231], v72 offset:26624
    v_mfma_f32_16x16x32_bf16 v[184:187], a[236:239], a[20:23], v[184:187]
    ds_read_b64_tr_b16 a[232:233], v69 offset:28672
    v_pk_max_i16 v95, v95, 0
    v_mfma_f32_16x16x32_bf16 v[188:191], a[236:239], a[92:95], v[188:191]
    ds_read_b64_tr_b16 a[234:235], v69 offset:30720
    s_waitcnt lgkmcnt(6)
    v_mfma_f32_16x16x32_bf16 v[160:163], a[216:219], a[24:27], v[160:163]
    ds_read_b64_tr_b16 a[236:237], v70 offset:28672
    s_add_u32 m0, s46, 43008
    v_mfma_f32_16x16x32_bf16 v[164:167], a[216:219], a[96:99], v[164:167]
    ds_read_b64_tr_b16 a[238:239], v70 offset:30720
    buffer_load_dwordx4 v40, s[16:19], s73 offen lds
    v_mfma_f32_16x16x32_bf16 v[168:171], a[220:223], a[24:27], v[168:171]
    ds_read_b64_tr_b16 a[216:217], v71 offset:28672
    v_cvt_pk_bf16_f32 v96, v140, v141
    v_mfma_f32_16x16x32_bf16 v[172:175], a[220:223], a[96:99], v[172:175]
    ds_read_b64_tr_b16 a[218:219], v71 offset:30720
    s_waitcnt lgkmcnt(6)
    v_mfma_f32_16x16x32_bf16 v[176:179], a[224:227], a[24:27], v[176:179]
    ds_read_b64_tr_b16 a[220:221], v72 offset:28672
    v_cvt_pk_bf16_f32 v97, v142, v143
    v_mfma_f32_16x16x32_bf16 v[180:183], a[224:227], a[96:99], v[180:183]
    ds_read_b64_tr_b16 a[222:223], v72 offset:30720
    v_mfma_f32_16x16x32_bf16 v[184:187], a[228:231], a[24:27], v[184:187]
    ds_read_b64_tr_b16 a[224:225], v69 offset:32768
    v_pk_max_i16 v96, v96, 0
    v_mfma_f32_16x16x32_bf16 v[188:191], a[228:231], a[96:99], v[188:191]
    ds_read_b64_tr_b16 a[226:227], v69 offset:34816
    s_waitcnt lgkmcnt(6)
    v_mfma_f32_16x16x32_bf16 v[160:163], a[232:235], a[28:31], v[160:163]
    ds_read_b64_tr_b16 a[228:229], v70 offset:32768
    s_add_u32 m0, s46, 44032
    v_mfma_f32_16x16x32_bf16 v[164:167], a[232:235], a[100:103], v[164:167]
    ds_read_b64_tr_b16 a[230:231], v70 offset:34816
    buffer_load_dwordx4 v41, s[16:19], s73 offen lds
    v_mfma_f32_16x16x32_bf16 v[168:171], a[236:239], a[28:31], v[168:171]
    ds_read_b64_tr_b16 a[232:233], v71 offset:32768
    v_pk_max_i16 v97, v97, 0
    v_mfma_f32_16x16x32_bf16 v[172:175], a[236:239], a[100:103], v[172:175]
    ds_read_b64_tr_b16 a[234:235], v71 offset:34816
    s_waitcnt lgkmcnt(6)
    v_mfma_f32_16x16x32_bf16 v[176:179], a[216:219], a[28:31], v[176:179]
    ds_read_b64_tr_b16 a[236:237], v72 offset:32768
    v_accvgpr_write_b32 a196, v94
    v_mfma_f32_16x16x32_bf16 v[180:183], a[216:219], a[100:103], v[180:183]
    ds_read_b64_tr_b16 a[238:239], v72 offset:34816
    buffer_store_dwordx4 v[94:97], v118, s[36:39], s66 offen offset:1024 sc1
    s_waitcnt vmcnt(24)
    s_barrier
    v_mfma_f32_16x16x32_bf16 v[184:187], a[220:223], a[28:31], v[184:187]
    ds_read_b64_tr_b16 a[216:217], v73 offset:0
    v_accvgpr_write_b32 a197, v95
    v_mfma_f32_16x16x32_bf16 v[188:191], a[220:223], a[100:103], v[188:191]
    ds_read_b64_tr_b16 a[218:219], v73 offset:2048
    s_waitcnt lgkmcnt(6)
    v_mfma_f32_16x16x32_bf16 v[160:163], a[224:227], a[32:35], v[160:163]
    ds_read_b64_tr_b16 a[220:221], v74 offset:0
    s_add_u32 m0, s46, 45056
    v_mfma_f32_16x16x32_bf16 v[164:167], a[224:227], a[104:107], v[164:167]
    ds_read_b64_tr_b16 a[222:223], v74 offset:2048
    buffer_load_dwordx4 v42, s[16:19], s73 offen lds
    v_mfma_f32_16x16x32_bf16 v[168:171], a[228:231], a[32:35], v[168:171]
    ds_read_b64_tr_b16 a[224:225], v75 offset:0
    v_accvgpr_write_b32 a198, v96
    v_mfma_f32_16x16x32_bf16 v[172:175], a[228:231], a[104:107], v[172:175]
    ds_read_b64_tr_b16 a[226:227], v75 offset:2048
    s_waitcnt lgkmcnt(6)
    v_mfma_f32_16x16x32_bf16 v[176:179], a[232:235], a[32:35], v[176:179]
    ds_read_b64_tr_b16 a[228:229], v76 offset:0
    v_accvgpr_write_b32 a199, v97
    v_mfma_f32_16x16x32_bf16 v[180:183], a[232:235], a[104:107], v[180:183]
    ds_read_b64_tr_b16 a[230:231], v76 offset:2048
    v_mfma_f32_16x16x32_bf16 v[184:187], a[236:239], a[32:35], v[184:187]
    ds_read_b64_tr_b16 a[232:233], v73 offset:4096
    s_add_u32 s57, s52, 0x80
    v_mfma_f32_16x16x32_bf16 v[188:191], a[236:239], a[104:107], v[188:191]
    ds_read_b64_tr_b16 a[234:235], v73 offset:6144
    s_barrier
    s_waitcnt lgkmcnt(6)
    v_mfma_f32_16x16x32_bf16 v[160:163], a[216:219], a[36:39], v[160:163]
    ds_read_b64_tr_b16 a[236:237], v74 offset:4096
    s_add_u32 m0, s46, 73728
    v_mfma_f32_16x16x32_bf16 v[164:167], a[216:219], a[108:111], v[164:167]
    ds_read_b64_tr_b16 a[238:239], v74 offset:6144
    buffer_load_dwordx4 v34, s[16:19], s57 offen lds
    v_mfma_f32_16x16x32_bf16 v[168:171], a[220:223], a[36:39], v[168:171]
    ds_read_b64_tr_b16 a[216:217], v75 offset:4096
    v_cvt_pk_bf16_f32 v98, v144, v145
    v_mfma_f32_16x16x32_bf16 v[172:175], a[220:223], a[108:111], v[172:175]
    ds_read_b64_tr_b16 a[218:219], v75 offset:6144
    s_waitcnt lgkmcnt(6)
    v_mfma_f32_16x16x32_bf16 v[176:179], a[224:227], a[36:39], v[176:179]
    ds_read_b64_tr_b16 a[220:221], v76 offset:4096
    v_cvt_pk_bf16_f32 v99, v146, v147
    v_mfma_f32_16x16x32_bf16 v[180:183], a[224:227], a[108:111], v[180:183]
    ds_read_b64_tr_b16 a[222:223], v76 offset:6144
    v_mfma_f32_16x16x32_bf16 v[184:187], a[228:231], a[36:39], v[184:187]
    ds_read_b64_tr_b16 a[224:225], v73 offset:8192
    v_pk_max_i16 v98, v98, 0
    v_mfma_f32_16x16x32_bf16 v[188:191], a[228:231], a[108:111], v[188:191]
    ds_read_b64_tr_b16 a[226:227], v73 offset:10240
    s_waitcnt lgkmcnt(6)
    v_mfma_f32_16x16x32_bf16 v[160:163], a[232:235], a[40:43], v[160:163]
    ds_read_b64_tr_b16 a[228:229], v74 offset:8192
    s_add_u32 m0, s46, 74752
    v_mfma_f32_16x16x32_bf16 v[164:167], a[232:235], a[112:115], v[164:167]
    ds_read_b64_tr_b16 a[230:231], v74 offset:10240
    buffer_load_dwordx4 v35, s[16:19], s57 offen lds
    v_mfma_f32_16x16x32_bf16 v[168:171], a[236:239], a[40:43], v[168:171]
    ds_read_b64_tr_b16 a[232:233], v75 offset:8192
    v_pk_max_i16 v99, v99, 0
    v_mfma_f32_16x16x32_bf16 v[172:175], a[236:239], a[112:115], v[172:175]
    ds_read_b64_tr_b16 a[234:235], v75 offset:10240
    s_waitcnt lgkmcnt(6)
    v_mfma_f32_16x16x32_bf16 v[176:179], a[216:219], a[40:43], v[176:179]
    ds_read_b64_tr_b16 a[236:237], v76 offset:8192
    v_cvt_pk_bf16_f32 v100, v152, v153
    v_mfma_f32_16x16x32_bf16 v[180:183], a[216:219], a[112:115], v[180:183]
    ds_read_b64_tr_b16 a[238:239], v76 offset:10240
    v_mfma_f32_16x16x32_bf16 v[184:187], a[220:223], a[40:43], v[184:187]
    ds_read_b64_tr_b16 a[216:217], v73 offset:12288
    v_cvt_pk_bf16_f32 v101, v154, v155
    v_mfma_f32_16x16x32_bf16 v[188:191], a[220:223], a[112:115], v[188:191]
    ds_read_b64_tr_b16 a[218:219], v73 offset:14336
    s_waitcnt lgkmcnt(6)
    v_mfma_f32_16x16x32_bf16 v[160:163], a[224:227], a[44:47], v[160:163]
    ds_read_b64_tr_b16 a[220:221], v74 offset:12288
    s_add_u32 m0, s46, 75776
    v_mfma_f32_16x16x32_bf16 v[164:167], a[224:227], a[116:119], v[164:167]
    ds_read_b64_tr_b16 a[222:223], v74 offset:14336
    buffer_load_dwordx4 v36, s[16:19], s57 offen lds
    v_mfma_f32_16x16x32_bf16 v[168:171], a[228:231], a[44:47], v[168:171]
    ds_read_b64_tr_b16 a[224:225], v75 offset:12288
    v_pk_max_i16 v100, v100, 0
    v_mfma_f32_16x16x32_bf16 v[172:175], a[228:231], a[116:119], v[172:175]
    ds_read_b64_tr_b16 a[226:227], v75 offset:14336
    s_waitcnt lgkmcnt(6)
    v_mfma_f32_16x16x32_bf16 v[176:179], a[232:235], a[44:47], v[176:179]
    ds_read_b64_tr_b16 a[228:229], v76 offset:12288
    v_pk_max_i16 v101, v101, 0
    v_mfma_f32_16x16x32_bf16 v[180:183], a[232:235], a[116:119], v[180:183]
    ds_read_b64_tr_b16 a[230:231], v76 offset:14336
    buffer_store_dwordx4 v[98:101], v116, s[36:39], s66 offen offset:1024 sc1
    v_mfma_f32_16x16x32_bf16 v[184:187], a[236:239], a[44:47], v[184:187]
    ds_read_b64_tr_b16 a[232:233], v73 offset:16384
    v_accvgpr_write_b32 a164, v98
    v_mfma_f32_16x16x32_bf16 v[188:191], a[236:239], a[116:119], v[188:191]
    ds_read_b64_tr_b16 a[234:235], v73 offset:18432
    s_waitcnt lgkmcnt(6)
    v_mfma_f32_16x16x32_bf16 v[160:163], a[216:219], a[48:51], v[160:163]
    ds_read_b64_tr_b16 a[236:237], v74 offset:16384
    s_add_u32 m0, s46, 76800
    v_mfma_f32_16x16x32_bf16 v[164:167], a[216:219], a[120:123], v[164:167]
    ds_read_b64_tr_b16 a[238:239], v74 offset:18432
    buffer_load_dwordx4 v37, s[16:19], s57 offen lds
    v_mfma_f32_16x16x32_bf16 v[168:171], a[220:223], a[48:51], v[168:171]
    ds_read_b64_tr_b16 a[216:217], v75 offset:16384
    v_accvgpr_write_b32 a165, v99
    v_mfma_f32_16x16x32_bf16 v[172:175], a[220:223], a[120:123], v[172:175]
    ds_read_b64_tr_b16 a[218:219], v75 offset:18432
    s_waitcnt lgkmcnt(6)
    v_mfma_f32_16x16x32_bf16 v[176:179], a[224:227], a[48:51], v[176:179]
    ds_read_b64_tr_b16 a[220:221], v76 offset:16384
    v_accvgpr_write_b32 a166, v100
    v_mfma_f32_16x16x32_bf16 v[180:183], a[224:227], a[120:123], v[180:183]
    ds_read_b64_tr_b16 a[222:223], v76 offset:18432
    v_mfma_f32_16x16x32_bf16 v[184:187], a[228:231], a[48:51], v[184:187]
    ds_read_b64_tr_b16 a[224:225], v73 offset:20480
    v_accvgpr_write_b32 a167, v101
    v_mfma_f32_16x16x32_bf16 v[188:191], a[228:231], a[120:123], v[188:191]
    ds_read_b64_tr_b16 a[226:227], v73 offset:22528
    s_waitcnt lgkmcnt(6)
    v_mfma_f32_16x16x32_bf16 v[160:163], a[232:235], a[52:55], v[160:163]
    ds_read_b64_tr_b16 a[228:229], v74 offset:20480
    s_add_u32 m0, s46, 77824
    v_mfma_f32_16x16x32_bf16 v[164:167], a[232:235], a[124:127], v[164:167]
    ds_read_b64_tr_b16 a[230:231], v74 offset:22528
    buffer_load_dwordx4 v38, s[16:19], s57 offen lds
    v_mfma_f32_16x16x32_bf16 v[168:171], a[236:239], a[52:55], v[168:171]
    ds_read_b64_tr_b16 a[232:233], v75 offset:20480
    v_cvt_pk_bf16_f32 v102, v148, v149
    v_mfma_f32_16x16x32_bf16 v[172:175], a[236:239], a[124:127], v[172:175]
    ds_read_b64_tr_b16 a[234:235], v75 offset:22528
    s_waitcnt lgkmcnt(6)
    v_mfma_f32_16x16x32_bf16 v[176:179], a[216:219], a[52:55], v[176:179]
    ds_read_b64_tr_b16 a[236:237], v76 offset:20480
    v_cvt_pk_bf16_f32 v103, v150, v151
    v_mfma_f32_16x16x32_bf16 v[180:183], a[216:219], a[124:127], v[180:183]
    ds_read_b64_tr_b16 a[238:239], v76 offset:22528
    ds_read_b32 a240, v88 offset:768
    v_mfma_f32_16x16x32_bf16 v[184:187], a[220:223], a[52:55], v[184:187]
    ds_read_b64_tr_b16 a[216:217], v73 offset:24576
    v_pk_max_i16 v102, v102, 0
    v_mfma_f32_16x16x32_bf16 v[188:191], a[220:223], a[124:127], v[188:191]
    ds_read_b64_tr_b16 a[218:219], v73 offset:26624
    s_waitcnt lgkmcnt(7)
    v_mfma_f32_16x16x32_bf16 v[160:163], a[224:227], a[56:59], v[160:163]
    ds_read_b64_tr_b16 a[220:221], v74 offset:24576
    s_add_u32 m0, s46, 78848
    v_mfma_f32_16x16x32_bf16 v[164:167], a[224:227], a[128:131], v[164:167]
    ds_read_b64_tr_b16 a[222:223], v74 offset:26624
    buffer_load_dwordx4 v39, s[16:19], s57 offen lds
    v_mfma_f32_16x16x32_bf16 v[168:171], a[228:231], a[56:59], v[168:171]
    ds_read_b64_tr_b16 a[224:225], v75 offset:24576
    v_pk_max_i16 v103, v103, 0
    v_mfma_f32_16x16x32_bf16 v[172:175], a[228:231], a[128:131], v[172:175]
    ds_read_b64_tr_b16 a[226:227], v75 offset:26624
    s_waitcnt lgkmcnt(7)
    v_mfma_f32_16x16x32_bf16 v[176:179], a[232:235], a[56:59], v[176:179]
    ds_read_b64_tr_b16 a[228:229], v76 offset:24576
    v_cvt_pk_bf16_f32 v104, v156, v157
    v_mfma_f32_16x16x32_bf16 v[180:183], a[232:235], a[128:131], v[180:183]
    ds_read_b64_tr_b16 a[230:231], v76 offset:26624
    ds_read_b32 a244, v88 offset:832
    v_mfma_f32_16x16x32_bf16 v[184:187], a[236:239], a[56:59], v[184:187]
    ds_read_b64_tr_b16 a[232:233], v73 offset:28672
    v_cvt_pk_bf16_f32 v105, v158, v159
    v_mfma_f32_16x16x32_bf16 v[188:191], a[236:239], a[128:131], v[188:191]
    ds_read_b64_tr_b16 a[234:235], v73 offset:30720
    s_waitcnt lgkmcnt(7)
    v_mfma_f32_16x16x32_bf16 v[160:163], a[216:219], a[60:63], v[160:163]
    ds_read_b64_tr_b16 a[236:237], v74 offset:28672
    s_add_u32 m0, s46, 79872
    v_mfma_f32_16x16x32_bf16 v[164:167], a[216:219], a[132:135], v[164:167]
    ds_read_b64_tr_b16 a[238:239], v74 offset:30720
    buffer_load_dwordx4 v40, s[16:19], s57 offen lds
    v_mfma_f32_16x16x32_bf16 v[168:171], a[220:223], a[60:63], v[168:171]
    ds_read_b64_tr_b16 a[216:217], v75 offset:28672
    v_pk_max_i16 v104, v104, 0
    v_mfma_f32_16x16x32_bf16 v[172:175], a[220:223], a[132:135], v[172:175]
    ds_read_b64_tr_b16 a[218:219], v75 offset:30720
    s_waitcnt lgkmcnt(7)
    v_mfma_f32_16x16x32_bf16 v[176:179], a[224:227], a[60:63], v[176:179]
    ds_read_b64_tr_b16 a[220:221], v76 offset:28672
    v_pk_max_i16 v105, v105, 0
    v_mfma_f32_16x16x32_bf16 v[180:183], a[224:227], a[132:135], v[180:183]
    ds_read_b64_tr_b16 a[222:223], v76 offset:30720
    ds_read_b32 a248, v88 offset:896
    v_mfma_f32_16x16x32_bf16 v[184:187], a[228:231], a[60:63], v[184:187]
    ds_read_b64_tr_b16 a[224:225], v73 offset:32768
    v_accvgpr_write_b32 a200, v102
    v_mfma_f32_16x16x32_bf16 v[188:191], a[228:231], a[132:135], v[188:191]
    ds_read_b64_tr_b16 a[226:227], v73 offset:34816
    s_waitcnt lgkmcnt(7)
    v_mfma_f32_16x16x32_bf16 v[160:163], a[232:235], a[64:67], v[160:163]
    ds_read_b64_tr_b16 a[228:229], v74 offset:32768
    s_add_u32 m0, s46, 80896
    v_mfma_f32_16x16x32_bf16 v[164:167], a[232:235], a[136:139], v[164:167]
    ds_read_b64_tr_b16 a[230:231], v74 offset:34816
    buffer_load_dwordx4 v41, s[16:19], s57 offen lds
    v_mfma_f32_16x16x32_bf16 v[168:171], a[236:239], a[64:67], v[168:171]
    ds_read_b64_tr_b16 a[232:233], v75 offset:32768
    v_accvgpr_write_b32 a201, v103
    v_mfma_f32_16x16x32_bf16 v[172:175], a[236:239], a[136:139], v[172:175]
    ds_read_b64_tr_b16 a[234:235], v75 offset:34816
    s_waitcnt lgkmcnt(7)
    v_mfma_f32_16x16x32_bf16 v[176:179], a[216:219], a[64:67], v[176:179]
    ds_read_b64_tr_b16 a[236:237], v76 offset:32768
    v_accvgpr_write_b32 a202, v104
    v_mfma_f32_16x16x32_bf16 v[180:183], a[216:219], a[136:139], v[180:183]
    ds_read_b64_tr_b16 a[238:239], v76 offset:34816
    ds_read_b32 a252, v88 offset:960
    s_waitcnt vmcnt(22)
    s_barrier
    v_mfma_f32_16x16x32_bf16 v[184:187], a[220:223], a[64:67], v[184:187]
    ds_read_b64_tr_b16 a[216:217], v77 offset:0
    v_accvgpr_write_b32 a203, v105
    v_mfma_f32_16x16x32_bf16 v[188:191], a[220:223], a[136:139], v[188:191]
    ds_read_b64_tr_b16 a[218:219], v77 offset:1024
    s_waitcnt lgkmcnt(7)
    v_mfma_f32_16x16x32_bf16 v[160:163], a[224:227], a[68:71], v[160:163]
    ds_read_b64_tr_b16 a[220:221], v78 offset:0
    s_add_u32 m0, s46, 81920
    v_mfma_f32_16x16x32_bf16 v[164:167], a[224:227], a[140:143], v[164:167]
    ds_read_b64_tr_b16 a[222:223], v78 offset:1024
    buffer_load_dwordx4 v42, s[16:19], s57 offen lds
    v_mfma_f32_16x16x32_bf16 v[168:171], a[228:231], a[68:71], v[168:171]
    ds_read_b64_tr_b16 a[224:225], v77 offset:2048
    v_mfma_f32_16x16x32_bf16 v[172:175], a[228:231], a[140:143], v[172:175]
    ds_read_b64_tr_b16 a[226:227], v77 offset:3072
    s_waitcnt lgkmcnt(7)
    v_mfma_f32_16x16x32_bf16 v[176:179], a[232:235], a[68:71], v[176:179]
    ds_read_b64_tr_b16 a[228:229], v78 offset:2048
    v_mfma_f32_16x16x32_bf16 v[180:183], a[232:235], a[140:143], v[180:183]
    ds_read_b64_tr_b16 a[230:231], v78 offset:3072
    buffer_store_dwordx4 v[102:105], v118, s[36:39], s66 offen offset:2048 sc1
    v_mfma_f32_16x16x32_bf16 v[184:187], a[236:239], a[68:71], v[184:187]
    ds_read_b64_tr_b16 a[232:233], v77 offset:4096
    s_add_u32 s73, s52, 0x100
    v_mfma_f32_16x16x32_bf16 v[188:191], a[236:239], a[140:143], v[188:191]
    ds_read_b64_tr_b16 a[234:235], v77 offset:5120
    v_mfma_f32_16x16x32_bf16 v[160:163], a[240:243], v[108:111], v[160:163]
    v_mfma_f32_16x16x32_bf16 v[164:167], a[240:243], v[112:115], v[164:167]
    v_mfma_f32_16x16x32_bf16 v[168:171], a[244:247], v[108:111], v[168:171]
    v_mfma_f32_16x16x32_bf16 v[172:175], a[244:247], v[112:115], v[172:175]
    v_mfma_f32_16x16x32_bf16 v[176:179], a[248:251], v[108:111], v[176:179]
    v_mfma_f32_16x16x32_bf16 v[180:183], a[248:251], v[112:115], v[180:183]
    s_waitcnt lgkmcnt(10)
    v_mfma_f32_16x16x32_bf16 v[184:187], a[252:255], v[108:111], v[184:187]
    v_mfma_f32_16x16x32_bf16 v[188:191], a[252:255], v[112:115], v[188:191]
    s_barrier
    s_waitcnt lgkmcnt(6)
    v_mfma_f32_16x16x32_bf16 v[128:131], a[216:219], a[0:3], 0
    ds_read_b64_tr_b16 a[236:237], v78 offset:4096
    s_add_u32 m0, s46, 110592
    v_mfma_f32_16x16x32_bf16 v[132:135], a[216:219], a[72:75], 0
    ds_read_b64_tr_b16 a[238:239], v78 offset:5120
    buffer_load_dwordx4 v34, s[16:19], s73 offen lds
    v_mfma_f32_16x16x32_bf16 v[136:139], a[220:223], a[0:3], 0
    ds_read_b64_tr_b16 a[216:217], v77 offset:6144
    v_mfma_f32_16x16x32_bf16 v[140:143], a[220:223], a[72:75], 0
    ds_read_b64_tr_b16 a[218:219], v77 offset:7168
    s_waitcnt lgkmcnt(6)
    v_mfma_f32_16x16x32_bf16 v[128:131], a[224:227], a[4:7], v[128:131]
    ds_read_b64_tr_b16 a[220:221], v78 offset:6144
    v_mfma_f32_16x16x32_bf16 v[132:135], a[224:227], a[76:79], v[132:135]
    ds_read_b64_tr_b16 a[222:223], v78 offset:7168
    v_mfma_f32_16x16x32_bf16 v[136:139], a[228:231], a[4:7], v[136:139]
    ds_read_b64_tr_b16 a[224:225], v77 offset:8192
    v_cvt_pk_bf16_f32 v90, v160, v161
    v_cvt_pk_bf16_f32 v91, v162, v163
    v_mfma_f32_16x16x32_bf16 v[140:143], a[228:231], a[76:79], v[140:143]
    ds_read_b64_tr_b16 a[226:227], v77 offset:9216
    s_waitcnt lgkmcnt(6)
    v_mfma_f32_16x16x32_bf16 v[128:131], a[232:235], a[8:11], v[128:131]
    ds_read_b64_tr_b16 a[228:229], v78 offset:8192
    s_add_u32 m0, s46, 111616
    v_mfma_f32_16x16x32_bf16 v[132:135], a[232:235], a[80:83], v[132:135]
    ds_read_b64_tr_b16 a[230:231], v78 offset:9216
    buffer_load_dwordx4 v35, s[16:19], s73 offen lds
    v_mfma_f32_16x16x32_bf16 v[136:139], a[236:239], a[8:11], v[136:139]
    ds_read_b64_tr_b16 a[232:233], v77 offset:10240
    v_pk_max_i16 v90, v90, 0
    v_pk_max_i16 v91, v91, 0
    v_mfma_f32_16x16x32_bf16 v[140:143], a[236:239], a[80:83], v[140:143]
    ds_read_b64_tr_b16 a[234:235], v77 offset:11264
    s_waitcnt lgkmcnt(6)
    v_mfma_f32_16x16x32_bf16 v[128:131], a[216:219], a[12:15], v[128:131]
    ds_read_b64_tr_b16 a[236:237], v78 offset:10240
    v_cvt_pk_bf16_f32 v92, v168, v169
    v_mfma_f32_16x16x32_bf16 v[132:135], a[216:219], a[84:87], v[132:135]
    ds_read_b64_tr_b16 a[238:239], v78 offset:11264
    v_mfma_f32_16x16x32_bf16 v[136:139], a[220:223], a[12:15], v[136:139]
    ds_read_b64_tr_b16 a[216:217], v77 offset:12288
    v_cvt_pk_bf16_f32 v93, v170, v171
    v_pk_max_i16 v92, v92, 0
    v_mfma_f32_16x16x32_bf16 v[140:143], a[220:223], a[84:87], v[140:143]
    ds_read_b64_tr_b16 a[218:219], v77 offset:13312
    s_waitcnt lgkmcnt(6)
    v_mfma_f32_16x16x32_bf16 v[128:131], a[224:227], a[16:19], v[128:131]
    ds_read_b64_tr_b16 a[220:221], v78 offset:12288
    s_add_u32 m0, s46, 112640
    v_mfma_f32_16x16x32_bf16 v[132:135], a[224:227], a[88:91], v[132:135]
    ds_read_b64_tr_b16 a[222:223], v78 offset:13312
    buffer_load_dwordx4 v36, s[16:19], s73 offen lds
    v_mfma_f32_16x16x32_bf16 v[136:139], a[228:231], a[16:19], v[136:139]
    ds_read_b64_tr_b16 a[224:225], v77 offset:14336
    v_pk_max_i16 v93, v93, 0
    v_accvgpr_write_b32 a168, v90
    v_mfma_f32_16x16x32_bf16 v[140:143], a[228:231], a[88:91], v[140:143]
    ds_read_b64_tr_b16 a[226:227], v77 offset:15360
    s_waitcnt lgkmcnt(6)
    v_mfma_f32_16x16x32_bf16 v[128:131], a[232:235], a[20:23], v[128:131]
    ds_read_b64_tr_b16 a[228:229], v78 offset:14336
    v_accvgpr_write_b32 a169, v91
    v_mfma_f32_16x16x32_bf16 v[132:135], a[232:235], a[92:95], v[132:135]
    ds_read_b64_tr_b16 a[230:231], v78 offset:15360
    buffer_store_dwordx4 v[90:93], v116, s[36:39], s66 offen offset:2048 sc1
    v_mfma_f32_16x16x32_bf16 v[136:139], a[236:239], a[20:23], v[136:139]
    ds_read_b64_tr_b16 a[232:233], v77 offset:16384
    v_accvgpr_write_b32 a170, v92
    v_accvgpr_write_b32 a171, v93
    v_mfma_f32_16x16x32_bf16 v[140:143], a[236:239], a[92:95], v[140:143]
    ds_read_b64_tr_b16 a[234:235], v77 offset:17408
    s_waitcnt lgkmcnt(6)
    v_mfma_f32_16x16x32_bf16 v[128:131], a[216:219], a[24:27], v[128:131]
    ds_read_b64_tr_b16 a[236:237], v78 offset:16384
    s_add_u32 m0, s46, 113664
    v_mfma_f32_16x16x32_bf16 v[132:135], a[216:219], a[96:99], v[132:135]
    ds_read_b64_tr_b16 a[238:239], v78 offset:17408
    buffer_load_dwordx4 v37, s[16:19], s73 offen lds
    v_mfma_f32_16x16x32_bf16 v[136:139], a[220:223], a[24:27], v[136:139]
    ds_read_b64_tr_b16 a[216:217], v77 offset:18432
    v_cvt_pk_bf16_f32 v94, v164, v165
    v_cvt_pk_bf16_f32 v95, v166, v167
    v_mfma_f32_16x16x32_bf16 v[140:143], a[220:223], a[96:99], v[140:143]
    ds_read_b64_tr_b16 a[218:219], v77 offset:19456
    s_waitcnt lgkmcnt(6)
    v_mfma_f32_16x16x32_bf16 v[128:131], a[224:227], a[28:31], v[128:131]
    ds_read_b64_tr_b16 a[220:221], v78 offset:18432
    v_pk_max_i16 v94, v94, 0
    v_mfma_f32_16x16x32_bf16 v[132:135], a[224:227], a[100:103], v[132:135]
    ds_read_b64_tr_b16 a[222:223], v78 offset:19456
    v_mfma_f32_16x16x32_bf16 v[136:139], a[228:231], a[28:31], v[136:139]
    ds_read_b64_tr_b16 a[224:225], v77 offset:20480
    v_pk_max_i16 v95, v95, 0
    v_cvt_pk_bf16_f32 v96, v172, v173
    v_mfma_f32_16x16x32_bf16 v[140:143], a[228:231], a[100:103], v[140:143]
    ds_read_b64_tr_b16 a[226:227], v77 offset:21504
    s_waitcnt lgkmcnt(6)
    v_mfma_f32_16x16x32_bf16 v[128:131], a[232:235], a[32:35], v[128:131]
    ds_read_b64_tr_b16 a[228:229], v78 offset:20480
    s_add_u32 m0, s46, 114688
    v_mfma_f32_16x16x32_bf16 v[132:135], a[232:235], a[104:107], v[132:135]
    ds_read_b64_tr_b16 a[230:231], v78 offset:21504
    buffer_load_dwordx4 v38, s[16:19], s73 offen lds
    v_mfma_f32_16x16x32_bf16 v[136:139], a[236:239], a[32:35], v[136:139]
    ds_read_b64_tr_b16 a[232:233], v77 offset:22528
    v_cvt_pk_bf16_f32 v97, v174, v175
    v_pk_max_i16 v96, v96, 0
    v_mfma_f32_16x16x32_bf16 v[140:143], a[236:239], a[104:107], v[140:143]
    ds_read_b64_tr_b16 a[234:235], v77 offset:23552
    s_waitcnt lgkmcnt(6)
    v_mfma_f32_16x16x32_bf16 v[128:131], a[216:219], a[36:39], v[128:131]
    ds_read_b64_tr_b16 a[236:237], v78 offset:22528
    v_pk_max_i16 v97, v97, 0
    v_mfma_f32_16x16x32_bf16 v[132:135], a[216:219], a[108:111], v[132:135]
    ds_read_b64_tr_b16 a[238:239], v78 offset:23552
    ds_read_b32 a240, v88 offset:1024
    v_mfma_f32_16x16x32_bf16 v[136:139], a[220:223], a[36:39], v[136:139]
    ds_read_b64_tr_b16 a[216:217], v77 offset:24576
    v_accvgpr_write_b32 a204, v94
    v_accvgpr_write_b32 a205, v95
    v_mfma_f32_16x16x32_bf16 v[140:143], a[220:223], a[108:111], v[140:143]
    ds_read_b64_tr_b16 a[218:219], v77 offset:25600
    s_waitcnt lgkmcnt(7)
    v_mfma_f32_16x16x32_bf16 v[128:131], a[224:227], a[40:43], v[128:131]
    ds_read_b64_tr_b16 a[220:221], v78 offset:24576
    s_add_u32 m0, s46, 115712
    v_mfma_f32_16x16x32_bf16 v[132:135], a[224:227], a[112:115], v[132:135]
    ds_read_b64_tr_b16 a[222:223], v78 offset:25600
    buffer_load_dwordx4 v39, s[16:19], s73 offen lds
    v_mfma_f32_16x16x32_bf16 v[136:139], a[228:231], a[40:43], v[136:139]
    ds_read_b64_tr_b16 a[224:225], v77 offset:26624
    v_accvgpr_write_b32 a206, v96
    v_accvgpr_write_b32 a207, v97
    v_mfma_f32_16x16x32_bf16 v[140:143], a[228:231], a[112:115], v[140:143]
    ds_read_b64_tr_b16 a[226:227], v77 offset:27648
    s_waitcnt lgkmcnt(7)
    v_mfma_f32_16x16x32_bf16 v[128:131], a[232:235], a[44:47], v[128:131]
    ds_read_b64_tr_b16 a[228:229], v78 offset:26624
    v_cvt_pk_bf16_f32 v98, v176, v177
    v_mfma_f32_16x16x32_bf16 v[132:135], a[232:235], a[116:119], v[132:135]
    ds_read_b64_tr_b16 a[230:231], v78 offset:27648
    ds_read_b32 a244, v88 offset:1088
    v_mfma_f32_16x16x32_bf16 v[136:139], a[236:239], a[44:47], v[136:139]
    ds_read_b64_tr_b16 a[232:233], v77 offset:28672
    v_cvt_pk_bf16_f32 v99, v178, v179
    v_pk_max_i16 v98, v98, 0
    v_mfma_f32_16x16x32_bf16 v[140:143], a[236:239], a[116:119], v[140:143]
    ds_read_b64_tr_b16 a[234:235], v77 offset:29696
    s_waitcnt lgkmcnt(7)
    v_mfma_f32_16x16x32_bf16 v[128:131], a[216:219], a[48:51], v[128:131]
    ds_read_b64_tr_b16 a[236:237], v78 offset:28672
    s_add_u32 m0, s46, 116736
    v_mfma_f32_16x16x32_bf16 v[132:135], a[216:219], a[120:123], v[132:135]
    ds_read_b64_tr_b16 a[238:239], v78 offset:29696
    buffer_load_dwordx4 v40, s[16:19], s73 offen lds
    v_mfma_f32_16x16x32_bf16 v[136:139], a[220:223], a[48:51], v[136:139]
    ds_read_b64_tr_b16 a[216:217], v77 offset:30720
    v_pk_max_i16 v99, v99, 0
    v_cvt_pk_bf16_f32 v100, v184, v185
    v_mfma_f32_16x16x32_bf16 v[140:143], a[220:223], a[120:123], v[140:143]
    ds_read_b64_tr_b16 a[218:219], v77 offset:31744
    s_waitcnt lgkmcnt(7)
    v_mfma_f32_16x16x32_bf16 v[128:131], a[224:227], a[52:55], v[128:131]
    ds_read_b64_tr_b16 a[220:221], v78 offset:30720
    v_cvt_pk_bf16_f32 v101, v186, v187
    v_mfma_f32_16x16x32_bf16 v[132:135], a[224:227], a[124:127], v[132:135]
    ds_read_b64_tr_b16 a[222:223], v78 offset:31744
    buffer_store_dwordx4 v[94:97], v118, s[36:39], s66 offen offset:3072 sc1
    v_mfma_f32_16x16x32_bf16 v[136:139], a[228:231], a[52:55], v[136:139]
    ds_read_b64_tr_b16 a[224:225], v77 offset:32768
    v_pk_max_i16 v100, v100, 0
    v_pk_max_i16 v101, v101, 0
    v_mfma_f32_16x16x32_bf16 v[140:143], a[228:231], a[124:127], v[140:143]
    ds_read_b64_tr_b16 a[226:227], v77 offset:33792
    s_waitcnt lgkmcnt(6)
    v_mfma_f32_16x16x32_bf16 v[128:131], a[232:235], a[56:59], v[128:131]
    ds_read_b64_tr_b16 a[228:229], v78 offset:32768
    s_add_u32 m0, s46, 117760
    v_mfma_f32_16x16x32_bf16 v[132:135], a[232:235], a[128:131], v[132:135]
    ds_read_b64_tr_b16 a[230:231], v78 offset:33792
    buffer_load_dwordx4 v41, s[16:19], s73 offen lds
    v_mfma_f32_16x16x32_bf16 v[136:139], a[236:239], a[56:59], v[136:139]
    ds_read_b64_tr_b16 a[232:233], v77 offset:34816
    v_accvgpr_write_b32 a172, v98
    v_accvgpr_write_b32 a173, v99
    v_mfma_f32_16x16x32_bf16 v[140:143], a[236:239], a[128:131], v[140:143]
    ds_read_b64_tr_b16 a[234:235], v77 offset:35840
    s_waitcnt lgkmcnt(6)
    v_mfma_f32_16x16x32_bf16 v[128:131], a[216:219], a[60:63], v[128:131]
    ds_read_b64_tr_b16 a[236:237], v78 offset:34816
    v_accvgpr_write_b32 a174, v100
    v_mfma_f32_16x16x32_bf16 v[132:135], a[216:219], a[132:135], v[132:135]
    ds_read_b64_tr_b16 a[238:239], v78 offset:35840
    buffer_store_dwordx4 v[98:101], v116, s[36:39], s66 offen offset:3072 sc1
    s_waitcnt vmcnt(22)
    s_barrier
    v_mfma_f32_16x16x32_bf16 v[136:139], a[220:223], a[60:63], v[136:139]
    ds_read_b64_tr_b16 a[216:217], v65 offset:0
    v_accvgpr_write_b32 a175, v101
    v_cvt_pk_bf16_f32 v102, v180, v181
    v_mfma_f32_16x16x32_bf16 v[140:143], a[220:223], a[132:135], v[140:143]
    ds_read_b64_tr_b16 a[218:219], v65 offset:2048
    s_waitcnt lgkmcnt(6)
    v_mfma_f32_16x16x32_bf16 v[128:131], a[224:227], a[64:67], v[128:131]
    ds_read_b64_tr_b16 a[220:221], v66 offset:0
    s_add_u32 m0, s46, 118784
    v_mfma_f32_16x16x32_bf16 v[132:135], a[224:227], a[136:139], v[132:135]
    ds_read_b64_tr_b16 a[222:223], v66 offset:2048
    buffer_load_dwordx4 v42, s[16:19], s73 offen lds
    v_mfma_f32_16x16x32_bf16 v[136:139], a[228:231], a[64:67], v[136:139]
    ds_read_b64_tr_b16 a[224:225], v67 offset:0
    v_cvt_pk_bf16_f32 v103, v182, v183
    v_pk_max_i16 v102, v102, 0
    v_mfma_f32_16x16x32_bf16 v[140:143], a[228:231], a[136:139], v[140:143]
    ds_read_b64_tr_b16 a[226:227], v67 offset:2048
    s_waitcnt lgkmcnt(6)
    v_mfma_f32_16x16x32_bf16 v[128:131], a[232:235], a[68:71], v[128:131]
    ds_read_b64_tr_b16 a[228:229], v68 offset:0
    v_pk_max_i16 v103, v103, 0
    v_mfma_f32_16x16x32_bf16 v[132:135], a[232:235], a[140:143], v[132:135]
    ds_read_b64_tr_b16 a[230:231], v68 offset:2048
    v_mfma_f32_16x16x32_bf16 v[136:139], a[236:239], a[68:71], v[136:139]
    ds_read_b64_tr_b16 a[232:233], v65 offset:4096
    s_add_u32 s57, s52, 0x180
    v_mfma_f32_16x16x32_bf16 v[140:143], a[236:239], a[140:143], v[140:143]
    ds_read_b64_tr_b16 a[234:235], v65 offset:6144
    v_mfma_f32_16x16x32_bf16 v[128:131], a[240:243], v[108:111], v[128:131]
    v_mfma_f32_16x16x32_bf16 v[132:135], a[240:243], v[112:115], v[132:135]
    v_mfma_f32_16x16x32_bf16 v[136:139], a[244:247], v[108:111], v[136:139]
    v_mfma_f32_16x16x32_bf16 v[140:143], a[244:247], v[112:115], v[140:143]
    s_barrier
    s_waitcnt lgkmcnt(6)
    v_mfma_f32_16x16x32_bf16 v[192:195], a[216:219], a[144:147], 0
    ds_read_b64_tr_b16 a[236:237], v66 offset:4096
    s_add_u32 m0, s46, 0
    v_mfma_f32_16x16x32_bf16 v[196:199], a[216:219], a[180:183], 0
    ds_read_b64_tr_b16 a[238:239], v66 offset:6144
    buffer_load_dwordx4 v34, s[16:19], s57 offen lds
    v_mfma_f32_16x16x32_bf16 v[200:203], a[220:223], a[144:147], 0
    ds_read_b64_tr_b16 a[216:217], v67 offset:4096
    v_cvt_pk_bf16_f32 v104, v188, v189
    v_cvt_pk_bf16_f32 v105, v190, v191
    v_mfma_f32_16x16x32_bf16 v[204:207], a[220:223], a[180:183], 0
    ds_read_b64_tr_b16 a[218:219], v67 offset:6144
    s_waitcnt lgkmcnt(6)
    v_mfma_f32_16x16x32_bf16 v[208:211], a[224:227], a[144:147], 0
    ds_read_b64_tr_b16 a[220:221], v68 offset:4096
    v_pk_max_i16 v104, v104, 0
    v_mfma_f32_16x16x32_bf16 v[212:215], a[224:227], a[180:183], 0
    ds_read_b64_tr_b16 a[222:223], v68 offset:6144
    s_waitcnt vmcnt(13)
    buffer_store_dwordx2 v[84:85], v82, s[60:63], s68 offen offset:0 sc1
    v_mfma_f32_16x16x32_bf16 v[216:219], a[228:231], a[144:147], 0
    ds_read_b64_tr_b16 a[224:225], v65 offset:8192
    v_pk_max_i16 v105, v105, 0
    v_accvgpr_write_b32 a208, v102
    v_mfma_f32_16x16x32_bf16 v[220:223], a[228:231], a[180:183], 0
    ds_read_b64_tr_b16 a[226:227], v65 offset:10240
    s_waitcnt lgkmcnt(6)
    v_mfma_f32_16x16x32_bf16 v[192:195], a[232:235], a[148:151], v[192:195]
    ds_read_b64_tr_b16 a[228:229], v66 offset:8192
    s_add_u32 m0, s46, 1024
    v_mfma_f32_16x16x32_bf16 v[196:199], a[232:235], a[184:187], v[196:199]
    ds_read_b64_tr_b16 a[230:231], v66 offset:10240
    buffer_load_dwordx4 v35, s[16:19], s57 offen lds
    v_mfma_f32_16x16x32_bf16 v[200:203], a[236:239], a[148:151], v[200:203]
    ds_read_b64_tr_b16 a[232:233], v67 offset:8192
    v_accvgpr_write_b32 a209, v103
    v_accvgpr_write_b32 a210, v104
    v_mfma_f32_16x16x32_bf16 v[204:207], a[236:239], a[184:187], v[204:207]
    ds_read_b64_tr_b16 a[234:235], v67 offset:10240
    s_waitcnt lgkmcnt(6)
    v_mfma_f32_16x16x32_bf16 v[208:211], a[216:219], a[148:151], v[208:211]
    ds_read_b64_tr_b16 a[236:237], v68 offset:8192
    v_accvgpr_write_b32 a211, v105
    v_mfma_f32_16x16x32_bf16 v[212:215], a[216:219], a[184:187], v[212:215]
    ds_read_b64_tr_b16 a[238:239], v68 offset:10240
    buffer_store_dwordx4 v[102:105], v119, s[36:39], s66 offen offset:0 sc1
    v_mfma_f32_16x16x32_bf16 v[216:219], a[220:223], a[148:151], v[216:219]
    ds_read_b64_tr_b16 a[216:217], v65 offset:12288
    v_cvt_pk_bf16_f32 v90, v128, v129
    v_cvt_pk_bf16_f32 v91, v130, v131
    v_mfma_f32_16x16x32_bf16 v[220:223], a[220:223], a[184:187], v[220:223]
    ds_read_b64_tr_b16 a[218:219], v65 offset:14336
    s_waitcnt lgkmcnt(6)
    v_mfma_f32_16x16x32_bf16 v[192:195], a[224:227], a[152:155], v[192:195]
    ds_read_b64_tr_b16 a[220:221], v66 offset:12288
    s_add_u32 m0, s46, 2048
    v_mfma_f32_16x16x32_bf16 v[196:199], a[224:227], a[188:191], v[196:199]
    ds_read_b64_tr_b16 a[222:223], v66 offset:14336
    buffer_load_dwordx4 v36, s[16:19], s57 offen lds
    v_mfma_f32_16x16x32_bf16 v[200:203], a[228:231], a[152:155], v[200:203]
    ds_read_b64_tr_b16 a[224:225], v67 offset:12288
    v_pk_max_i16 v90, v90, 0
    v_pk_max_i16 v91, v91, 0
    v_mfma_f32_16x16x32_bf16 v[204:207], a[228:231], a[188:191], v[204:207]
    ds_read_b64_tr_b16 a[226:227], v67 offset:14336
    s_waitcnt lgkmcnt(6)
    v_mfma_f32_16x16x32_bf16 v[208:211], a[232:235], a[152:155], v[208:211]
    ds_read_b64_tr_b16 a[228:229], v68 offset:12288
    v_cvt_pk_bf16_f32 v92, v136, v137
    v_mfma_f32_16x16x32_bf16 v[212:215], a[232:235], a[188:191], v[212:215]
    ds_read_b64_tr_b16 a[230:231], v68 offset:14336
    v_mfma_f32_16x16x32_bf16 v[216:219], a[236:239], a[152:155], v[216:219]
    ds_read_b64_tr_b16 a[232:233], v65 offset:16384
    v_cvt_pk_bf16_f32 v93, v138, v139
    v_pk_max_i16 v92, v92, 0
    v_mfma_f32_16x16x32_bf16 v[220:223], a[236:239], a[188:191], v[220:223]
    ds_read_b64_tr_b16 a[234:235], v65 offset:18432
    s_waitcnt lgkmcnt(6)
    v_mfma_f32_16x16x32_bf16 v[192:195], a[216:219], a[156:159], v[192:195]
    ds_read_b64_tr_b16 a[236:237], v66 offset:16384
    s_add_u32 m0, s46, 3072
    v_mfma_f32_16x16x32_bf16 v[196:199], a[216:219], a[192:195], v[196:199]
    ds_read_b64_tr_b16 a[238:239], v66 offset:18432
    buffer_load_dwordx4 v37, s[16:19], s57 offen lds
    v_mfma_f32_16x16x32_bf16 v[200:203], a[220:223], a[156:159], v[200:203]
    ds_read_b64_tr_b16 a[216:217], v67 offset:16384
    v_pk_max_i16 v93, v93, 0
    v_accvgpr_write_b32 a176, v90
    v_mfma_f32_16x16x32_bf16 v[204:207], a[220:223], a[192:195], v[204:207]
    ds_read_b64_tr_b16 a[218:219], v67 offset:18432
    s_waitcnt lgkmcnt(6)
    v_mfma_f32_16x16x32_bf16 v[208:211], a[224:227], a[156:159], v[208:211]
    ds_read_b64_tr_b16 a[220:221], v68 offset:16384
    v_accvgpr_write_b32 a177, v91
    v_mfma_f32_16x16x32_bf16 v[212:215], a[224:227], a[192:195], v[212:215]
    ds_read_b64_tr_b16 a[222:223], v68 offset:18432
    buffer_store_dwordx4 v[90:93], v117, s[36:39], s66 offen offset:0 sc1
    v_mfma_f32_16x16x32_bf16 v[216:219], a[228:231], a[156:159], v[216:219]
    ds_read_b64_tr_b16 a[224:225], v65 offset:20480
    v_accvgpr_write_b32 a178, v92
    v_accvgpr_write_b32 a179, v93
    v_mfma_f32_16x16x32_bf16 v[220:223], a[228:231], a[192:195], v[220:223]
    ds_read_b64_tr_b16 a[226:227], v65 offset:22528
    s_waitcnt lgkmcnt(6)
    v_mfma_f32_16x16x32_bf16 v[192:195], a[232:235], a[160:163], v[192:195]
    ds_read_b64_tr_b16 a[228:229], v66 offset:20480
    s_add_u32 m0, s46, 4096
    v_mfma_f32_16x16x32_bf16 v[196:199], a[232:235], a[196:199], v[196:199]
    ds_read_b64_tr_b16 a[230:231], v66 offset:22528
    buffer_load_dwordx4 v38, s[16:19], s57 offen lds
    v_mfma_f32_16x16x32_bf16 v[200:203], a[236:239], a[160:163], v[200:203]
    ds_read_b64_tr_b16 a[232:233], v67 offset:20480
    v_cvt_pk_bf16_f32 v94, v132, v133
    v_cvt_pk_bf16_f32 v95, v134, v135
    v_mfma_f32_16x16x32_bf16 v[204:207], a[236:239], a[196:199], v[204:207]
    ds_read_b64_tr_b16 a[234:235], v67 offset:22528
    s_waitcnt lgkmcnt(6)
    v_mfma_f32_16x16x32_bf16 v[208:211], a[216:219], a[160:163], v[208:211]
    ds_read_b64_tr_b16 a[236:237], v68 offset:20480
    v_pk_max_i16 v94, v94, 0
    v_mfma_f32_16x16x32_bf16 v[212:215], a[216:219], a[196:199], v[212:215]
    ds_read_b64_tr_b16 a[238:239], v68 offset:22528
    v_mfma_f32_16x16x32_bf16 v[216:219], a[220:223], a[160:163], v[216:219]
    ds_read_b64_tr_b16 a[216:217], v65 offset:24576
    v_pk_max_i16 v95, v95, 0
    v_cvt_pk_bf16_f32 v96, v140, v141
    v_mfma_f32_16x16x32_bf16 v[220:223], a[220:223], a[196:199], v[220:223]
    ds_read_b64_tr_b16 a[218:219], v65 offset:26624
    s_waitcnt lgkmcnt(6)
    v_mfma_f32_16x16x32_bf16 v[192:195], a[224:227], a[164:167], v[192:195]
    ds_read_b64_tr_b16 a[220:221], v66 offset:24576
    s_add_u32 m0, s46, 5120
    v_mfma_f32_16x16x32_bf16 v[196:199], a[224:227], a[200:203], v[196:199]
    ds_read_b64_tr_b16 a[222:223], v66 offset:26624
    buffer_load_dwordx4 v39, s[16:19], s57 offen lds
    v_mfma_f32_16x16x32_bf16 v[200:203], a[228:231], a[164:167], v[200:203]
    ds_read_b64_tr_b16 a[224:225], v67 offset:24576
    v_cvt_pk_bf16_f32 v97, v142, v143
    v_pk_max_i16 v96, v96, 0
    v_mfma_f32_16x16x32_bf16 v[204:207], a[228:231], a[200:203], v[204:207]
    ds_read_b64_tr_b16 a[226:227], v67 offset:26624
    s_waitcnt lgkmcnt(6)
    v_mfma_f32_16x16x32_bf16 v[208:211], a[232:235], a[164:167], v[208:211]
    ds_read_b64_tr_b16 a[228:229], v68 offset:24576
    v_pk_max_i16 v97, v97, 0
    v_mfma_f32_16x16x32_bf16 v[212:215], a[232:235], a[200:203], v[212:215]
    ds_read_b64_tr_b16 a[230:231], v68 offset:26624
    buffer_store_dwordx4 v[94:97], v119, s[36:39], s66 offen offset:1024 sc1
    v_mfma_f32_16x16x32_bf16 v[216:219], a[236:239], a[164:167], v[216:219]
    ds_read_b64_tr_b16 a[232:233], v65 offset:28672
    v_accvgpr_write_b32 a212, v94
    v_accvgpr_write_b32 a213, v95
    v_mfma_f32_16x16x32_bf16 v[220:223], a[236:239], a[200:203], v[220:223]
    ds_read_b64_tr_b16 a[234:235], v65 offset:30720
    s_waitcnt lgkmcnt(6)
    v_mfma_f32_16x16x32_bf16 v[192:195], a[216:219], a[168:171], v[192:195]
    ds_read_b64_tr_b16 a[236:237], v66 offset:28672
    s_add_u32 m0, s46, 6144
    v_mfma_f32_16x16x32_bf16 v[196:199], a[216:219], a[204:207], v[196:199]
    ds_read_b64_tr_b16 a[238:239], v66 offset:30720
    buffer_load_dwordx4 v40, s[16:19], s57 offen lds
    v_mfma_f32_16x16x32_bf16 v[200:203], a[220:223], a[168:171], v[200:203]
    ds_read_b64_tr_b16 a[216:217], v67 offset:28672
    v_accvgpr_write_b32 a214, v96
    v_accvgpr_write_b32 a215, v97
    v_mfma_f32_16x16x32_bf16 v[204:207], a[220:223], a[204:207], v[204:207]
    ds_read_b64_tr_b16 a[218:219], v67 offset:30720
    s_waitcnt lgkmcnt(6)
    v_mfma_f32_16x16x32_bf16 v[208:211], a[224:227], a[168:171], v[208:211]
    ds_read_b64_tr_b16 a[220:221], v68 offset:28672
    v_mfma_f32_16x16x32_bf16 v[212:215], a[224:227], a[204:207], v[212:215]
    ds_read_b64_tr_b16 a[222:223], v68 offset:30720
    v_mfma_f32_16x16x32_bf16 v[216:219], a[228:231], a[168:171], v[216:219]
    ds_read_b64_tr_b16 a[224:225], v65 offset:32768
    v_mfma_f32_16x16x32_bf16 v[220:223], a[228:231], a[204:207], v[220:223]
    ds_read_b64_tr_b16 a[226:227], v65 offset:34816
    s_waitcnt lgkmcnt(6)
    v_mfma_f32_16x16x32_bf16 v[192:195], a[232:235], a[172:175], v[192:195]
    ds_read_b64_tr_b16 a[228:229], v66 offset:32768
    s_add_u32 m0, s46, 7168
    v_mfma_f32_16x16x32_bf16 v[196:199], a[232:235], a[208:211], v[196:199]
    ds_read_b64_tr_b16 a[230:231], v66 offset:34816
    buffer_load_dwordx4 v41, s[16:19], s57 offen lds
    v_mfma_f32_16x16x32_bf16 v[200:203], a[236:239], a[172:175], v[200:203]
    ds_read_b64_tr_b16 a[232:233], v67 offset:32768
    v_mfma_f32_16x16x32_bf16 v[204:207], a[236:239], a[208:211], v[204:207]
    ds_read_b64_tr_b16 a[234:235], v67 offset:34816
    s_waitcnt lgkmcnt(6)
    v_mfma_f32_16x16x32_bf16 v[208:211], a[216:219], a[172:175], v[208:211]
    ds_read_b64_tr_b16 a[236:237], v68 offset:32768
    v_mfma_f32_16x16x32_bf16 v[212:215], a[216:219], a[208:211], v[212:215]
    ds_read_b64_tr_b16 a[238:239], v68 offset:34816
    s_barrier
    v_mfma_f32_16x16x32_bf16 v[216:219], a[220:223], a[172:175], v[216:219]
    ds_read_b64_tr_b16 a[216:217], v69 offset:0
    v_mfma_f32_16x16x32_bf16 v[220:223], a[220:223], a[208:211], v[220:223]
    ds_read_b64_tr_b16 a[218:219], v69 offset:2048
    s_waitcnt lgkmcnt(6)
    v_mfma_f32_16x16x32_bf16 v[192:195], a[224:227], a[176:179], v[192:195]
    ds_read_b64_tr_b16 a[220:221], v70 offset:0
    s_add_u32 m0, s46, 8192
    v_mfma_f32_16x16x32_bf16 v[196:199], a[224:227], a[212:215], v[196:199]
    ds_read_b64_tr_b16 a[222:223], v70 offset:2048
    buffer_load_dwordx4 v42, s[16:19], s57 offen lds
    v_mfma_f32_16x16x32_bf16 v[200:203], a[228:231], a[176:179], v[200:203]
    ds_read_b64_tr_b16 a[224:225], v71 offset:0
    v_mfma_f32_16x16x32_bf16 v[204:207], a[228:231], a[212:215], v[204:207]
    ds_read_b64_tr_b16 a[226:227], v71 offset:2048
    s_waitcnt lgkmcnt(6)
    v_mfma_f32_16x16x32_bf16 v[208:211], a[232:235], a[176:179], v[208:211]
    ds_read_b64_tr_b16 a[228:229], v72 offset:0
    v_mfma_f32_16x16x32_bf16 v[212:215], a[232:235], a[212:215], v[212:215]
    ds_read_b64_tr_b16 a[230:231], v72 offset:2048
    buffer_load_dwordx2 v[86:87], v82, s[60:63], s69 offen offset:0 sc1
    v_mfma_f32_16x16x32_bf16 v[216:219], a[236:239], a[176:179], v[216:219]
    ds_read_b64_tr_b16 a[232:233], v69 offset:4096
    s_add_u32 s73, s52, 0x0
    v_mfma_f32_16x16x32_bf16 v[220:223], a[236:239], a[212:215], v[220:223]
    ds_read_b64_tr_b16 a[234:235], v69 offset:6144
    s_barrier
    s_waitcnt lgkmcnt(6)
    v_mfma_f32_16x16x32_bf16 v[224:227], a[216:219], a[144:147], 0
    ds_read_b64_tr_b16 a[236:237], v70 offset:4096
    s_add_u32 m0, s46, 36864
    v_mfma_f32_16x16x32_bf16 v[228:231], a[216:219], a[180:183], 0
    ds_read_b64_tr_b16 a[238:239], v70 offset:6144
    buffer_load_dwordx4 v43, s[16:19], s73 offen lds
    v_mfma_f32_16x16x32_bf16 v[232:235], a[220:223], a[144:147], 0
    ds_read_b64_tr_b16 a[216:217], v71 offset:4096
    s_load_dwordx2 s[4:5], s[0:1], 56
    v_mfma_f32_16x16x32_bf16 v[236:239], a[220:223], a[180:183], 0
    ds_read_b64_tr_b16 a[218:219], v71 offset:6144
    s_waitcnt lgkmcnt(6)
    v_mfma_f32_16x16x32_bf16 v[240:243], a[224:227], a[144:147], 0
    ds_read_b64_tr_b16 a[220:221], v72 offset:4096
    s_lshl_b32 s76, s11, 1
    v_mfma_f32_16x16x32_bf16 v[244:247], a[224:227], a[180:183], 0
    ds_read_b64_tr_b16 a[222:223], v72 offset:6144
    v_mfma_f32_16x16x32_bf16 v[248:251], a[228:231], a[144:147], 0
    ds_read_b64_tr_b16 a[224:225], v69 offset:8192
    s_add_u32 s76, s76, s10
    v_mfma_f32_16x16x32_bf16 v[252:255], a[228:231], a[180:183], 0
    ds_read_b64_tr_b16 a[226:227], v69 offset:10240
    s_waitcnt lgkmcnt(6)
    v_mfma_f32_16x16x32_bf16 v[224:227], a[232:235], a[148:151], v[224:227]
    ds_read_b64_tr_b16 a[228:229], v70 offset:8192
    s_add_u32 m0, s46, 37888
    v_mfma_f32_16x16x32_bf16 v[228:231], a[232:235], a[184:187], v[228:231]
    ds_read_b64_tr_b16 a[230:231], v70 offset:10240
    buffer_load_dwordx4 v44, s[16:19], s73 offen lds
    v_mfma_f32_16x16x32_bf16 v[232:235], a[236:239], a[148:151], v[232:235]
    ds_read_b64_tr_b16 a[232:233], v71 offset:8192
    s_lshl_b32 s76, s76, 2
    v_mfma_f32_16x16x32_bf16 v[236:239], a[236:239], a[184:187], v[236:239]
    ds_read_b64_tr_b16 a[234:235], v71 offset:10240
    s_waitcnt lgkmcnt(6)
    v_mfma_f32_16x16x32_bf16 v[240:243], a[216:219], a[148:151], v[240:243]
    ds_read_b64_tr_b16 a[236:237], v72 offset:8192
    s_add_u32 s76, s76, s20
    v_mfma_f32_16x16x32_bf16 v[244:247], a[216:219], a[184:187], v[244:247]
    ds_read_b64_tr_b16 a[238:239], v72 offset:10240
    v_mfma_f32_16x16x32_bf16 v[248:251], a[220:223], a[148:151], v[248:251]
    ds_read_b64_tr_b16 a[216:217], v69 offset:12288
    s_lshl_b32 s76, s76, 7
    v_mfma_f32_16x16x32_bf16 v[252:255], a[220:223], a[184:187], v[252:255]
    ds_read_b64_tr_b16 a[218:219], v69 offset:14336
    s_waitcnt lgkmcnt(6)
    v_mfma_f32_16x16x32_bf16 v[224:227], a[224:227], a[152:155], v[224:227]
    ds_read_b64_tr_b16 a[220:221], v70 offset:12288
    s_add_u32 m0, s46, 38912
    v_mfma_f32_16x16x32_bf16 v[228:231], a[224:227], a[188:191], v[228:231]
    ds_read_b64_tr_b16 a[222:223], v70 offset:14336
    buffer_load_dwordx4 v45, s[16:19], s73 offen lds
    v_mfma_f32_16x16x32_bf16 v[232:235], a[228:231], a[152:155], v[232:235]
    ds_read_b64_tr_b16 a[224:225], v71 offset:12288
    s_add_u32 s76, s76, 147456
    v_mfma_f32_16x16x32_bf16 v[236:239], a[228:231], a[188:191], v[236:239]
    ds_read_b64_tr_b16 a[226:227], v71 offset:14336
    s_waitcnt lgkmcnt(6)
    v_mfma_f32_16x16x32_bf16 v[240:243], a[232:235], a[152:155], v[240:243]
    ds_read_b64_tr_b16 a[228:229], v72 offset:12288
    s_lshl_b32 s77, s3, 3
    v_mfma_f32_16x16x32_bf16 v[244:247], a[232:235], a[188:191], v[244:247]
    ds_read_b64_tr_b16 a[230:231], v72 offset:14336
    s_waitcnt vmcnt(13)
    buffer_store_dwordx2 v[84:85], v82, s[60:63], s68 offen offset:32 sc1
    v_mfma_f32_16x16x32_bf16 v[248:251], a[236:239], a[152:155], v[248:251]
    ds_read_b64_tr_b16 a[232:233], v69 offset:16384
    s_add_u32 s77, s77, s76
    v_mfma_f32_16x16x32_bf16 v[252:255], a[236:239], a[188:191], v[252:255]
    ds_read_b64_tr_b16 a[234:235], v69 offset:18432
    s_waitcnt lgkmcnt(6)
    v_mfma_f32_16x16x32_bf16 v[224:227], a[216:219], a[156:159], v[224:227]
    ds_read_b64_tr_b16 a[236:237], v70 offset:16384
    s_add_u32 m0, s46, 39936
    v_mfma_f32_16x16x32_bf16 v[228:231], a[216:219], a[192:195], v[228:231]
    ds_read_b64_tr_b16 a[238:239], v70 offset:18432
    buffer_load_dwordx4 v46, s[16:19], s73 offen lds
    v_mfma_f32_16x16x32_bf16 v[232:235], a[220:223], a[156:159], v[232:235]
    ds_read_b64_tr_b16 a[216:217], v71 offset:16384
    s_bfe_u32 s44, s3, 0x10001
    v_mfma_f32_16x16x32_bf16 v[236:239], a[220:223], a[192:195], v[236:239]
    ds_read_b64_tr_b16 a[218:219], v71 offset:18432
    s_waitcnt lgkmcnt(6)
    v_mfma_f32_16x16x32_bf16 v[240:243], a[224:227], a[156:159], v[240:243]
    ds_read_b64_tr_b16 a[220:221], v72 offset:16384
    s_add_u32 s44, s44, s54
    v_mfma_f32_16x16x32_bf16 v[244:247], a[224:227], a[192:195], v[244:247]
    ds_read_b64_tr_b16 a[222:223], v72 offset:18432
    v_mfma_f32_16x16x32_bf16 v[248:251], a[228:231], a[156:159], v[248:251]
    ds_read_b64_tr_b16 a[224:225], v69 offset:20480
    s_lshr_b32 s45, s21, 5
    v_mfma_f32_16x16x32_bf16 v[252:255], a[228:231], a[192:195], v[252:255]
    ds_read_b64_tr_b16 a[226:227], v69 offset:22528
    s_waitcnt lgkmcnt(6)
    v_mfma_f32_16x16x32_bf16 v[224:227], a[232:235], a[160:163], v[224:227]
    ds_read_b64_tr_b16 a[228:229], v70 offset:20480
    s_add_u32 m0, s46, 40960
    v_mfma_f32_16x16x32_bf16 v[228:231], a[232:235], a[196:199], v[228:231]
    ds_read_b64_tr_b16 a[230:231], v70 offset:22528
    buffer_load_dwordx4 v47, s[16:19], s73 offen lds
    v_mfma_f32_16x16x32_bf16 v[232:235], a[236:239], a[160:163], v[232:235]
    ds_read_b64_tr_b16 a[232:233], v71 offset:20480
    s_and_b32 s47, s3, 1
    v_mfma_f32_16x16x32_bf16 v[236:239], a[236:239], a[196:199], v[236:239]
    ds_read_b64_tr_b16 a[234:235], v71 offset:22528
    s_waitcnt lgkmcnt(6)
    v_mfma_f32_16x16x32_bf16 v[240:243], a[216:219], a[160:163], v[240:243]
    ds_read_b64_tr_b16 a[236:237], v72 offset:20480
    s_add_u32 s45, s45, s47
    v_mfma_f32_16x16x32_bf16 v[244:247], a[216:219], a[196:199], v[244:247]
    ds_read_b64_tr_b16 a[238:239], v72 offset:22528
    v_mfma_f32_16x16x32_bf16 v[248:251], a[220:223], a[160:163], v[248:251]
    ds_read_b64_tr_b16 a[216:217], v69 offset:24576
    s_lshr_b32 s47, s3, 2
    v_mfma_f32_16x16x32_bf16 v[252:255], a[220:223], a[196:199], v[252:255]
    ds_read_b64_tr_b16 a[218:219], v69 offset:26624
    s_waitcnt lgkmcnt(6)
    v_mfma_f32_16x16x32_bf16 v[224:227], a[224:227], a[164:167], v[224:227]
    ds_read_b64_tr_b16 a[220:221], v70 offset:24576
    s_add_u32 m0, s46, 41984
    v_mfma_f32_16x16x32_bf16 v[228:231], a[224:227], a[200:203], v[228:231]
    ds_read_b64_tr_b16 a[222:223], v70 offset:26624
    buffer_load_dwordx4 v48, s[16:19], s73 offen lds
    v_mfma_f32_16x16x32_bf16 v[232:235], a[228:231], a[164:167], v[232:235]
    ds_read_b64_tr_b16 a[224:225], v71 offset:24576
    s_lshl_b32 s47, s47, 1
    v_mfma_f32_16x16x32_bf16 v[236:239], a[228:231], a[200:203], v[236:239]
    ds_read_b64_tr_b16 a[226:227], v71 offset:26624
    s_waitcnt lgkmcnt(6)
    v_mfma_f32_16x16x32_bf16 v[240:243], a[232:235], a[164:167], v[240:243]
    ds_read_b64_tr_b16 a[228:229], v72 offset:24576
    s_add_u32 s47, s47, s45
    v_mfma_f32_16x16x32_bf16 v[244:247], a[232:235], a[200:203], v[244:247]
    ds_read_b64_tr_b16 a[230:231], v72 offset:26624
    v_mfma_f32_16x16x32_bf16 v[248:251], a[236:239], a[164:167], v[248:251]
    ds_read_b64_tr_b16 a[232:233], v69 offset:28672
    s_add_u32 s48, s45, 4
    v_mfma_f32_16x16x32_bf16 v[252:255], a[236:239], a[200:203], v[252:255]
    ds_read_b64_tr_b16 a[234:235], v69 offset:30720
    s_waitcnt lgkmcnt(6)
    v_mfma_f32_16x16x32_bf16 v[224:227], a[216:219], a[168:171], v[224:227]
    ds_read_b64_tr_b16 a[236:237], v70 offset:28672
    s_add_u32 m0, s46, 43008
    v_mfma_f32_16x16x32_bf16 v[228:231], a[216:219], a[204:207], v[228:231]
    ds_read_b64_tr_b16 a[238:239], v70 offset:30720
    buffer_load_dwordx4 v49, s[16:19], s73 offen lds
    v_mfma_f32_16x16x32_bf16 v[232:235], a[220:223], a[168:171], v[232:235]
    ds_read_b64_tr_b16 a[216:217], v71 offset:28672
    s_add_u32 s45, s45, 6
    v_mfma_f32_16x16x32_bf16 v[236:239], a[220:223], a[204:207], v[236:239]
    ds_read_b64_tr_b16 a[218:219], v71 offset:30720
    s_waitcnt lgkmcnt(6)
    v_mfma_f32_16x16x32_bf16 v[240:243], a[224:227], a[168:171], v[240:243]
    ds_read_b64_tr_b16 a[220:221], v72 offset:28672
    s_lshr_b32 s49, s22, 5
    v_mfma_f32_16x16x32_bf16 v[244:247], a[224:227], a[204:207], v[244:247]
    ds_read_b64_tr_b16 a[222:223], v72 offset:30720
    v_mfma_f32_16x16x32_bf16 v[248:251], a[228:231], a[168:171], v[248:251]
    ds_read_b64_tr_b16 a[224:225], v69 offset:32768
    s_cmp_ge_u32 s3, 4
    s_cselect_b32 s49, s45, s49
    v_mfma_f32_16x16x32_bf16 v[252:255], a[228:231], a[204:207], v[252:255]
    ds_read_b64_tr_b16 a[226:227], v69 offset:34816
    s_waitcnt lgkmcnt(6)
    v_mfma_f32_16x16x32_bf16 v[224:227], a[232:235], a[172:175], v[224:227]
    ds_read_b64_tr_b16 a[228:229], v70 offset:32768
    s_add_u32 m0, s46, 44032
    v_mfma_f32_16x16x32_bf16 v[228:231], a[232:235], a[208:211], v[228:231]
    ds_read_b64_tr_b16 a[230:231], v70 offset:34816
    buffer_load_dwordx4 v50, s[16:19], s73 offen lds
    v_mfma_f32_16x16x32_bf16 v[232:235], a[236:239], a[172:175], v[232:235]
    ds_read_b64_tr_b16 a[232:233], v71 offset:32768
    s_mul_i32 s45, s44, 18432
    v_mfma_f32_16x16x32_bf16 v[236:239], a[236:239], a[208:211], v[236:239]
    ds_read_b64_tr_b16 a[234:235], v71 offset:34816
    s_waitcnt lgkmcnt(6)
    v_mfma_f32_16x16x32_bf16 v[240:243], a[216:219], a[172:175], v[240:243]
    ds_read_b64_tr_b16 a[236:237], v72 offset:32768
    v_and_b32 v4, 15, v1
    v_mfma_f32_16x16x32_bf16 v[244:247], a[216:219], a[208:211], v[244:247]
    ds_read_b64_tr_b16 a[238:239], v72 offset:34816
    s_waitcnt vmcnt(13)
    buffer_store_dwordx2 v[84:85], v82, s[60:63], s68 offen offset:64 sc1
    s_barrier
    v_mfma_f32_16x16x32_bf16 v[248:251], a[220:223], a[172:175], v[248:251]
    ds_read_b64_tr_b16 a[216:217], v73 offset:0
    v_lshl_add_u32 v4, s44, 4, v4
    v_mfma_f32_16x16x32_bf16 v[252:255], a[220:223], a[208:211], v[252:255]
    ds_read_b64_tr_b16 a[218:219], v73 offset:2048
    s_waitcnt lgkmcnt(6)
    v_mfma_f32_16x16x32_bf16 v[224:227], a[224:227], a[176:179], v[224:227]
    ds_read_b64_tr_b16 a[220:221], v74 offset:0
    s_add_u32 m0, s46, 45056
    v_mfma_f32_16x16x32_bf16 v[228:231], a[224:227], a[212:215], v[228:231]
    ds_read_b64_tr_b16 a[222:223], v74 offset:2048
    buffer_load_dwordx4 v51, s[16:19], s73 offen lds
    v_mfma_f32_16x16x32_bf16 v[232:235], a[228:231], a[176:179], v[232:235]
    ds_read_b64_tr_b16 a[224:225], v75 offset:0
    v_mul_u32_u24 v4, 1152, v4
    v_mfma_f32_16x16x32_bf16 v[236:239], a[228:231], a[212:215], v[236:239]
    ds_read_b64_tr_b16 a[226:227], v75 offset:2048
    s_waitcnt lgkmcnt(6)
    v_mfma_f32_16x16x32_bf16 v[240:243], a[232:235], a[176:179], v[240:243]
    ds_read_b64_tr_b16 a[228:229], v76 offset:0
    v_lshrrev_b32 v5, 4, v1
    v_mfma_f32_16x16x32_bf16 v[244:247], a[232:235], a[212:215], v[244:247]
    ds_read_b64_tr_b16 a[230:231], v76 offset:2048
    v_mfma_f32_16x16x32_bf16 v[248:251], a[236:239], a[176:179], v[248:251]
    ds_read_b64_tr_b16 a[232:233], v73 offset:4096
    s_add_u32 s57, s52, 0x80
    v_mfma_f32_16x16x32_bf16 v[252:255], a[236:239], a[212:215], v[252:255]
    ds_read_b64_tr_b16 a[234:235], v73 offset:6144
    s_barrier
    s_waitcnt lgkmcnt(6)
    v_mfma_f32_16x16x32_bf16 v[160:163], a[216:219], a[144:147], 0
    ds_read_b64_tr_b16 a[236:237], v74 offset:4096
    s_add_u32 m0, s46, 73728
    v_mfma_f32_16x16x32_bf16 v[164:167], a[216:219], a[180:183], 0
    ds_read_b64_tr_b16 a[238:239], v74 offset:6144
    buffer_load_dwordx4 v43, s[16:19], s57 offen lds
    v_mfma_f32_16x16x32_bf16 v[168:171], a[220:223], a[144:147], 0
    ds_read_b64_tr_b16 a[216:217], v75 offset:4096
    v_and_b32 v6, 1, v5
    v_mfma_f32_16x16x32_bf16 v[172:175], a[220:223], a[180:183], 0
    ds_read_b64_tr_b16 a[218:219], v75 offset:6144
    s_waitcnt lgkmcnt(6)
    v_mfma_f32_16x16x32_bf16 v[176:179], a[224:227], a[144:147], 0
    ds_read_b64_tr_b16 a[220:221], v76 offset:4096
    v_and_b32 v5, 2, v5
    v_mfma_f32_16x16x32_bf16 v[180:183], a[224:227], a[180:183], 0
    ds_read_b64_tr_b16 a[222:223], v76 offset:6144
    s_waitcnt vmcnt(12)
    v_readfirstlane_b32 s74, v86
    v_readfirstlane_b32 s75, v87
    s_cmp_eq_u64 s[74:75], s[100:101]
    s_cbranch_scc0 L_k3_slow0
L_k3_back0:
    v_mfma_f32_16x16x32_bf16 v[184:187], a[228:231], a[144:147], 0
    ds_read_b64_tr_b16 a[224:225], v73 offset:8192
    v_lshl_add_u32 v4, v5, 3, v4
    v_mfma_f32_16x16x32_bf16 v[188:191], a[228:231], a[180:183], 0
    ds_read_b64_tr_b16 a[226:227], v73 offset:10240
    s_waitcnt lgkmcnt(6)
    v_mfma_f32_16x16x32_bf16 v[160:163], a[232:235], a[148:151], v[160:163]
    ds_read_b64_tr_b16 a[228:229], v74 offset:8192
    s_add_u32 m0, s46, 74752
    v_mfma_f32_16x16x32_bf16 v[164:167], a[232:235], a[184:187], v[164:167]
    ds_read_b64_tr_b16 a[230:231], v74 offset:10240
    buffer_load_dwordx4 v44, s[16:19], s57 offen lds
    v_mfma_f32_16x16x32_bf16 v[168:171], a[236:239], a[148:151], v[168:171]
    ds_read_b64_tr_b16 a[232:233], v75 offset:8192
    v_lshl_add_u32 v121, v6, 5, v4
    v_mfma_f32_16x16x32_bf16 v[172:175], a[236:239], a[184:187], v[172:175]
    ds_read_b64_tr_b16 a[234:235], v75 offset:10240
    s_waitcnt lgkmcnt(6)
    v_mfma_f32_16x16x32_bf16 v[176:179], a[216:219], a[148:151], v[176:179]
    ds_read_b64_tr_b16 a[236:237], v76 offset:8192
    v_min_u32 v5, 7, v1
    v_mfma_f32_16x16x32_bf16 v[180:183], a[216:219], a[184:187], v[180:183]
    ds_read_b64_tr_b16 a[238:239], v76 offset:10240
    buffer_load_dwordx4 a[0:3], v81, s[36:39], s67 offen offset:0 sc1
    v_mfma_f32_16x16x32_bf16 v[184:187], a[220:223], a[148:151], v[184:187]
    ds_read_b64_tr_b16 a[216:217], v73 offset:12288
    v_lshlrev_b32 v120, 3, v5
    v_mfma_f32_16x16x32_bf16 v[188:191], a[220:223], a[184:187], v[188:191]
    ds_read_b64_tr_b16 a[218:219], v73 offset:14336
    s_waitcnt lgkmcnt(6)
    v_mfma_f32_16x16x32_bf16 v[160:163], a[224:227], a[152:155], v[160:163]
    ds_read_b64_tr_b16 a[220:221], v74 offset:12288
    s_add_u32 m0, s46, 75776
    v_mfma_f32_16x16x32_bf16 v[164:167], a[224:227], a[188:191], v[164:167]
    ds_read_b64_tr_b16 a[222:223], v74 offset:14336
    buffer_load_dwordx4 v45, s[16:19], s57 offen lds
    v_mfma_f32_16x16x32_bf16 v[168:171], a[228:231], a[152:155], v[168:171]
    ds_read_b64_tr_b16 a[224:225], v75 offset:12288
    v_mfma_f32_16x16x32_bf16 v[172:175], a[228:231], a[188:191], v[172:175]
    ds_read_b64_tr_b16 a[226:227], v75 offset:14336
    s_waitcnt lgkmcnt(6)
    v_mfma_f32_16x16x32_bf16 v[176:179], a[232:235], a[152:155], v[176:179]
    ds_read_b64_tr_b16 a[228:229], v76 offset:12288
    v_mfma_f32_16x16x32_bf16 v[180:183], a[232:235], a[188:191], v[180:183]
    ds_read_b64_tr_b16 a[230:231], v76 offset:14336
    buffer_load_dwordx2 v[126:127], v82, s[60:63], s69 offen offset:32 sc1
    v_mfma_f32_16x16x32_bf16 v[184:187], a[236:239], a[152:155], v[184:187]
    ds_read_b64_tr_b16 a[232:233], v73 offset:16384
    v_mfma_f32_16x16x32_bf16 v[188:191], a[236:239], a[188:191], v[188:191]
    ds_read_b64_tr_b16 a[234:235], v73 offset:18432
    s_waitcnt lgkmcnt(6)
    v_mfma_f32_16x16x32_bf16 v[160:163], a[216:219], a[156:159], v[160:163]
    ds_read_b64_tr_b16 a[236:237], v74 offset:16384
    s_add_u32 m0, s46, 76800
    v_mfma_f32_16x16x32_bf16 v[164:167], a[216:219], a[192:195], v[164:167]
    ds_read_b64_tr_b16 a[238:239], v74 offset:18432
    buffer_load_dwordx4 v46, s[16:19], s57 offen lds
    v_mfma_f32_16x16x32_bf16 v[168:171], a[220:223], a[156:159], v[168:171]
    ds_read_b64_tr_b16 a[216:217], v75 offset:16384
    v_mfma_f32_16x16x32_bf16 v[172:175], a[220:223], a[192:195], v[172:175]
    ds_read_b64_tr_b16 a[218:219], v75 offset:18432
    s_waitcnt lgkmcnt(6)
    v_mfma_f32_16x16x32_bf16 v[176:179], a[224:227], a[156:159], v[176:179]
    ds_read_b64_tr_b16 a[220:221], v76 offset:16384
    v_mfma_f32_16x16x32_bf16 v[180:183], a[224:227], a[192:195], v[180:183]
    ds_read_b64_tr_b16 a[222:223], v76 offset:18432
    buffer_load_dwordx4 a[36:39], v117, s[36:39], s67 offen offset:1024 sc1
    v_mfma_f32_16x16x32_bf16 v[184:187], a[228:231], a[156:159], v[184:187]
    ds_read_b64_tr_b16 a[224:225], v73 offset:20480
    v_mfma_f32_16x16x32_bf16 v[188:191], a[228:231], a[192:195], v[188:191]
    ds_read_b64_tr_b16 a[226:227], v73 offset:22528
    s_waitcnt lgkmcnt(6)
    v_mfma_f32_16x16x32_bf16 v[160:163], a[232:235], a[160:163], v[160:163]
    ds_read_b64_tr_b16 a[228:229], v74 offset:20480
    s_add_u32 m0, s46, 77824
    v_mfma_f32_16x16x32_bf16 v[164:167], a[232:235], a[196:199], v[164:167]
    ds_read_b64_tr_b16 a[230:231], v74 offset:22528
    buffer_load_dwordx4 v47, s[16:19], s57 offen lds
    v_mfma_f32_16x16x32_bf16 v[168:171], a[236:239], a[160:163], v[168:171]
    ds_read_b64_tr_b16 a[232:233], v75 offset:20480
    v_mfma_f32_16x16x32_bf16 v[172:175], a[236:239], a[196:199], v[172:175]
    ds_read_b64_tr_b16 a[234:235], v75 offset:22528
    s_waitcnt lgkmcnt(6)
    v_mfma_f32_16x16x32_bf16 v[176:179], a[216:219], a[160:163], v[176:179]
    ds_read_b64_tr_b16 a[236:237], v76 offset:20480
    v_mfma_f32_16x16x32_bf16 v[180:183], a[216:219], a[196:199], v[180:183]
    ds_read_b64_tr_b16 a[238:239], v76 offset:22528
    buffer_load_dwordx4 a[4:7], v81, s[36:39], s67 offen offset:1024 sc1
    v_mfma_f32_16x16x32_bf16 v[184:187], a[220:223], a[160:163], v[184:187]
    ds_read_b64_tr_b16 a[216:217], v73 offset:24576
    v_mfma_f32_16x16x32_bf16 v[188:191], a[220:223], a[196:199], v[188:191]
    ds_read_b64_tr_b16 a[218:219], v73 offset:26624
    s_waitcnt lgkmcnt(6)
    v_mfma_f32_16x16x32_bf16 v[160:163], a[224:227], a[164:167], v[160:163]
    ds_read_b64_tr_b16 a[220:221], v74 offset:24576
    s_add_u32 m0, s46, 78848
    v_mfma_f32_16x16x32_bf16 v[164:167], a[224:227], a[200:203], v[164:167]
    ds_read_b64_tr_b16 a[222:223], v74 offset:26624
    buffer_load_dwordx4 v48, s[16:19], s57 offen lds
    v_mfma_f32_16x16x32_bf16 v[168:171], a[228:231], a[164:167], v[168:171]
    ds_read_b64_tr_b16 a[224:225], v75 offset:24576
    v_mfma_f32_16x16x32_bf16 v[172:175], a[228:231], a[200:203], v[172:175]
    ds_read_b64_tr_b16 a[226:227], v75 offset:26624
    s_waitcnt lgkmcnt(6)
    v_mfma_f32_16x16x32_bf16 v[176:179], a[232:235], a[164:167], v[176:179]
    ds_read_b64_tr_b16 a[228:229], v76 offset:24576
    v_mfma_f32_16x16x32_bf16 v[180:183], a[232:235], a[200:203], v[180:183]
    ds_read_b64_tr_b16 a[230:231], v76 offset:26624
    buffer_load_dwordx4 a[40:43], v117, s[36:39], s67 offen offset:2048 sc1
    v_mfma_f32_16x16x32_bf16 v[184:187], a[236:239], a[164:167], v[184:187]
    ds_read_b64_tr_b16 a[232:233], v73 offset:28672
    v_mfma_f32_16x16x32_bf16 v[188:191], a[236:239], a[200:203], v[188:191]
    ds_read_b64_tr_b16 a[234:235], v73 offset:30720
    s_waitcnt lgkmcnt(6)
    v_mfma_f32_16x16x32_bf16 v[160:163], a[216:219], a[168:171], v[160:163]
    ds_read_b64_tr_b16 a[236:237], v74 offset:28672
    s_add_u32 m0, s46, 79872
    v_mfma_f32_16x16x32_bf16 v[164:167], a[216:219], a[204:207], v[164:167]
    ds_read_b64_tr_b16 a[238:239], v74 offset:30720
    buffer_load_dwordx4 v49, s[16:19], s57 offen lds
    v_mfma_f32_16x16x32_bf16 v[168:171], a[220:223], a[168:171], v[168:171]
    ds_read_b64_tr_b16 a[216:217], v75 offset:28672
    v_mfma_f32_16x16x32_bf16 v[172:175], a[220:223], a[204:207], v[172:175]
    ds_read_b64_tr_b16 a[218:219], v75 offset:30720
    s_waitcnt lgkmcnt(6)
    v_mfma_f32_16x16x32_bf16 v[176:179], a[224:227], a[168:171], v[176:179]
    ds_read_b64_tr_b16 a[220:221], v76 offset:28672
    v_mfma_f32_16x16x32_bf16 v[180:183], a[224:227], a[204:207], v[180:183]
    ds_read_b64_tr_b16 a[222:223], v76 offset:30720
    buffer_load_dwordx4 a[8:11], v81, s[36:39], s67 offen offset:2048 sc1
    v_mfma_f32_16x16x32_bf16 v[184:187], a[228:231], a[168:171], v[184:187]
    ds_read_b64_tr_b16 a[224:225], v73 offset:32768
    v_mfma_f32_16x16x32_bf16 v[188:191], a[228:231], a[204:207], v[188:191]
    ds_read_b64_tr_b16 a[226:227], v73 offset:34816
    s_waitcnt lgkmcnt(6)
    v_mfma_f32_16x16x32_bf16 v[160:163], a[232:235], a[172:175], v[160:163]
    ds_read_b64_tr_b16 a[228:229], v74 offset:32768
    s_add_u32 m0, s46, 80896
    v_mfma_f32_16x16x32_bf16 v[164:167], a[232:235], a[208:211], v[164:167]
    ds_read_b64_tr_b16 a[230:231], v74 offset:34816
    buffer_load_dwordx4 v50, s[16:19], s57 offen lds
    v_mfma_f32_16x16x32_bf16 v[168:171], a[236:239], a[172:175], v[168:171]
    ds_read_b64_tr_b16 a[232:233], v75 offset:32768
    v_mfma_f32_16x16x32_bf16 v[172:175], a[236:239], a[208:211], v[172:175]
    ds_read_b64_tr_b16 a[234:235], v75 offset:34816
    s_waitcnt lgkmcnt(6)
    v_mfma_f32_16x16x32_bf16 v[176:179], a[216:219], a[172:175], v[176:179]
    ds_read_b64_tr_b16 a[236:237], v76 offset:32768
    v_mfma_f32_16x16x32_bf16 v[180:183], a[216:219], a[208:211], v[180:183]
    ds_read_b64_tr_b16 a[238:239], v76 offset:34816
    buffer_load_dwordx2 v[106:107], v82, s[60:63], s69 offen offset:64 sc1
    s_barrier
    v_mfma_f32_16x16x32_bf16 v[184:187], a[220:223], a[172:175], v[184:187]
    ds_read_b64_tr_b16 a[216:217], v61 offset:0
    v_mfma_f32_16x16x32_bf16 v[188:191], a[220:223], a[208:211], v[188:191]
    ds_read_b64_tr_b16 a[218:219], v61 offset:2048
    s_waitcnt lgkmcnt(6)
    v_mfma_f32_16x16x32_bf16 v[160:163], a[224:227], a[176:179], v[160:163]
    ds_read_b64_tr_b16 a[220:221], v62 offset:0
    s_add_u32 m0, s46, 81920
    v_mfma_f32_16x16x32_bf16 v[164:167], a[224:227], a[212:215], v[164:167]
    ds_read_b64_tr_b16 a[222:223], v62 offset:2048
    buffer_load_dwordx4 v51, s[16:19], s57 offen lds
    v_mfma_f32_16x16x32_bf16 v[168:171], a[228:231], a[176:179], v[168:171]
    ds_read_b64_tr_b16 a[224:225], v63 offset:0
    v_mfma_f32_16x16x32_bf16 v[172:175], a[228:231], a[212:215], v[172:175]
    ds_read_b64_tr_b16 a[226:227], v63 offset:2048
    s_waitcnt lgkmcnt(6)
    v_mfma_f32_16x16x32_bf16 v[176:179], a[232:235], a[176:179], v[176:179]
    ds_read_b64_tr_b16 a[228:229], v64 offset:0
    v_mfma_f32_16x16x32_bf16 v[180:183], a[232:235], a[212:215], v[180:183]
    ds_read_b64_tr_b16 a[230:231], v64 offset:2048
    buffer_load_dwordx4 a[44:47], v117, s[36:39], s67 offen offset:3072 sc1
    v_mfma_f32_16x16x32_bf16 v[184:187], a[236:239], a[176:179], v[184:187]
    ds_read_b64_tr_b16 a[232:233], v61 offset:4096
    s_add_u32 s73, s52, 0x100
    v_mfma_f32_16x16x32_bf16 v[188:191], a[236:239], a[212:215], v[188:191]
    ds_read_b64_tr_b16 a[234:235], v61 offset:6144
    s_barrier
    s_waitcnt lgkmcnt(6)
    v_mfma_f32_16x16x32_bf16 v[128:131], a[216:219], a[144:147], 0
    ds_read_b64_tr_b16 a[236:237], v62 offset:4096
    s_add_u32 m0, s46, 110592
    v_mfma_f32_16x16x32_bf16 v[132:135], a[216:219], a[180:183], 0
    ds_read_b64_tr_b16 a[238:239], v62 offset:6144
    buffer_load_dwordx4 v43, s[16:19], s73 offen lds
    v_mfma_f32_16x16x32_bf16 v[136:139], a[220:223], a[144:147], 0
    ds_read_b64_tr_b16 a[216:217], v63 offset:4096
    v_mfma_f32_16x16x32_bf16 v[140:143], a[220:223], a[180:183], 0
    ds_read_b64_tr_b16 a[218:219], v63 offset:6144
    s_waitcnt lgkmcnt(6)
    v_mfma_f32_16x16x32_bf16 v[144:147], a[224:227], a[144:147], 0
    ds_read_b64_tr_b16 a[220:221], v64 offset:4096
    v_mfma_f32_16x16x32_bf16 v[148:151], a[224:227], a[180:183], 0
    ds_read_b64_tr_b16 a[222:223], v64 offset:6144
    buffer_load_dwordx4 a[12:15], v81, s[36:39], s67 offen offset:3072 sc1
    v_mfma_f32_16x16x32_bf16 v[152:155], a[228:231], a[144:147], 0
    ds_read_b64_tr_b16 a[224:225], v61 offset:8192
    v_mfma_f32_16x16x32_bf16 v[156:159], a[228:231], a[180:183], 0
    ds_read_b64_tr_b16 a[226:227], v61 offset:10240
    s_waitcnt lgkmcnt(6)
    v_mfma_f32_16x16x32_bf16 v[128:131], a[232:235], a[148:151], v[128:131]
    ds_read_b64_tr_b16 a[228:229], v62 offset:8192
    s_add_u32 m0, s46, 111616
    v_mfma_f32_16x16x32_bf16 v[132:135], a[232:235], a[184:187], v[132:135]
    ds_read_b64_tr_b16 a[230:231], v62 offset:10240
    buffer_load_dwordx4 v44, s[16:19], s73 offen lds
    v_mfma_f32_16x16x32_bf16 v[136:139], a[236:239], a[148:151], v[136:139]
    ds_read_b64_tr_b16 a[232:233], v63 offset:8192
    v_mfma_f32_16x16x32_bf16 v[140:143], a[236:239], a[184:187], v[140:143]
    ds_read_b64_tr_b16 a[234:235], v63 offset:10240
    s_waitcnt lgkmcnt(6)
    v_mfma_f32_16x16x32_bf16 v[144:147], a[216:219], a[148:151], v[144:147]
    ds_read_b64_tr_b16 a[236:237], v64 offset:8192
    v_mfma_f32_16x16x32_bf16 v[148:151], a[216:219], a[184:187], v[148:151]
    ds_read_b64_tr_b16 a[238:239], v64 offset:10240
    buffer_load_dwordx4 a[48:51], v118, s[36:39], s67 offen offset:0 sc1
    v_mfma_f32_16x16x32_bf16 v[152:155], a[220:223], a[148:151], v[152:155]
    ds_read_b64_tr_b16 a[216:217], v61 offset:12288
    v_mfma_f32_16x16x32_bf16 v[156:159], a[220:223], a[184:187], v[156:159]
    ds_read_b64_tr_b16 a[218:219], v61 offset:14336
    s_waitcnt lgkmcnt(6)
    v_mfma_f32_16x16x32_bf16 v[128:131], a[224:227], a[152:155], v[128:131]
    ds_read_b64_tr_b16 a[220:221], v62 offset:12288
    s_add_u32 m0, s46, 112640
    v_mfma_f32_16x16x32_bf16 v[132:135], a[224:227], a[188:191], v[132:135]
    ds_read_b64_tr_b16 a[222:223], v62 offset:14336
    buffer_load_dwordx4 v45, s[16:19], s73 offen lds
    v_mfma_f32_16x16x32_bf16 v[136:139], a[228:231], a[152:155], v[136:139]
    ds_read_b64_tr_b16 a[224:225], v63 offset:12288
    v_mfma_f32_16x16x32_bf16 v[140:143], a[228:231], a[188:191], v[140:143]
    ds_read_b64_tr_b16 a[226:227], v63 offset:14336
    s_waitcnt lgkmcnt(6)
    v_mfma_f32_16x16x32_bf16 v[144:147], a[232:235], a[152:155], v[144:147]
    ds_read_b64_tr_b16 a[228:229], v64 offset:12288
    v_mfma_f32_16x16x32_bf16 v[148:151], a[232:235], a[188:191], v[148:151]
    ds_read_b64_tr_b16 a[230:231], v64 offset:14336
    buffer_load_dwordx4 a[16:19], v116, s[36:39], s67 offen offset:0 sc1
    v_mfma_f32_16x16x32_bf16 v[152:155], a[236:239], a[152:155], v[152:155]
    ds_read_b64_tr_b16 a[232:233], v61 offset:16384
    v_mfma_f32_16x16x32_bf16 v[156:159], a[236:239], a[188:191], v[156:159]
    ds_read_b64_tr_b16 a[234:235], v61 offset:18432
    s_waitcnt lgkmcnt(6)
    v_mfma_f32_16x16x32_bf16 v[128:131], a[216:219], a[156:159], v[128:131]
    ds_read_b64_tr_b16 a[236:237], v62 offset:16384
    s_add_u32 m0, s46, 113664
    v_mfma_f32_16x16x32_bf16 v[132:135], a[216:219], a[192:195], v[132:135]
    ds_read_b64_tr_b16 a[238:239], v62 offset:18432
    buffer_load_dwordx4 v46, s[16:19], s73 offen lds
    v_mfma_f32_16x16x32_bf16 v[136:139], a[220:223], a[156:159], v[136:139]
    ds_read_b64_tr_b16 a[216:217], v63 offset:16384
    v_mfma_f32_16x16x32_bf16 v[140:143], a[220:223], a[192:195], v[140:143]
    ds_read_b64_tr_b16 a[218:219], v63 offset:18432
    s_waitcnt lgkmcnt(6)
    v_mfma_f32_16x16x32_bf16 v[144:147], a[224:227], a[156:159], v[144:147]
    ds_read_b64_tr_b16 a[220:221], v64 offset:16384
    v_mfma_f32_16x16x32_bf16 v[148:151], a[224:227], a[192:195], v[148:151]
    ds_read_b64_tr_b16 a[222:223], v64 offset:18432
    s_waitcnt vmcnt(19)
    v_readfirstlane_b32 s74, v126
    v_readfirstlane_b32 s75, v127
    s_cmp_eq_u64 s[74:75], s[100:101]
    s_cbranch_scc0 L_k3_slow1
L_k3_back1:
    v_mfma_f32_16x16x32_bf16 v[152:155], a[228:231], a[156:159], v[152:155]
    ds_read_b64_tr_b16 a[224:225], v61 offset:20480
    v_mfma_f32_16x16x32_bf16 v[156:159], a[228:231], a[192:195], v[156:159]
    ds_read_b64_tr_b16 a[226:227], v61 offset:22528
    s_waitcnt lgkmcnt(6)
    v_mfma_f32_16x16x32_bf16 v[128:131], a[232:235], a[160:163], v[128:131]
    ds_read_b64_tr_b16 a[228:229], v62 offset:20480
    s_add_u32 m0, s46, 114688
    v_mfma_f32_16x16x32_bf16 v[132:135], a[232:235], a[196:199], v[132:135]
    ds_read_b64_tr_b16 a[230:231], v62 offset:22528
    buffer_load_dwordx4 v47, s[16:19], s73 offen lds
    v_mfma_f32_16x16x32_bf16 v[136:139], a[236:239], a[160:163], v[136:139]
    ds_read_b64_tr_b16 a[232:233], v63 offset:20480
    v_mfma_f32_16x16x32_bf16 v[140:143], a[236:239], a[196:199], v[140:143]
    ds_read_b64_tr_b16 a[234:235], v63 offset:22528
    s_waitcnt lgkmcnt(6)
    v_mfma_f32_16x16x32_bf16 v[144:147], a[216:219], a[160:163], v[144:147]
    ds_read_b64_tr_b16 a[236:237], v64 offset:20480
    v_mfma_f32_16x16x32_bf16 v[148:151], a[216:219], a[196:199], v[148:151]
    ds_read_b64_tr_b16 a[238:239], v64 offset:22528
    buffer_load_dwordx4 a[24:27], v116, s[36:39], s67 offen offset:2048 sc1
    v_mfma_f32_16x16x32_bf16 v[152:155], a[220:223], a[160:163], v[152:155]
    ds_read_b64_tr_b16 a[216:217], v61 offset:24576
    v_mfma_f32_16x16x32_bf16 v[156:159], a[220:223], a[196:199], v[156:159]
    ds_read_b64_tr_b16 a[218:219], v61 offset:26624
    s_waitcnt lgkmcnt(6)
    v_mfma_f32_16x16x32_bf16 v[128:131], a[224:227], a[164:167], v[128:131]
    ds_read_b64_tr_b16 a[220:221], v62 offset:24576
    s_add_u32 m0, s46, 115712
    v_mfma_f32_16x16x32_bf16 v[132:135], a[224:227], a[200:203], v[132:135]
    ds_read_b64_tr_b16 a[222:223], v62 offset:26624
    buffer_load_dwordx4 v48, s[16:19], s73 offen lds
    v_mfma_f32_16x16x32_bf16 v[136:139], a[228:231], a[164:167], v[136:139]
    ds_read_b64_tr_b16 a[224:225], v63 offset:24576
    v_mfma_f32_16x16x32_bf16 v[140:143], a[228:231], a[200:203], v[140:143]
    ds_read_b64_tr_b16 a[226:227], v63 offset:26624
    s_waitcnt lgkmcnt(6)
    v_mfma_f32_16x16x32_bf16 v[144:147], a[232:235], a[164:167], v[144:147]
    ds_read_b64_tr_b16 a[228:229], v64 offset:24576
    v_mfma_f32_16x16x32_bf16 v[148:151], a[232:235], a[200:203], v[148:151]
    ds_read_b64_tr_b16 a[230:231], v64 offset:26624
    buffer_load_dwordx4 a[52:55], v118, s[36:39], s67 offen offset:1024 sc1
    v_mfma_f32_16x16x32_bf16 v[152:155], a[236:239], a[164:167], v[152:155]
    ds_read_b64_tr_b16 a[232:233], v61 offset:28672
    v_mfma_f32_16x16x32_bf16 v[156:159], a[236:239], a[200:203], v[156:159]
    ds_read_b64_tr_b16 a[234:235], v61 offset:30720
    s_waitcnt lgkmcnt(6)
    v_mfma_f32_16x16x32_bf16 v[128:131], a[216:219], a[168:171], v[128:131]
    ds_read_b64_tr_b16 a[236:237], v62 offset:28672
    s_add_u32 m0, s46, 116736
    v_mfma_f32_16x16x32_bf16 v[132:135], a[216:219], a[204:207], v[132:135]
    ds_read_b64_tr_b16 a[238:239], v62 offset:30720
    buffer_load_dwordx4 v49, s[16:19], s73 offen lds
    v_mfma_f32_16x16x32_bf16 v[136:139], a[220:223], a[168:171], v[136:139]
    ds_read_b64_tr_b16 a[216:217], v63 offset:28672
    v_mfma_f32_16x16x32_bf16 v[140:143], a[220:223], a[204:207], v[140:143]
    ds_read_b64_tr_b16 a[218:219], v63 offset:30720
    s_waitcnt lgkmcnt(6)
    v_mfma_f32_16x16x32_bf16 v[144:147], a[224:227], a[168:171], v[144:147]
    ds_read_b64_tr_b16 a[220:221], v64 offset:28672
    v_mfma_f32_16x16x32_bf16 v[148:151], a[224:227], a[204:207], v[148:151]
    ds_read_b64_tr_b16 a[222:223], v64 offset:30720
    buffer_load_dwordx4 a[60:63], v118, s[36:39], s67 offen offset:3072 sc1
    v_mfma_f32_16x16x32_bf16 v[152:155], a[228:231], a[168:171], v[152:155]
    ds_read_b64_tr_b16 a[224:225], v61 offset:32768
    v_mfma_f32_16x16x32_bf16 v[156:159], a[228:231], a[204:207], v[156:159]
    ds_read_b64_tr_b16 a[226:227], v61 offset:34816
    s_waitcnt lgkmcnt(6)
    v_mfma_f32_16x16x32_bf16 v[128:131], a[232:235], a[172:175], v[128:131]
    ds_read_b64_tr_b16 a[228:229], v62 offset:32768
    s_add_u32 m0, s46, 117760
    v_mfma_f32_16x16x32_bf16 v[132:135], a[232:235], a[208:211], v[132:135]
    ds_read_b64_tr_b16 a[230:231], v62 offset:34816
    buffer_load_dwordx4 v50, s[16:19], s73 offen lds
    v_mfma_f32_16x16x32_bf16 v[136:139], a[236:239], a[172:175], v[136:139]
    ds_read_b64_tr_b16 a[232:233], v63 offset:32768
    v_mfma_f32_16x16x32_bf16 v[140:143], a[236:239], a[208:211], v[140:143]
    ds_read_b64_tr_b16 a[234:235], v63 offset:34816
    s_waitcnt lgkmcnt(6)
    v_mfma_f32_16x16x32_bf16 v[144:147], a[216:219], a[172:175], v[144:147]
    ds_read_b64_tr_b16 a[236:237], v64 offset:32768
    v_mfma_f32_16x16x32_bf16 v[148:151], a[216:219], a[208:211], v[148:151]
    ds_read_b64_tr_b16 a[238:239], v64 offset:34816
    buffer_load_dwordx4 a[20:23], v116, s[36:39], s67 offen offset:1024 sc1
    s_barrier
    v_mfma_f32_16x16x32_bf16 v[152:155], a[220:223], a[172:175], v[152:155]
    ds_read_b64_tr_b16 a[216:217], v65 offset:0
    v_mfma_f32_16x16x32_bf16 v[156:159], a[220:223], a[208:211], v[156:159]
    ds_read_b64_tr_b16 a[218:219], v65 offset:2048
    s_waitcnt lgkmcnt(6)
    v_mfma_f32_16x16x32_bf16 v[128:131], a[224:227], a[176:179], v[128:131]
    ds_read_b64_tr_b16 a[220:221], v66 offset:0
    s_add_u32 m0, s46, 118784
    v_mfma_f32_16x16x32_bf16 v[132:135], a[224:227], a[212:215], v[132:135]
    ds_read_b64_tr_b16 a[222:223], v66 offset:2048
    buffer_load_dwordx4 v51, s[16:19], s73 offen lds
    v_mfma_f32_16x16x32_bf16 v[136:139], a[228:231], a[176:179], v[136:139]
    ds_read_b64_tr_b16 a[224:225], v67 offset:0
    v_mfma_f32_16x16x32_bf16 v[140:143], a[228:231], a[212:215], v[140:143]
    ds_read_b64_tr_b16 a[226:227], v67 offset:2048
    s_waitcnt lgkmcnt(6)
    v_mfma_f32_16x16x32_bf16 v[144:147], a[232:235], a[176:179], v[144:147]
    ds_read_b64_tr_b16 a[228:229], v68 offset:0
    v_mfma_f32_16x16x32_bf16 v[148:151], a[232:235], a[212:215], v[148:151]
    ds_read_b64_tr_b16 a[230:231], v68 offset:2048
    buffer_load_dwordx4 a[28:31], v116, s[36:39], s67 offen offset:3072 sc1
    v_mfma_f32_16x16x32_bf16 v[152:155], a[236:239], a[176:179], v[152:155]
    ds_read_b64_tr_b16 a[232:233], v65 offset:4096
    s_add_u32 s57, s52, 0x180
    v_mfma_f32_16x16x32_bf16 v[156:159], a[236:239], a[212:215], v[156:159]
    ds_read_b64_tr_b16 a[234:235], v65 offset:6144
    s_barrier
    s_waitcnt vmcnt(27)
    s_waitcnt lgkmcnt(6)
    v_mfma_f32_16x16x32_bf16 v[192:195], a[216:219], a[0:3], v[192:195]
    ds_read_b64_tr_b16 a[236:237], v66 offset:4096
    s_add_u32 m0, s46, 0
    v_mfma_f32_16x16x32_bf16 v[196:199], a[216:219], a[36:39], v[196:199]
    ds_read_b64_tr_b16 a[238:239], v66 offset:6144
    buffer_load_dwordx4 v43, s[16:19], s57 offen lds
    v_mfma_f32_16x16x32_bf16 v[200:203], a[220:223], a[0:3], v[200:203]
    ds_read_b64_tr_b16 a[216:217], v67 offset:4096
    v_mfma_f32_16x16x32_bf16 v[204:207], a[220:223], a[36:39], v[204:207]
    ds_read_b64_tr_b16 a[218:219], v67 offset:6144
    s_waitcnt lgkmcnt(6)
    v_mfma_f32_16x16x32_bf16 v[208:211], a[224:227], a[0:3], v[208:211]
    ds_read_b64_tr_b16 a[220:221], v68 offset:4096
    v_mfma_f32_16x16x32_bf16 v[212:215], a[224:227], a[36:39], v[212:215]
    ds_read_b64_tr_b16 a[222:223], v68 offset:6144
    buffer_load_dwordx4 a[56:59], v118, s[36:39], s67 offen offset:2048 sc1
    v_mfma_f32_16x16x32_bf16 v[216:219], a[228:231], a[0:3], v[216:219]
    ds_read_b64_tr_b16 a[224:225], v65 offset:8192
    v_mfma_f32_16x16x32_bf16 v[220:223], a[228:231], a[36:39], v[220:223]
    ds_read_b64_tr_b16 a[226:227], v65 offset:10240
    s_waitcnt vmcnt(25)
    s_waitcnt lgkmcnt(6)
    v_mfma_f32_16x16x32_bf16 v[192:195], a[232:235], a[4:7], v[192:195]
    ds_read_b64_tr_b16 a[228:229], v66 offset:8192
    s_add_u32 m0, s46, 1024
    v_mfma_f32_16x16x32_bf16 v[196:199], a[232:235], a[40:43], v[196:199]
    ds_read_b64_tr_b16 a[230:231], v66 offset:10240
    buffer_load_dwordx4 v44, s[16:19], s57 offen lds
    v_mfma_f32_16x16x32_bf16 v[200:203], a[236:239], a[4:7], v[200:203]
    ds_read_b64_tr_b16 a[232:233], v67 offset:8192
    v_mfma_f32_16x16x32_bf16 v[204:207], a[236:239], a[40:43], v[204:207]
    ds_read_b64_tr_b16 a[234:235], v67 offset:10240
    s_waitcnt lgkmcnt(6)
    v_mfma_f32_16x16x32_bf16 v[208:211], a[216:219], a[4:7], v[208:211]
    ds_read_b64_tr_b16 a[236:237], v68 offset:8192
    v_mfma_f32_16x16x32_bf16 v[212:215], a[216:219], a[40:43], v[212:215]
    ds_read_b64_tr_b16 a[238:239], v68 offset:10240
    buffer_load_dwordx4 a[64:67], v119, s[36:39], s67 offen offset:0 sc1
    v_mfma_f32_16x16x32_bf16 v[216:219], a[220:223], a[4:7], v[216:219]
    ds_read_b64_tr_b16 a[216:217], v65 offset:12288
    v_mfma_f32_16x16x32_bf16 v[220:223], a[220:223], a[40:43], v[220:223]
    ds_read_b64_tr_b16 a[218:219], v65 offset:14336
    s_waitcnt vmcnt(21)
    s_waitcnt lgkmcnt(6)
    v_mfma_f32_16x16x32_bf16 v[192:195], a[224:227], a[8:11], v[192:195]
    ds_read_b64_tr_b16 a[220:221], v66 offset:12288
    s_add_u32 m0, s46, 2048
    v_mfma_f32_16x16x32_bf16 v[196:199], a[224:227], a[44:47], v[196:199]
    ds_read_b64_tr_b16 a[222:223], v66 offset:14336
    buffer_load_dwordx4 v45, s[16:19], s57 offen lds
    v_mfma_f32_16x16x32_bf16 v[200:203], a[228:231], a[8:11], v[200:203]
    ds_read_b64_tr_b16 a[224:225], v67 offset:12288
    v_mfma_f32_16x16x32_bf16 v[204:207], a[228:231], a[44:47], v[204:207]
    ds_read_b64_tr_b16 a[226:227], v67 offset:14336
    s_waitcnt lgkmcnt(6)
    v_mfma_f32_16x16x32_bf16 v[208:211], a[232:235], a[8:11], v[208:211]
    ds_read_b64_tr_b16 a[228:229], v68 offset:12288
    v_mfma_f32_16x16x32_bf16 v[212:215], a[232:235], a[44:47], v[212:215]
    ds_read_b64_tr_b16 a[230:231], v68 offset:14336
    v_readfirstlane_b32 s74, v106
    v_readfirstlane_b32 s75, v107
    s_cmp_eq_u64 s[74:75], s[100:101]
    s_cbranch_scc0 L_k3_slow2
L_k3_back2:
    v_mfma_f32_16x16x32_bf16 v[216:219], a[236:239], a[8:11], v[216:219]
    ds_read_b64_tr_b16 a[232:233], v65 offset:16384
    v_mfma_f32_16x16x32_bf16 v[220:223], a[236:239], a[44:47], v[220:223]
    ds_read_b64_tr_b16 a[234:235], v65 offset:18432
    s_waitcnt vmcnt(18)
    s_waitcnt lgkmcnt(6)
    v_mfma_f32_16x16x32_bf16 v[192:195], a[216:219], a[12:15], v[192:195]
    ds_read_b64_tr_b16 a[236:237], v66 offset:16384
    s_add_u32 m0, s46, 3072
    v_mfma_f32_16x16x32_bf16 v[196:199], a[216:219], a[48:51], v[196:199]
    ds_read_b64_tr_b16 a[238:239], v66 offset:18432
    buffer_load_dwordx4 v46, s[16:19], s57 offen lds
    v_mfma_f32_16x16x32_bf16 v[200:203], a[220:223], a[12:15], v[200:203]
    ds_read_b64_tr_b16 a[216:217], v67 offset:16384
    v_mfma_f32_16x16x32_bf16 v[204:207], a[220:223], a[48:51], v[204:207]
    ds_read_b64_tr_b16 a[218:219], v67 offset:18432
    s_waitcnt lgkmcnt(6)
    v_mfma_f32_16x16x32_bf16 v[208:211], a[224:227], a[12:15], v[208:211]
    ds_read_b64_tr_b16 a[220:221], v68 offset:16384
    v_mfma_f32_16x16x32_bf16 v[212:215], a[224:227], a[48:51], v[212:215]
    ds_read_b64_tr_b16 a[222:223], v68 offset:18432
    buffer_load_dwordx4 a[32:35], v117, s[36:39], s67 offen offset:0 sc1
    v_mfma_f32_16x16x32_bf16 v[216:219], a[228:231], a[12:15], v[216:219]
    ds_read_b64_tr_b16 a[224:225], v65 offset:20480
    v_mfma_f32_16x16x32_bf16 v[220:223], a[228:231], a[48:51], v[220:223]
    ds_read_b64_tr_b16 a[226:227], v65 offset:22528
    s_waitcnt vmcnt(13)
    s_waitcnt lgkmcnt(6)
    v_mfma_f32_16x16x32_bf16 v[192:195], a[232:235], a[16:19], v[192:195]
    ds_read_b64_tr_b16 a[228:229], v66 offset:20480
    s_add_u32 m0, s46, 4096
    v_mfma_f32_16x16x32_bf16 v[196:199], a[232:235], a[52:55], v[196:199]
    ds_read_b64_tr_b16 a[230:231], v66 offset:22528
    buffer_load_dwordx4 v47, s[16:19], s57 offen lds
    v_mfma_f32_16x16x32_bf16 v[200:203], a[236:239], a[16:19], v[200:203]
    ds_read_b64_tr_b16 a[232:233], v67 offset:20480
    v_mfma_f32_16x16x32_bf16 v[204:207], a[236:239], a[52:55], v[204:207]
    ds_read_b64_tr_b16 a[234:235], v67 offset:22528
    s_waitcnt lgkmcnt(6)
    v_mfma_f32_16x16x32_bf16 v[208:211], a[216:219], a[16:19], v[208:211]
    ds_read_b64_tr_b16 a[236:237], v68 offset:20480
    v_mfma_f32_16x16x32_bf16 v[212:215], a[216:219], a[52:55], v[212:215]
    ds_read_b64_tr_b16 a[238:239], v68 offset:22528
    buffer_load_dwordx4 a[68:71], v119, s[36:39], s67 offen offset:1024 sc1
    v_mfma_f32_16x16x32_bf16 v[216:219], a[220:223], a[16:19], v[216:219]
    ds_read_b64_tr_b16 a[216:217], v65 offset:24576
    v_mfma_f32_16x16x32_bf16 v[220:223], a[220:223], a[52:55], v[220:223]
    ds_read_b64_tr_b16 a[218:219], v65 offset:26624
    s_waitcnt vmcnt(7)
    s_waitcnt lgkmcnt(6)
    v_mfma_f32_16x16x32_bf16 v[192:195], a[224:227], a[20:23], v[192:195]
    ds_read_b64_tr_b16 a[220:221], v66 offset:24576
    s_add_u32 m0, s46, 5120
    v_mfma_f32_16x16x32_bf16 v[196:199], a[224:227], a[56:59], v[196:199]
    ds_read_b64_tr_b16 a[222:223], v66 offset:26624
    buffer_load_dwordx4 v48, s[16:19], s57 offen lds
    v_mfma_f32_16x16x32_bf16 v[200:203], a[228:231], a[20:23], v[200:203]
    ds_read_b64_tr_b16 a[224:225], v67 offset:24576
    v_mfma_f32_16x16x32_bf16 v[204:207], a[228:231], a[56:59], v[204:207]
    ds_read_b64_tr_b16 a[226:227], v67 offset:26624
    s_waitcnt lgkmcnt(6)
    v_mfma_f32_16x16x32_bf16 v[208:211], a[232:235], a[20:23], v[208:211]
    ds_read_b64_tr_b16 a[228:229], v68 offset:24576
    v_mfma_f32_16x16x32_bf16 v[212:215], a[232:235], a[56:59], v[212:215]
    ds_read_b64_tr_b16 a[230:231], v68 offset:26624
    v_mfma_f32_16x16x32_bf16 v[216:219], a[236:239], a[20:23], v[216:219]
    ds_read_b64_tr_b16 a[232:233], v65 offset:28672
    v_mfma_f32_16x16x32_bf16 v[220:223], a[236:239], a[56:59], v[220:223]
    ds_read_b64_tr_b16 a[234:235], v65 offset:30720
    s_waitcnt lgkmcnt(6)
    v_mfma_f32_16x16x32_bf16 v[192:195], a[216:219], a[24:27], v[192:195]
    ds_read_b64_tr_b16 a[236:237], v66 offset:28672
    s_add_u32 m0, s46, 6144
    v_mfma_f32_16x16x32_bf16 v[196:199], a[216:219], a[60:63], v[196:199]
    ds_read_b64_tr_b16 a[238:239], v66 offset:30720
    buffer_load_dwordx4 v49, s[16:19], s57 offen lds
    v_mfma_f32_16x16x32_bf16 v[200:203], a[220:223], a[24:27], v[200:203]
    ds_read_b64_tr_b16 a[216:217], v67 offset:28672
    v_mfma_f32_16x16x32_bf16 v[204:207], a[220:223], a[60:63], v[204:207]
    ds_read_b64_tr_b16 a[218:219], v67 offset:30720
    s_waitcnt lgkmcnt(6)
    v_mfma_f32_16x16x32_bf16 v[208:211], a[224:227], a[24:27], v[208:211]
    ds_read_b64_tr_b16 a[220:221], v68 offset:28672
    v_mfma_f32_16x16x32_bf16 v[212:215], a[224:227], a[60:63], v[212:215]
    ds_read_b64_tr_b16 a[222:223], v68 offset:30720
    v_mfma_f32_16x16x32_bf16 v[216:219], a[228:231], a[24:27], v[216:219]
    ds_read_b64_tr_b16 a[224:225], v65 offset:32768
    v_mfma_f32_16x16x32_bf16 v[220:223], a[228:231], a[60:63], v[220:223]
    ds_read_b64_tr_b16 a[226:227], v65 offset:34816
    s_waitcnt vmcnt(7)
    s_waitcnt lgkmcnt(6)
    v_mfma_f32_16x16x32_bf16 v[192:195], a[232:235], a[28:31], v[192:195]
    ds_read_b64_tr_b16 a[228:229], v66 offset:32768
    s_add_u32 m0, s46, 7168
    v_mfma_f32_16x16x32_bf16 v[196:199], a[232:235], a[64:67], v[196:199]
    ds_read_b64_tr_b16 a[230:231], v66 offset:34816
    buffer_load_dwordx4 v50, s[16:19], s57 offen lds
    v_mfma_f32_16x16x32_bf16 v[200:203], a[236:239], a[28:31], v[200:203]
    ds_read_b64_tr_b16 a[232:233], v67 offset:32768
    v_mfma_f32_16x16x32_bf16 v[204:207], a[236:239], a[64:67], v[204:207]
    ds_read_b64_tr_b16 a[234:235], v67 offset:34816
    s_waitcnt lgkmcnt(6)
    v_mfma_f32_16x16x32_bf16 v[208:211], a[216:219], a[28:31], v[208:211]
    ds_read_b64_tr_b16 a[236:237], v68 offset:32768
    v_mfma_f32_16x16x32_bf16 v[212:215], a[216:219], a[64:67], v[212:215]
    ds_read_b64_tr_b16 a[238:239], v68 offset:34816
    s_barrier
    v_mfma_f32_16x16x32_bf16 v[216:219], a[220:223], a[28:31], v[216:219]
    ds_read_b64_tr_b16 a[216:217], v69 offset:0
    v_mfma_f32_16x16x32_bf16 v[220:223], a[220:223], a[64:67], v[220:223]
    ds_read_b64_tr_b16 a[218:219], v69 offset:2048
    s_waitcnt vmcnt(3)
    s_waitcnt lgkmcnt(6)
    v_mfma_f32_16x16x32_bf16 v[192:195], a[224:227], a[32:35], v[192:195]
    ds_read_b64_tr_b16 a[220:221], v70 offset:0
    s_add_u32 m0, s46, 8192
    v_mfma_f32_16x16x32_bf16 v[196:199], a[224:227], a[68:71], v[196:199]
    ds_read_b64_tr_b16 a[222:223], v70 offset:2048
    buffer_load_dwordx4 v51, s[16:19], s57 offen lds
    v_mfma_f32_16x16x32_bf16 v[200:203], a[228:231], a[32:35], v[200:203]
    ds_read_b64_tr_b16 a[224:225], v71 offset:0
    v_mfma_f32_16x16x32_bf16 v[204:207], a[228:231], a[68:71], v[204:207]
    ds_read_b64_tr_b16 a[226:227], v71 offset:2048
    s_waitcnt lgkmcnt(6)
    v_mfma_f32_16x16x32_bf16 v[208:211], a[232:235], a[32:35], v[208:211]
    ds_read_b64_tr_b16 a[228:229], v72 offset:0
    v_mfma_f32_16x16x32_bf16 v[212:215], a[232:235], a[68:71], v[212:215]
    ds_read_b64_tr_b16 a[230:231], v72 offset:2048
    v_mfma_f32_16x16x32_bf16 v[216:219], a[236:239], a[32:35], v[216:219]
    ds_read_b64_tr_b16 a[232:233], v69 offset:4096
    s_add_u32 s73, s53, 0x0
    v_mfma_f32_16x16x32_bf16 v[220:223], a[236:239], a[68:71], v[220:223]
    ds_read_b64_tr_b16 a[234:235], v69 offset:6144
    s_barrier
    s_waitcnt lgkmcnt(6)
    v_mfma_f32_16x16x32_bf16 v[224:227], a[216:219], a[0:3], v[224:227]
    ds_read_b64_tr_b16 a[236:237], v70 offset:4096
    s_add_u32 m0, s46, 36864
    v_mfma_f32_16x16x32_bf16 v[228:231], a[216:219], a[36:39], v[228:231]
    ds_read_b64_tr_b16 a[238:239], v70 offset:6144
    buffer_load_dwordx4 v52, s[16:19], s73 offen lds
    v_mfma_f32_16x16x32_bf16 v[232:235], a[220:223], a[0:3], v[232:235]
    ds_read_b64_tr_b16 a[216:217], v71 offset:4096
    v_mfma_f32_16x16x32_bf16 v[236:239], a[220:223], a[36:39], v[236:239]
    ds_read_b64_tr_b16 a[218:219], v71 offset:6144
    s_waitcnt lgkmcnt(6)
    v_mfma_f32_16x16x32_bf16 v[240:243], a[224:227], a[0:3], v[240:243]
    ds_read_b64_tr_b16 a[220:221], v72 offset:4096
    v_mfma_f32_16x16x32_bf16 v[244:247], a[224:227], a[36:39], v[244:247]
    ds_read_b64_tr_b16 a[222:223], v72 offset:6144
    v_mfma_f32_16x16x32_bf16 v[248:251], a[228:231], a[0:3], v[248:251]
    ds_read_b64_tr_b16 a[224:225], v69 offset:8192
    v_cvt_pk_bf16_f32 v90, v192, v193
    v_mfma_f32_16x16x32_bf16 v[252:255], a[228:231], a[36:39], v[252:255]
    ds_read_b64_tr_b16 a[226:227], v69 offset:10240
    s_waitcnt lgkmcnt(6)
    v_mfma_f32_16x16x32_bf16 v[224:227], a[232:235], a[4:7], v[224:227]
    ds_read_b64_tr_b16 a[228:229], v70 offset:8192
    s_add_u32 m0, s46, 37888
    v_mfma_f32_16x16x32_bf16 v[228:231], a[232:235], a[40:43], v[228:231]
    ds_read_b64_tr_b16 a[230:231], v70 offset:10240
    buffer_load_dwordx4 v53, s[16:19], s73 offen lds
    v_mfma_f32_16x16x32_bf16 v[232:235], a[236:239], a[4:7], v[232:235]
    ds_read_b64_tr_b16 a[232:233], v71 offset:8192
    v_cvt_pk_bf16_f32 v91, v194, v195
    v_mfma_f32_16x16x32_bf16 v[236:239], a[236:239], a[40:43], v[236:239]
    ds_read_b64_tr_b16 a[234:235], v71 offset:10240
    s_waitcnt lgkmcnt(6)
    v_mfma_f32_16x16x32_bf16 v[240:243], a[216:219], a[4:7], v[240:243]
    ds_read_b64_tr_b16 a[236:237], v72 offset:8192
    v_cvt_pk_bf16_f32 v92, v200, v201
    v_mfma_f32_16x16x32_bf16 v[244:247], a[216:219], a[40:43], v[244:247]
    ds_read_b64_tr_b16 a[238:239], v72 offset:10240
    v_mfma_f32_16x16x32_bf16 v[248:251], a[220:223], a[4:7], v[248:251]
    ds_read_b64_tr_b16 a[216:217], v69 offset:12288
    v_cvt_pk_bf16_f32 v93, v202, v203
    v_mfma_f32_16x16x32_bf16 v[252:255], a[220:223], a[40:43], v[252:255]
    ds_read_b64_tr_b16 a[218:219], v69 offset:14336
    s_waitcnt lgkmcnt(6)
    v_mfma_f32_16x16x32_bf16 v[224:227], a[224:227], a[8:11], v[224:227]
    ds_read_b64_tr_b16 a[220:221], v70 offset:12288
    s_add_u32 m0, s46, 38912
    v_mfma_f32_16x16x32_bf16 v[228:231], a[224:227], a[44:47], v[228:231]
    ds_read_b64_tr_b16 a[222:223], v70 offset:14336
    buffer_load_dwordx4 v54, s[16:19], s73 offen lds
    v_mfma_f32_16x16x32_bf16 v[232:235], a[228:231], a[8:11], v[232:235]
    ds_read_b64_tr_b16 a[224:225], v71 offset:12288
    v_cvt_pk_bf16_f32 v94, v196, v197
    v_mfma_f32_16x16x32_bf16 v[236:239], a[228:231], a[44:47], v[236:239]
    ds_read_b64_tr_b16 a[226:227], v71 offset:14336
    s_waitcnt lgkmcnt(6)
    v_mfma_f32_16x16x32_bf16 v[240:243], a[232:235], a[8:11], v[240:243]
    ds_read_b64_tr_b16 a[228:229], v72 offset:12288
    v_cvt_pk_bf16_f32 v95, v198, v199
    v_mfma_f32_16x16x32_bf16 v[244:247], a[232:235], a[44:47], v[244:247]
    ds_read_b64_tr_b16 a[230:231], v72 offset:14336
    buffer_store_dwordx4 v[90:93], v81, s[40:43], s71 offen offset:0 sc1
    v_mfma_f32_16x16x32_bf16 v[248:251], a[236:239], a[8:11], v[248:251]
    ds_read_b64_tr_b16 a[232:233], v69 offset:16384
    v_cvt_pk_bf16_f32 v96, v204, v205
    v_mfma_f32_16x16x32_bf16 v[252:255], a[236:239], a[44:47], v[252:255]
    ds_read_b64_tr_b16 a[234:235], v69 offset:18432
    s_waitcnt lgkmcnt(6)
    v_mfma_f32_16x16x32_bf16 v[224:227], a[216:219], a[12:15], v[224:227]
    ds_read_b64_tr_b16 a[236:237], v70 offset:16384
    s_add_u32 m0, s46, 39936
    v_mfma_f32_16x16x32_bf16 v[228:231], a[216:219], a[48:51], v[228:231]
    ds_read_b64_tr_b16 a[238:239], v70 offset:18432
    buffer_load_dwordx4 v55, s[16:19], s73 offen lds
    v_mfma_f32_16x16x32_bf16 v[232:235], a[220:223], a[12:15], v[232:235]
    ds_read_b64_tr_b16 a[216:217], v71 offset:16384
    v_cvt_pk_bf16_f32 v97, v206, v207
    v_mfma_f32_16x16x32_bf16 v[236:239], a[220:223], a[48:51], v[236:239]
    ds_read_b64_tr_b16 a[218:219], v71 offset:18432
    s_waitcnt lgkmcnt(6)
    v_mfma_f32_16x16x32_bf16 v[240:243], a[224:227], a[12:15], v[240:243]
    ds_read_b64_tr_b16 a[220:221], v72 offset:16384
    v_cvt_pk_bf16_f32 v98, v208, v209
    v_mfma_f32_16x16x32_bf16 v[244:247], a[224:227], a[48:51], v[244:247]
    ds_read_b64_tr_b16 a[222:223], v72 offset:18432
    buffer_store_dwordx4 v[94:97], v119, s[40:43], s71 offen offset:2048 sc1
    v_mfma_f32_16x16x32_bf16 v[248:251], a[228:231], a[12:15], v[248:251]
    ds_read_b64_tr_b16 a[224:225], v69 offset:20480
    v_cvt_pk_bf16_f32 v99, v210, v211
    v_mfma_f32_16x16x32_bf16 v[252:255], a[228:231], a[48:51], v[252:255]
    ds_read_b64_tr_b16 a[226:227], v69 offset:22528
    s_waitcnt lgkmcnt(6)
    v_mfma_f32_16x16x32_bf16 v[224:227], a[232:235], a[16:19], v[224:227]
    ds_read_b64_tr_b16 a[228:229], v70 offset:20480
    s_add_u32 m0, s46, 40960
    v_mfma_f32_16x16x32_bf16 v[228:231], a[232:235], a[52:55], v[228:231]
    ds_read_b64_tr_b16 a[230:231], v70 offset:22528
    buffer_load_dwordx4 v56, s[16:19], s73 offen lds
    v_mfma_f32_16x16x32_bf16 v[232:235], a[236:239], a[16:19], v[232:235]
    ds_read_b64_tr_b16 a[232:233], v71 offset:20480
    v_cvt_pk_bf16_f32 v100, v216, v217
    v_mfma_f32_16x16x32_bf16 v[236:239], a[236:239], a[52:55], v[236:239]
    ds_read_b64_tr_b16 a[234:235], v71 offset:22528
    s_waitcnt lgkmcnt(6)
    v_mfma_f32_16x16x32_bf16 v[240:243], a[216:219], a[16:19], v[240:243]
    ds_read_b64_tr_b16 a[236:237], v72 offset:20480
    v_cvt_pk_bf16_f32 v101, v218, v219
    v_mfma_f32_16x16x32_bf16 v[244:247], a[216:219], a[52:55], v[244:247]
    ds_read_b64_tr_b16 a[238:239], v72 offset:22528
    buffer_store_dwordx4 v[98:101], v81, s[40:43], s71 offen offset:1024 sc1
    v_mfma_f32_16x16x32_bf16 v[248:251], a[220:223], a[16:19], v[248:251]
    ds_read_b64_tr_b16 a[216:217], v69 offset:24576
    v_cvt_pk_bf16_f32 v102, v212, v213
    v_mfma_f32_16x16x32_bf16 v[252:255], a[220:223], a[52:55], v[252:255]
    ds_read_b64_tr_b16 a[218:219], v69 offset:26624
    s_waitcnt lgkmcnt(6)
    v_mfma_f32_16x16x32_bf16 v[224:227], a[224:227], a[20:23], v[224:227]
    ds_read_b64_tr_b16 a[220:221], v70 offset:24576
    s_add_u32 m0, s46, 41984
    v_mfma_f32_16x16x32_bf16 v[228:231], a[224:227], a[56:59], v[228:231]
    ds_read_b64_tr_b16 a[222:223], v70 offset:26624
    buffer_load_dwordx4 v57, s[16:19], s73 offen lds
    v_mfma_f32_16x16x32_bf16 v[232:235], a[228:231], a[20:23], v[232:235]
    ds_read_b64_tr_b16 a[224:225], v71 offset:24576
    v_cvt_pk_bf16_f32 v103, v214, v215
    v_mfma_f32_16x16x32_bf16 v[236:239], a[228:231], a[56:59], v[236:239]
    ds_read_b64_tr_b16 a[226:227], v71 offset:26624
    s_waitcnt lgkmcnt(6)
    v_mfma_f32_16x16x32_bf16 v[240:243], a[232:235], a[20:23], v[240:243]
    ds_read_b64_tr_b16 a[228:229], v72 offset:24576
    v_cvt_pk_bf16_f32 v104, v220, v221
    v_mfma_f32_16x16x32_bf16 v[244:247], a[232:235], a[56:59], v[244:247]
    ds_read_b64_tr_b16 a[230:231], v72 offset:26624
    v_mfma_f32_16x16x32_bf16 v[248:251], a[236:239], a[20:23], v[248:251]
    ds_read_b64_tr_b16 a[232:233], v69 offset:28672
    v_cvt_pk_bf16_f32 v105, v222, v223
    v_mfma_f32_16x16x32_bf16 v[252:255], a[236:239], a[56:59], v[252:255]
    ds_read_b64_tr_b16 a[234:235], v69 offset:30720
    s_waitcnt lgkmcnt(6)
    v_mfma_f32_16x16x32_bf16 v[224:227], a[216:219], a[24:27], v[224:227]
    ds_read_b64_tr_b16 a[236:237], v70 offset:28672
    s_add_u32 m0, s46, 43008
    v_mfma_f32_16x16x32_bf16 v[228:231], a[216:219], a[60:63], v[228:231]
    ds_read_b64_tr_b16 a[238:239], v70 offset:30720
    buffer_load_dwordx4 v58, s[16:19], s73 offen lds
    v_mfma_f32_16x16x32_bf16 v[232:235], a[220:223], a[24:27], v[232:235]
    ds_read_b64_tr_b16 a[216:217], v71 offset:28672
    v_mfma_f32_16x16x32_bf16 v[236:239], a[220:223], a[60:63], v[236:239]
    ds_read_b64_tr_b16 a[218:219], v71 offset:30720
    s_waitcnt lgkmcnt(6)
    v_mfma_f32_16x16x32_bf16 v[240:243], a[224:227], a[24:27], v[240:243]
    ds_read_b64_tr_b16 a[220:221], v72 offset:28672
    v_mfma_f32_16x16x32_bf16 v[244:247], a[224:227], a[60:63], v[244:247]
    ds_read_b64_tr_b16 a[222:223], v72 offset:30720
    buffer_store_dwordx4 v[102:105], v119, s[40:43], s71 offen offset:3072 sc1
    v_mfma_f32_16x16x32_bf16 v[248:251], a[228:231], a[24:27], v[248:251]
    ds_read_b64_tr_b16 a[224:225], v69 offset:32768
    v_mfma_f32_16x16x32_bf16 v[252:255], a[228:231], a[60:63], v[252:255]
    ds_read_b64_tr_b16 a[226:227], v69 offset:34816
    s_waitcnt lgkmcnt(6)
    v_mfma_f32_16x16x32_bf16 v[224:227], a[232:235], a[28:31], v[224:227]
    ds_read_b64_tr_b16 a[228:229], v70 offset:32768
    s_add_u32 m0, s46, 44032
    v_mfma_f32_16x16x32_bf16 v[228:231], a[232:235], a[64:67], v[228:231]
    ds_read_b64_tr_b16 a[230:231], v70 offset:34816
    buffer_load_dwordx4 v59, s[16:19], s73 offen lds
    v_mfma_f32_16x16x32_bf16 v[232:235], a[236:239], a[28:31], v[232:235]
    ds_read_b64_tr_b16 a[232:233], v71 offset:32768
    v_mfma_f32_16x16x32_bf16 v[236:239], a[236:239], a[64:67], v[236:239]
    ds_read_b64_tr_b16 a[234:235], v71 offset:34816
    s_waitcnt lgkmcnt(6)
    v_mfma_f32_16x16x32_bf16 v[240:243], a[216:219], a[28:31], v[240:243]
    ds_read_b64_tr_b16 a[236:237], v72 offset:32768
    v_mfma_f32_16x16x32_bf16 v[244:247], a[216:219], a[64:67], v[244:247]
    ds_read_b64_tr_b16 a[238:239], v72 offset:34816
    s_barrier
    v_mfma_f32_16x16x32_bf16 v[248:251], a[220:223], a[28:31], v[248:251]
    ds_read_b64_tr_b16 a[216:217], v73 offset:0
    v_mfma_f32_16x16x32_bf16 v[252:255], a[220:223], a[64:67], v[252:255]
    ds_read_b64_tr_b16 a[218:219], v73 offset:2048
    s_waitcnt lgkmcnt(6)
    v_mfma_f32_16x16x32_bf16 v[224:227], a[224:227], a[32:35], v[224:227]
    ds_read_b64_tr_b16 a[220:221], v74 offset:0
    s_add_u32 m0, s46, 45056
    v_mfma_f32_16x16x32_bf16 v[228:231], a[224:227], a[68:71], v[228:231]
    ds_read_b64_tr_b16 a[222:223], v74 offset:2048
    buffer_load_dwordx4 v60, s[16:19], s73 offen lds
    v_mfma_f32_16x16x32_bf16 v[232:235], a[228:231], a[32:35], v[232:235]
    ds_read_b64_tr_b16 a[224:225], v75 offset:0
    v_mfma_f32_16x16x32_bf16 v[236:239], a[228:231], a[68:71], v[236:239]
    ds_read_b64_tr_b16 a[226:227], v75 offset:2048
    s_waitcnt lgkmcnt(6)
    v_mfma_f32_16x16x32_bf16 v[240:243], a[232:235], a[32:35], v[240:243]
    ds_read_b64_tr_b16 a[228:229], v76 offset:0
    v_mfma_f32_16x16x32_bf16 v[244:247], a[232:235], a[68:71], v[244:247]
    ds_read_b64_tr_b16 a[230:231], v76 offset:2048
    v_mfma_f32_16x16x32_bf16 v[248:251], a[236:239], a[32:35], v[248:251]
    ds_read_b64_tr_b16 a[232:233], v73 offset:4096
    v_mfma_f32_16x16x32_bf16 v[252:255], a[236:239], a[68:71], v[252:255]
    ds_read_b64_tr_b16 a[234:235], v73 offset:6144
    s_waitcnt lgkmcnt(6)
    v_mfma_f32_16x16x32_bf16 v[160:163], a[216:219], a[0:3], v[160:163]
    ds_read_b64_tr_b16 a[236:237], v74 offset:4096
    v_mfma_f32_16x16x32_bf16 v[164:167], a[216:219], a[36:39], v[164:167]
    ds_read_b64_tr_b16 a[238:239], v74 offset:6144
    v_mfma_f32_16x16x32_bf16 v[168:171], a[220:223], a[0:3], v[168:171]
    ds_read_b64_tr_b16 a[216:217], v75 offset:4096
    v_mfma_f32_16x16x32_bf16 v[172:175], a[220:223], a[36:39], v[172:175]
    ds_read_b64_tr_b16 a[218:219], v75 offset:6144
    s_waitcnt lgkmcnt(6)
    v_mfma_f32_16x16x32_bf16 v[176:179], a[224:227], a[0:3], v[176:179]
    ds_read_b64_tr_b16 a[220:221], v76 offset:4096
    v_mfma_f32_16x16x32_bf16 v[180:183], a[224:227], a[36:39], v[180:183]
    ds_read_b64_tr_b16 a[222:223], v76 offset:6144
    v_mfma_f32_16x16x32_bf16 v[184:187], a[228:231], a[0:3], v[184:187]
    ds_read_b64_tr_b16 a[224:225], v73 offset:8192
    v_cvt_pk_bf16_f32 v90, v224, v225
    v_mfma_f32_16x16x32_bf16 v[188:191], a[228:231], a[36:39], v[188:191]
    ds_read_b64_tr_b16 a[226:227], v73 offset:10240
    s_waitcnt lgkmcnt(6)
    v_mfma_f32_16x16x32_bf16 v[160:163], a[232:235], a[4:7], v[160:163]
    ds_read_b64_tr_b16 a[228:229], v74 offset:8192
    v_cvt_pk_bf16_f32 v91, v226, v227
    v_mfma_f32_16x16x32_bf16 v[164:167], a[232:235], a[40:43], v[164:167]
    ds_read_b64_tr_b16 a[230:231], v74 offset:10240
    v_mfma_f32_16x16x32_bf16 v[168:171], a[236:239], a[4:7], v[168:171]
    ds_read_b64_tr_b16 a[232:233], v75 offset:8192
    v_cvt_pk_bf16_f32 v92, v232, v233
    v_mfma_f32_16x16x32_bf16 v[172:175], a[236:239], a[40:43], v[172:175]
    ds_read_b64_tr_b16 a[234:235], v75 offset:10240
    s_waitcnt lgkmcnt(6)
    v_mfma_f32_16x16x32_bf16 v[176:179], a[216:219], a[4:7], v[176:179]
    ds_read_b64_tr_b16 a[236:237], v76 offset:8192
    v_cvt_pk_bf16_f32 v93, v234, v235
    v_mfma_f32_16x16x32_bf16 v[180:183], a[216:219], a[40:43], v[180:183]
    ds_read_b64_tr_b16 a[238:239], v76 offset:10240
    buffer_store_dwordx4 v[90:93], v81, s[40:43], s71 offen offset:2048 sc1
    v_mfma_f32_16x16x32_bf16 v[184:187], a[220:223], a[4:7], v[184:187]
    ds_read_b64_tr_b16 a[216:217], v73 offset:12288
    v_cvt_pk_bf16_f32 v94, v228, v229
    v_mfma_f32_16x16x32_bf16 v[188:191], a[220:223], a[40:43], v[188:191]
    ds_read_b64_tr_b16 a[218:219], v73 offset:14336
    s_waitcnt lgkmcnt(6)
    v_mfma_f32_16x16x32_bf16 v[160:163], a[224:227], a[8:11], v[160:163]
    ds_read_b64_tr_b16 a[220:221], v74 offset:12288
    v_cvt_pk_bf16_f32 v95, v230, v231
    v_mfma_f32_16x16x32_bf16 v[164:167], a[224:227], a[44:47], v[164:167]
    ds_read_b64_tr_b16 a[222:223], v74 offset:14336
    v_mfma_f32_16x16x32_bf16 v[168:171], a[228:231], a[8:11], v[168:171]
    ds_read_b64_tr_b16 a[224:225], v75 offset:12288
    v_cvt_pk_bf16_f32 v96, v236, v237
    v_mfma_f32_16x16x32_bf16 v[172:175], a[228:231], a[44:47], v[172:175]
    ds_read_b64_tr_b16 a[226:227], v75 offset:14336
    s_waitcnt lgkmcnt(6)
    v_mfma_f32_16x16x32_bf16 v[176:179], a[232:235], a[8:11], v[176:179]
    ds_read_b64_tr_b16 a[228:229], v76 offset:12288
    v_cvt_pk_bf16_f32 v97, v238, v239
    v_mfma_f32_16x16x32_bf16 v[180:183], a[232:235], a[44:47], v[180:183]
    ds_read_b64_tr_b16 a[230:231], v76 offset:14336
    buffer_store_dwordx4 v[94:97], v124, s[40:43], s71 offen offset:0 sc1
    v_mfma_f32_16x16x32_bf16 v[184:187], a[236:239], a[8:11], v[184:187]
    ds_read_b64_tr_b16 a[232:233], v73 offset:16384
    v_cvt_pk_bf16_f32 v98, v240, v241
    v_mfma_f32_16x16x32_bf16 v[188:191], a[236:239], a[44:47], v[188:191]
    ds_read_b64_tr_b16 a[234:235], v73 offset:18432
    s_waitcnt lgkmcnt(6)
    v_mfma_f32_16x16x32_bf16 v[160:163], a[216:219], a[12:15], v[160:163]
    ds_read_b64_tr_b16 a[236:237], v74 offset:16384
    v_cvt_pk_bf16_f32 v99, v242, v243
    v_mfma_f32_16x16x32_bf16 v[164:167], a[216:219], a[48:51], v[164:167]
    ds_read_b64_tr_b16 a[238:239], v74 offset:18432
    v_mfma_f32_16x16x32_bf16 v[168:171], a[220:223], a[12:15], v[168:171]
    ds_read_b64_tr_b16 a[216:217], v75 offset:16384
    v_cvt_pk_bf16_f32 v100, v248, v249
    v_mfma_f32_16x16x32_bf16 v[172:175], a[220:223], a[48:51], v[172:175]
    ds_read_b64_tr_b16 a[218:219], v75 offset:18432
    s_waitcnt lgkmcnt(6)
    v_mfma_f32_16x16x32_bf16 v[176:179], a[224:227], a[12:15], v[176:179]
    ds_read_b64_tr_b16 a[220:221], v76 offset:16384
    v_cvt_pk_bf16_f32 v101, v250, v251
    v_mfma_f32_16x16x32_bf16 v[180:183], a[224:227], a[48:51], v[180:183]
    ds_read_b64_tr_b16 a[222:223], v76 offset:18432
    buffer_store_dwordx4 v[98:101], v81, s[40:43], s71 offen offset:3072 sc1
    v_mfma_f32_16x16x32_bf16 v[184:187], a[228:231], a[12:15], v[184:187]
    ds_read_b64_tr_b16 a[224:225], v73 offset:20480
    v_cvt_pk_bf16_f32 v102, v244, v245
    v_mfma_f32_16x16x32_bf16 v[188:191], a[228:231], a[48:51], v[188:191]
    ds_read_b64_tr_b16 a[226:227], v73 offset:22528
    s_waitcnt lgkmcnt(6)
    v_mfma_f32_16x16x32_bf16 v[160:163], a[232:235], a[16:19], v[160:163]
    ds_read_b64_tr_b16 a[228:229], v74 offset:20480
    v_cvt_pk_bf16_f32 v103, v246, v247
    v_mfma_f32_16x16x32_bf16 v[164:167], a[232:235], a[52:55], v[164:167]
    ds_read_b64_tr_b16 a[230:231], v74 offset:22528
    v_mfma_f32_16x16x32_bf16 v[168:171], a[236:239], a[16:19], v[168:171]
    ds_read_b64_tr_b16 a[232:233], v75 offset:20480
    v_cvt_pk_bf16_f32 v104, v252, v253
    v_mfma_f32_16x16x32_bf16 v[172:175], a[236:239], a[52:55], v[172:175]
    ds_read_b64_tr_b16 a[234:235], v75 offset:22528
    s_waitcnt lgkmcnt(6)
    v_mfma_f32_16x16x32_bf16 v[176:179], a[216:219], a[16:19], v[176:179]
    ds_read_b64_tr_b16 a[236:237], v76 offset:20480
    v_cvt_pk_bf16_f32 v105, v254, v255
    v_mfma_f32_16x16x32_bf16 v[180:183], a[216:219], a[52:55], v[180:183]
    ds_read_b64_tr_b16 a[238:239], v76 offset:22528
    buffer_store_dwordx4 v[102:105], v124, s[40:43], s71 offen offset:1024 sc1
    v_mfma_f32_16x16x32_bf16 v[184:187], a[220:223], a[16:19], v[184:187]
    ds_read_b64_tr_b16 a[216:217], v73 offset:24576
    v_mfma_f32_16x16x32_bf16 v[188:191], a[220:223], a[52:55], v[188:191]
    ds_read_b64_tr_b16 a[218:219], v73 offset:26624
    s_waitcnt lgkmcnt(6)
    v_mfma_f32_16x16x32_bf16 v[160:163], a[224:227], a[20:23], v[160:163]
    ds_read_b64_tr_b16 a[220:221], v74 offset:24576
    v_mfma_f32_16x16x32_bf16 v[164:167], a[224:227], a[56:59], v[164:167]
    ds_read_b64_tr_b16 a[222:223], v74 offset:26624
    v_mfma_f32_16x16x32_bf16 v[168:171], a[228:231], a[20:23], v[168:171]
    ds_read_b64_tr_b16 a[224:225], v75 offset:24576
    v_mfma_f32_16x16x32_bf16 v[172:175], a[228:231], a[56:59], v[172:175]
    ds_read_b64_tr_b16 a[226:227], v75 offset:26624
    s_waitcnt lgkmcnt(6)
    v_mfma_f32_16x16x32_bf16 v[176:179], a[232:235], a[20:23], v[176:179]
    ds_read_b64_tr_b16 a[228:229], v76 offset:24576
    v_mfma_f32_16x16x32_bf16 v[180:183], a[232:235], a[56:59], v[180:183]
    ds_read_b64_tr_b16 a[230:231], v76 offset:26624
    v_mfma_f32_16x16x32_bf16 v[184:187], a[236:239], a[20:23], v[184:187]
    ds_read_b64_tr_b16 a[232:233], v73 offset:28672
    v_mfma_f32_16x16x32_bf16 v[188:191], a[236:239], a[56:59], v[188:191]
    ds_read_b64_tr_b16 a[234:235], v73 offset:30720
    s_waitcnt lgkmcnt(6)
    v_mfma_f32_16x16x32_bf16 v[160:163], a[216:219], a[24:27], v[160:163]
    ds_read_b64_tr_b16 a[236:237], v74 offset:28672
    v_mfma_f32_16x16x32_bf16 v[164:167], a[216:219], a[60:63], v[164:167]
    ds_read_b64_tr_b16 a[238:239], v74 offset:30720
    v_mfma_f32_16x16x32_bf16 v[168:171], a[220:223], a[24:27], v[168:171]
    ds_read_b64_tr_b16 a[216:217], v75 offset:28672
    v_mfma_f32_16x16x32_bf16 v[172:175], a[220:223], a[60:63], v[172:175]
    ds_read_b64_tr_b16 a[218:219], v75 offset:30720
    s_waitcnt lgkmcnt(6)
    v_mfma_f32_16x16x32_bf16 v[176:179], a[224:227], a[24:27], v[176:179]
    ds_read_b64_tr_b16 a[220:221], v76 offset:28672
    v_mfma_f32_16x16x32_bf16 v[180:183], a[224:227], a[60:63], v[180:183]
    ds_read_b64_tr_b16 a[222:223], v76 offset:30720
    v_mfma_f32_16x16x32_bf16 v[184:187], a[228:231], a[24:27], v[184:187]
    ds_read_b64_tr_b16 a[224:225], v73 offset:32768
    v_mfma_f32_16x16x32_bf16 v[188:191], a[228:231], a[60:63], v[188:191]
    ds_read_b64_tr_b16 a[226:227], v73 offset:34816
    s_waitcnt lgkmcnt(6)
    v_mfma_f32_16x16x32_bf16 v[160:163], a[232:235], a[28:31], v[160:163]
    ds_read_b64_tr_b16 a[228:229], v74 offset:32768
    v_mfma_f32_16x16x32_bf16 v[164:167], a[232:235], a[64:67], v[164:167]
    ds_read_b64_tr_b16 a[230:231], v74 offset:34816
    v_mfma_f32_16x16x32_bf16 v[168:171], a[236:239], a[28:31], v[168:171]
    ds_read_b64_tr_b16 a[232:233], v75 offset:32768
    v_mfma_f32_16x16x32_bf16 v[172:175], a[236:239], a[64:67], v[172:175]
    ds_read_b64_tr_b16 a[234:235], v75 offset:34816
    s_waitcnt lgkmcnt(6)
    v_mfma_f32_16x16x32_bf16 v[176:179], a[216:219], a[28:31], v[176:179]
    ds_read_b64_tr_b16 a[236:237], v76 offset:32768
    v_mfma_f32_16x16x32_bf16 v[180:183], a[216:219], a[64:67], v[180:183]
    ds_read_b64_tr_b16 a[238:239], v76 offset:34816
    s_waitcnt vmcnt(17)
    s_barrier
    v_mfma_f32_16x16x32_bf16 v[184:187], a[220:223], a[28:31], v[184:187]
    ds_read_b64_tr_b16 a[216:217], v61 offset:0
    v_mfma_f32_16x16x32_bf16 v[188:191], a[220:223], a[64:67], v[188:191]
    ds_read_b64_tr_b16 a[218:219], v61 offset:2048
    s_waitcnt lgkmcnt(6)
    v_mfma_f32_16x16x32_bf16 v[160:163], a[224:227], a[32:35], v[160:163]
    ds_read_b64_tr_b16 a[220:221], v62 offset:0
    v_mfma_f32_16x16x32_bf16 v[164:167], a[224:227], a[68:71], v[164:167]
    ds_read_b64_tr_b16 a[222:223], v62 offset:2048
    v_mfma_f32_16x16x32_bf16 v[168:171], a[228:231], a[32:35], v[168:171]
    ds_read_b64_tr_b16 a[224:225], v63 offset:0
    v_mfma_f32_16x16x32_bf16 v[172:175], a[228:231], a[68:71], v[172:175]
    ds_read_b64_tr_b16 a[226:227], v63 offset:2048
    s_waitcnt lgkmcnt(6)
    v_mfma_f32_16x16x32_bf16 v[176:179], a[232:235], a[32:35], v[176:179]
    ds_read_b64_tr_b16 a[228:229], v64 offset:0
    v_mfma_f32_16x16x32_bf16 v[180:183], a[232:235], a[68:71], v[180:183]
    ds_read_b64_tr_b16 a[230:231], v64 offset:2048
    v_mfma_f32_16x16x32_bf16 v[184:187], a[236:239], a[32:35], v[184:187]
    ds_read_b64_tr_b16 a[232:233], v61 offset:4096
    v_mfma_f32_16x16x32_bf16 v[188:191], a[236:239], a[68:71], v[188:191]
    ds_read_b64_tr_b16 a[234:235], v61 offset:6144
    s_waitcnt lgkmcnt(6)
    v_mfma_f32_16x16x32_bf16 v[128:131], a[216:219], a[0:3], v[128:131]
    ds_read_b64_tr_b16 a[236:237], v62 offset:4096
    v_mfma_f32_16x16x32_bf16 v[132:135], a[216:219], a[36:39], v[132:135]
    ds_read_b64_tr_b16 a[238:239], v62 offset:6144
    v_mfma_f32_16x16x32_bf16 v[136:139], a[220:223], a[0:3], v[136:139]
    ds_read_b64_tr_b16 a[216:217], v63 offset:4096
    v_mfma_f32_16x16x32_bf16 v[140:143], a[220:223], a[36:39], v[140:143]
    ds_read_b64_tr_b16 a[218:219], v63 offset:6144
    s_waitcnt lgkmcnt(6)
    v_mfma_f32_16x16x32_bf16 v[144:147], a[224:227], a[0:3], v[144:147]
    ds_read_b64_tr_b16 a[220:221], v64 offset:4096
    v_mfma_f32_16x16x32_bf16 v[148:151], a[224:227], a[36:39], v[148:151]
    ds_read_b64_tr_b16 a[222:223], v64 offset:6144
    v_mfma_f32_16x16x32_bf16 v[152:155], a[228:231], a[0:3], v[152:155]
    ds_read_b64_tr_b16 a[224:225], v61 offset:8192
    v_cvt_pk_bf16_f32 v90, v160, v161
    v_mfma_f32_16x16x32_bf16 v[156:159], a[228:231], a[36:39], v[156:159]
    ds_read_b64_tr_b16 a[226:227], v61 offset:10240
    s_waitcnt lgkmcnt(6)
    v_mfma_f32_16x16x32_bf16 v[128:131], a[232:235], a[4:7], v[128:131]
    ds_read_b64_tr_b16 a[228:229], v62 offset:8192
    v_cvt_pk_bf16_f32 v91, v162, v163
    v_mfma_f32_16x16x32_bf16 v[132:135], a[232:235], a[40:43], v[132:135]
    ds_read_b64_tr_b16 a[230:231], v62 offset:10240
    v_mfma_f32_16x16x32_bf16 v[136:139], a[236:239], a[4:7], v[136:139]
    ds_read_b64_tr_b16 a[232:233], v63 offset:8192
    v_cvt_pk_bf16_f32 v92, v168, v169
    v_mfma_f32_16x16x32_bf16 v[140:143], a[236:239], a[40:43], v[140:143]
    ds_read_b64_tr_b16 a[234:235], v63 offset:10240
    s_waitcnt lgkmcnt(6)
    v_mfma_f32_16x16x32_bf16 v[144:147], a[216:219], a[4:7], v[144:147]
    ds_read_b64_tr_b16 a[236:237], v64 offset:8192
    v_cvt_pk_bf16_f32 v93, v170, v171
    v_mfma_f32_16x16x32_bf16 v[148:151], a[216:219], a[40:43], v[148:151]
    ds_read_b64_tr_b16 a[238:239], v64 offset:10240
    buffer_store_dwordx4 v[90:93], v116, s[40:43], s71 offen offset:0 sc1
    v_mfma_f32_16x16x32_bf16 v[152:155], a[220:223], a[4:7], v[152:155]
    ds_read_b64_tr_b16 a[216:217], v61 offset:12288
    v_cvt_pk_bf16_f32 v94, v164, v165
    v_mfma_f32_16x16x32_bf16 v[156:159], a[220:223], a[40:43], v[156:159]
    ds_read_b64_tr_b16 a[218:219], v61 offset:14336
    s_waitcnt lgkmcnt(6)
    v_mfma_f32_16x16x32_bf16 v[128:131], a[224:227], a[8:11], v[128:131]
    ds_read_b64_tr_b16 a[220:221], v62 offset:12288
    v_cvt_pk_bf16_f32 v95, v166, v167
    v_mfma_f32_16x16x32_bf16 v[132:135], a[224:227], a[44:47], v[132:135]
    ds_read_b64_tr_b16 a[222:223], v62 offset:14336
    v_mfma_f32_16x16x32_bf16 v[136:139], a[228:231], a[8:11], v[136:139]
    ds_read_b64_tr_b16 a[224:225], v63 offset:12288
    v_cvt_pk_bf16_f32 v96, v172, v173
    v_mfma_f32_16x16x32_bf16 v[140:143], a[228:231], a[44:47], v[140:143]
    ds_read_b64_tr_b16 a[226:227], v63 offset:14336
    s_waitcnt lgkmcnt(6)
    v_mfma_f32_16x16x32_bf16 v[144:147], a[232:235], a[8:11], v[144:147]
    ds_read_b64_tr_b16 a[228:229], v64 offset:12288
    v_cvt_pk_bf16_f32 v97, v174, v175
    v_mfma_f32_16x16x32_bf16 v[148:151], a[232:235], a[44:47], v[148:151]
    ds_read_b64_tr_b16 a[230:231], v64 offset:14336
    buffer_store_dwordx4 v[94:97], v124, s[40:43], s71 offen offset:2048 sc1
    v_mfma_f32_16x16x32_bf16 v[152:155], a[236:239], a[8:11], v[152:155]
    ds_read_b64_tr_b16 a[232:233], v61 offset:16384
    v_cvt_pk_bf16_f32 v98, v176, v177
    v_mfma_f32_16x16x32_bf16 v[156:159], a[236:239], a[44:47], v[156:159]
    ds_read_b64_tr_b16 a[234:235], v61 offset:18432
    s_waitcnt lgkmcnt(6)
    v_mfma_f32_16x16x32_bf16 v[128:131], a[216:219], a[12:15], v[128:131]
    ds_read_b64_tr_b16 a[236:237], v62 offset:16384
    v_cvt_pk_bf16_f32 v99, v178, v179
    v_mfma_f32_16x16x32_bf16 v[132:135], a[216:219], a[48:51], v[132:135]
    ds_read_b64_tr_b16 a[238:239], v62 offset:18432
    v_mfma_f32_16x16x32_bf16 v[136:139], a[220:223], a[12:15], v[136:139]
    ds_read_b64_tr_b16 a[216:217], v63 offset:16384
    v_cvt_pk_bf16_f32 v100, v184, v185
    v_mfma_f32_16x16x32_bf16 v[140:143], a[220:223], a[48:51], v[140:143]
    ds_read_b64_tr_b16 a[218:219], v63 offset:18432
    s_waitcnt lgkmcnt(6)
    v_mfma_f32_16x16x32_bf16 v[144:147], a[224:227], a[12:15], v[144:147]
    ds_read_b64_tr_b16 a[220:221], v64 offset:16384
    v_cvt_pk_bf16_f32 v101, v186, v187
    v_mfma_f32_16x16x32_bf16 v[148:151], a[224:227], a[48:51], v[148:151]
    ds_read_b64_tr_b16 a[222:223], v64 offset:18432
    buffer_store_dwordx4 v[98:101], v116, s[40:43], s71 offen offset:1024 sc1
    v_mfma_f32_16x16x32_bf16 v[152:155], a[228:231], a[12:15], v[152:155]
    ds_read_b64_tr_b16 a[224:225], v61 offset:20480
    v_cvt_pk_bf16_f32 v102, v180, v181
    v_mfma_f32_16x16x32_bf16 v[156:159], a[228:231], a[48:51], v[156:159]
    ds_read_b64_tr_b16 a[226:227], v61 offset:22528
    s_waitcnt lgkmcnt(6)
    v_mfma_f32_16x16x32_bf16 v[128:131], a[232:235], a[16:19], v[128:131]
    ds_read_b64_tr_b16 a[228:229], v62 offset:20480
    v_cvt_pk_bf16_f32 v103, v182, v183
    v_mfma_f32_16x16x32_bf16 v[132:135], a[232:235], a[52:55], v[132:135]
    ds_read_b64_tr_b16 a[230:231], v62 offset:22528
    v_mfma_f32_16x16x32_bf16 v[136:139], a[236:239], a[16:19], v[136:139]
    ds_read_b64_tr_b16 a[232:233], v63 offset:20480
    v_cvt_pk_bf16_f32 v104, v188, v189
    v_mfma_f32_16x16x32_bf16 v[140:143], a[236:239], a[52:55], v[140:143]
    ds_read_b64_tr_b16 a[234:235], v63 offset:22528
    s_waitcnt lgkmcnt(6)
    v_mfma_f32_16x16x32_bf16 v[144:147], a[216:219], a[16:19], v[144:147]
    ds_read_b64_tr_b16 a[236:237], v64 offset:20480
    v_cvt_pk_bf16_f32 v105, v190, v191
    v_mfma_f32_16x16x32_bf16 v[148:151], a[216:219], a[52:55], v[148:151]
    ds_read_b64_tr_b16 a[238:239], v64 offset:22528
    buffer_store_dwordx4 v[102:105], v124, s[40:43], s71 offen offset:3072 sc1
    v_mfma_f32_16x16x32_bf16 v[152:155], a[220:223], a[16:19], v[152:155]
    ds_read_b64_tr_b16 a[216:217], v61 offset:24576
    v_mfma_f32_16x16x32_bf16 v[156:159], a[220:223], a[52:55], v[156:159]
    ds_read_b64_tr_b16 a[218:219], v61 offset:26624
    s_waitcnt lgkmcnt(6)
    v_mfma_f32_16x16x32_bf16 v[128:131], a[224:227], a[20:23], v[128:131]
    ds_read_b64_tr_b16 a[220:221], v62 offset:24576
    v_mfma_f32_16x16x32_bf16 v[132:135], a[224:227], a[56:59], v[132:135]
    ds_read_b64_tr_b16 a[222:223], v62 offset:26624
    v_mfma_f32_16x16x32_bf16 v[136:139], a[228:231], a[20:23], v[136:139]
    ds_read_b64_tr_b16 a[224:225], v63 offset:24576
    v_mfma_f32_16x16x32_bf16 v[140:143], a[228:231], a[56:59], v[140:143]
    ds_read_b64_tr_b16 a[226:227], v63 offset:26624
    s_waitcnt lgkmcnt(6)
    v_mfma_f32_16x16x32_bf16 v[144:147], a[232:235], a[20:23], v[144:147]
    ds_read_b64_tr_b16 a[228:229], v64 offset:24576
    v_mfma_f32_16x16x32_bf16 v[148:151], a[232:235], a[56:59], v[148:151]
    ds_read_b64_tr_b16 a[230:231], v64 offset:26624
    v_mfma_f32_16x16x32_bf16 v[152:155], a[236:239], a[20:23], v[152:155]
    ds_read_b64_tr_b16 a[232:233], v61 offset:28672
    v_mfma_f32_16x16x32_bf16 v[156:159], a[236:239], a[56:59], v[156:159]
    ds_read_b64_tr_b16 a[234:235], v61 offset:30720
    s_waitcnt lgkmcnt(6)
    v_mfma_f32_16x16x32_bf16 v[128:131], a[216:219], a[24:27], v[128:131]
    ds_read_b64_tr_b16 a[236:237], v62 offset:28672
    v_mfma_f32_16x16x32_bf16 v[132:135], a[216:219], a[60:63], v[132:135]
    ds_read_b64_tr_b16 a[238:239], v62 offset:30720
    v_mfma_f32_16x16x32_bf16 v[136:139], a[220:223], a[24:27], v[136:139]
    ds_read_b64_tr_b16 a[216:217], v63 offset:28672
    v_mfma_f32_16x16x32_bf16 v[140:143], a[220:223], a[60:63], v[140:143]
    ds_read_b64_tr_b16 a[218:219], v63 offset:30720
    s_waitcnt lgkmcnt(6)
    v_mfma_f32_16x16x32_bf16 v[144:147], a[224:227], a[24:27], v[144:147]
    ds_read_b64_tr_b16 a[220:221], v64 offset:28672
    v_mfma_f32_16x16x32_bf16 v[148:151], a[224:227], a[60:63], v[148:151]
    ds_read_b64_tr_b16 a[222:223], v64 offset:30720
    v_mfma_f32_16x16x32_bf16 v[152:155], a[228:231], a[24:27], v[152:155]
    ds_read_b64_tr_b16 a[224:225], v61 offset:32768
    v_mfma_f32_16x16x32_bf16 v[156:159], a[228:231], a[60:63], v[156:159]
    ds_read_b64_tr_b16 a[226:227], v61 offset:34816
    s_waitcnt lgkmcnt(6)
    v_mfma_f32_16x16x32_bf16 v[128:131], a[232:235], a[28:31], v[128:131]
    ds_read_b64_tr_b16 a[228:229], v62 offset:32768
    v_mfma_f32_16x16x32_bf16 v[132:135], a[232:235], a[64:67], v[132:135]
    ds_read_b64_tr_b16 a[230:231], v62 offset:34816
    v_mfma_f32_16x16x32_bf16 v[136:139], a[236:239], a[28:31], v[136:139]
    ds_read_b64_tr_b16 a[232:233], v63 offset:32768
    v_mfma_f32_16x16x32_bf16 v[140:143], a[236:239], a[64:67], v[140:143]
    ds_read_b64_tr_b16 a[234:235], v63 offset:34816
    s_waitcnt lgkmcnt(6)
    v_mfma_f32_16x16x32_bf16 v[144:147], a[216:219], a[28:31], v[144:147]
    ds_read_b64_tr_b16 a[236:237], v64 offset:32768
    v_mfma_f32_16x16x32_bf16 v[148:151], a[216:219], a[64:67], v[148:151]
    ds_read_b64_tr_b16 a[238:239], v64 offset:34816
    s_waitcnt vmcnt(8)
    s_barrier
    v_mfma_f32_16x16x32_bf16 v[152:155], a[220:223], a[28:31], v[152:155]
    ds_read_b64_tr_b16 a[216:217], v79 offset:0
    v_mfma_f32_16x16x32_bf16 v[156:159], a[220:223], a[64:67], v[156:159]
    ds_read_b64_tr_b16 a[218:219], v79 offset:1024
    s_waitcnt lgkmcnt(6)
    v_mfma_f32_16x16x32_bf16 v[128:131], a[224:227], a[32:35], v[128:131]
    ds_read_b64_tr_b16 a[220:221], v80 offset:0
    v_mfma_f32_16x16x32_bf16 v[132:135], a[224:227], a[68:71], v[132:135]
    ds_read_b64_tr_b16 a[222:223], v80 offset:1024
    v_mfma_f32_16x16x32_bf16 v[136:139], a[228:231], a[32:35], v[136:139]
    ds_read_b64_tr_b16 a[224:225], v79 offset:2048
    v_mfma_f32_16x16x32_bf16 v[140:143], a[228:231], a[68:71], v[140:143]
    ds_read_b64_tr_b16 a[226:227], v79 offset:3072
    s_waitcnt lgkmcnt(6)
    v_mfma_f32_16x16x32_bf16 v[144:147], a[232:235], a[32:35], v[144:147]
    ds_read_b64_tr_b16 a[228:229], v80 offset:2048
    v_mfma_f32_16x16x32_bf16 v[148:151], a[232:235], a[68:71], v[148:151]
    ds_read_b64_tr_b16 a[230:231], v80 offset:3072
    v_mfma_f32_16x16x32_bf16 v[152:155], a[236:239], a[32:35], v[152:155]
    ds_read_b64_tr_b16 a[232:233], v79 offset:4096
    v_mfma_f32_16x16x32_bf16 v[156:159], a[236:239], a[68:71], v[156:159]
    ds_read_b64_tr_b16 a[234:235], v79 offset:5120
    s_waitcnt lgkmcnt(6)
    v_mfma_f32_16x16x32_bf16 v[192:195], a[216:219], a[144:147], 0
    ds_read_b64_tr_b16 a[236:237], v80 offset:4096
    v_mfma_f32_16x16x32_bf16 v[196:199], a[216:219], a[180:183], 0
    ds_read_b64_tr_b16 a[238:239], v80 offset:5120
    v_mfma_f32_16x16x32_bf16 v[200:203], a[220:223], a[144:147], 0
    ds_read_b64_tr_b16 a[216:217], v79 offset:6144
    v_mfma_f32_16x16x32_bf16 v[204:207], a[220:223], a[180:183], 0
    ds_read_b64_tr_b16 a[218:219], v79 offset:7168
    s_waitcnt lgkmcnt(6)
    v_mfma_f32_16x16x32_bf16 v[192:195], a[224:227], a[148:151], v[192:195]
    ds_read_b64_tr_b16 a[220:221], v80 offset:6144
    v_mfma_f32_16x16x32_bf16 v[196:199], a[224:227], a[184:187], v[196:199]
    ds_read_b64_tr_b16 a[222:223], v80 offset:7168
    v_mfma_f32_16x16x32_bf16 v[200:203], a[228:231], a[148:151], v[200:203]
    ds_read_b64_tr_b16 a[224:225], v79 offset:8192
    v_cvt_pk_bf16_f32 v90, v128, v129
    v_mfma_f32_16x16x32_bf16 v[204:207], a[228:231], a[184:187], v[204:207]
    ds_read_b64_tr_b16 a[226:227], v79 offset:9216
    s_waitcnt lgkmcnt(6)
    v_mfma_f32_16x16x32_bf16 v[192:195], a[232:235], a[152:155], v[192:195]
    ds_read_b64_tr_b16 a[228:229], v80 offset:8192
    v_cvt_pk_bf16_f32 v91, v130, v131
    v_mfma_f32_16x16x32_bf16 v[196:199], a[232:235], a[188:191], v[196:199]
    ds_read_b64_tr_b16 a[230:231], v80 offset:9216
    v_mfma_f32_16x16x32_bf16 v[200:203], a[236:239], a[152:155], v[200:203]
    ds_read_b64_tr_b16 a[232:233], v79 offset:10240
    v_cvt_pk_bf16_f32 v92, v136, v137
    v_mfma_f32_16x16x32_bf16 v[204:207], a[236:239], a[188:191], v[204:207]
    ds_read_b64_tr_b16 a[234:235], v79 offset:11264
    s_waitcnt lgkmcnt(6)
    v_mfma_f32_16x16x32_bf16 v[192:195], a[216:219], a[156:159], v[192:195]
    ds_read_b64_tr_b16 a[236:237], v80 offset:10240
    v_cvt_pk_bf16_f32 v93, v138, v139
    v_mfma_f32_16x16x32_bf16 v[196:199], a[216:219], a[192:195], v[196:199]
    ds_read_b64_tr_b16 a[238:239], v80 offset:11264
    buffer_store_dwordx4 v[90:93], v116, s[40:43], s71 offen offset:2048 sc1
    v_mfma_f32_16x16x32_bf16 v[200:203], a[220:223], a[156:159], v[200:203]
    ds_read_b64_tr_b16 a[216:217], v79 offset:12288
    v_cvt_pk_bf16_f32 v94, v132, v133
    v_mfma_f32_16x16x32_bf16 v[204:207], a[220:223], a[192:195], v[204:207]
    ds_read_b64_tr_b16 a[218:219], v79 offset:13312
    s_waitcnt lgkmcnt(6)
    v_mfma_f32_16x16x32_bf16 v[192:195], a[224:227], a[160:163], v[192:195]
    ds_read_b64_tr_b16 a[220:221], v80 offset:12288
    v_cvt_pk_bf16_f32 v95, v134, v135
    v_mfma_f32_16x16x32_bf16 v[196:199], a[224:227], a[196:199], v[196:199]
    ds_read_b64_tr_b16 a[222:223], v80 offset:13312
    v_mfma_f32_16x16x32_bf16 v[200:203], a[228:231], a[160:163], v[200:203]
    ds_read_b64_tr_b16 a[224:225], v79 offset:14336
    v_cvt_pk_bf16_f32 v96, v140, v141
    v_mfma_f32_16x16x32_bf16 v[204:207], a[228:231], a[196:199], v[204:207]
    ds_read_b64_tr_b16 a[226:227], v79 offset:15360
    s_waitcnt lgkmcnt(6)
    v_mfma_f32_16x16x32_bf16 v[192:195], a[232:235], a[164:167], v[192:195]
    ds_read_b64_tr_b16 a[228:229], v80 offset:14336
    v_cvt_pk_bf16_f32 v97, v142, v143
    v_mfma_f32_16x16x32_bf16 v[196:199], a[232:235], a[200:203], v[196:199]
    ds_read_b64_tr_b16 a[230:231], v80 offset:15360
    buffer_store_dwordx4 v[94:97], v125, s[40:43], s71 offen offset:0 sc1
    v_mfma_f32_16x16x32_bf16 v[200:203], a[236:239], a[164:167], v[200:203]
    ds_read_b64_tr_b16 a[232:233], v79 offset:16384
    v_cvt_pk_bf16_f32 v98, v144, v145
    v_mfma_f32_16x16x32_bf16 v[204:207], a[236:239], a[200:203], v[204:207]
    ds_read_b64_tr_b16 a[234:235], v79 offset:17408
    s_waitcnt lgkmcnt(6)
    v_mfma_f32_16x16x32_bf16 v[192:195], a[216:219], a[168:171], v[192:195]
    ds_read_b64_tr_b16 a[236:237], v80 offset:16384
    v_cvt_pk_bf16_f32 v99, v146, v147
    v_mfma_f32_16x16x32_bf16 v[196:199], a[216:219], a[204:207], v[196:199]
    ds_read_b64_tr_b16 a[238:239], v80 offset:17408
    s_waitcnt vmcnt(2)
    buffer_store_dwordx2 v[84:85], v82, s[60:63], s77 offen sc1
    v_mfma_f32_16x16x32_bf16 v[200:203], a[220:223], a[168:171], v[200:203]
    ds_read_b64_tr_b16 a[216:217], v79 offset:18432
    v_cvt_pk_bf16_f32 v100, v152, v153
    v_mfma_f32_16x16x32_bf16 v[204:207], a[220:223], a[204:207], v[204:207]
    ds_read_b64_tr_b16 a[218:219], v79 offset:19456
    s_waitcnt lgkmcnt(6)
    v_mfma_f32_16x16x32_bf16 v[192:195], a[224:227], a[172:175], v[192:195]
    ds_read_b64_tr_b16 a[220:221], v80 offset:18432
    v_cvt_pk_bf16_f32 v101, v154, v155
    v_mfma_f32_16x16x32_bf16 v[196:199], a[224:227], a[208:211], v[196:199]
    ds_read_b64_tr_b16 a[222:223], v80 offset:19456
    buffer_store_dwordx4 v[98:101], v116, s[40:43], s71 offen offset:3072 sc1
    v_mfma_f32_16x16x32_bf16 v[200:203], a[228:231], a[172:175], v[200:203]
    ds_read_b64_tr_b16 a[224:225], v79 offset:20480
    v_cvt_pk_bf16_f32 v102, v148, v149
    v_mfma_f32_16x16x32_bf16 v[204:207], a[228:231], a[208:211], v[204:207]
    ds_read_b64_tr_b16 a[226:227], v79 offset:21504
    s_waitcnt lgkmcnt(6)
    v_mfma_f32_16x16x32_bf16 v[192:195], a[232:235], a[176:179], v[192:195]
    ds_read_b64_tr_b16 a[228:229], v80 offset:20480
    v_cvt_pk_bf16_f32 v103, v150, v151
    v_mfma_f32_16x16x32_bf16 v[196:199], a[232:235], a[212:215], v[196:199]
    ds_read_b64_tr_b16 a[230:231], v80 offset:21504
    v_mfma_f32_16x16x32_bf16 v[200:203], a[236:239], a[176:179], v[200:203]
    ds_read_b64_tr_b16 a[232:233], v79 offset:22528
    v_cvt_pk_bf16_f32 v104, v156, v157
    v_mfma_f32_16x16x32_bf16 v[204:207], a[236:239], a[212:215], v[204:207]
    ds_read_b64_tr_b16 a[234:235], v79 offset:23552
    s_waitcnt lgkmcnt(6)
    v_mfma_f32_16x16x32_bf16 v[192:195], a[216:219], a[0:3], v[192:195]
    ds_read_b64_tr_b16 a[236:237], v80 offset:22528
    v_cvt_pk_bf16_f32 v105, v158, v159
    v_mfma_f32_16x16x32_bf16 v[196:199], a[216:219], a[36:39], v[196:199]
    ds_read_b64_tr_b16 a[238:239], v80 offset:23552
    buffer_store_dwordx4 v[102:105], v125, s[40:43], s71 offen offset:1024 sc1
    v_mfma_f32_16x16x32_bf16 v[200:203], a[220:223], a[0:3], v[200:203]
    ds_read_b64_tr_b16 a[216:217], v79 offset:24576
    v_mfma_f32_16x16x32_bf16 v[204:207], a[220:223], a[36:39], v[204:207]
    ds_read_b64_tr_b16 a[218:219], v79 offset:25600
    s_waitcnt lgkmcnt(6)
    v_mfma_f32_16x16x32_bf16 v[192:195], a[224:227], a[4:7], v[192:195]
    ds_read_b64_tr_b16 a[220:221], v80 offset:24576
    v_mfma_f32_16x16x32_bf16 v[196:199], a[224:227], a[40:43], v[196:199]
    ds_read_b64_tr_b16 a[222:223], v80 offset:25600
    v_mfma_f32_16x16x32_bf16 v[200:203], a[228:231], a[4:7], v[200:203]
    ds_read_b64_tr_b16 a[224:225], v79 offset:26624
    v_mfma_f32_16x16x32_bf16 v[204:207], a[228:231], a[40:43], v[204:207]
    ds_read_b64_tr_b16 a[226:227], v79 offset:27648
    s_waitcnt lgkmcnt(6)
    v_mfma_f32_16x16x32_bf16 v[192:195], a[232:235], a[8:11], v[192:195]
    ds_read_b64_tr_b16 a[228:229], v80 offset:26624
    v_mfma_f32_16x16x32_bf16 v[196:199], a[232:235], a[44:47], v[196:199]
    ds_read_b64_tr_b16 a[230:231], v80 offset:27648
    v_mfma_f32_16x16x32_bf16 v[200:203], a[236:239], a[8:11], v[200:203]
    ds_read_b64_tr_b16 a[232:233], v79 offset:28672
    v_mfma_f32_16x16x32_bf16 v[204:207], a[236:239], a[44:47], v[204:207]
    ds_read_b64_tr_b16 a[234:235], v79 offset:29696
    s_waitcnt lgkmcnt(6)
    v_mfma_f32_16x16x32_bf16 v[192:195], a[216:219], a[12:15], v[192:195]
    ds_read_b64_tr_b16 a[236:237], v80 offset:28672
    v_mfma_f32_16x16x32_bf16 v[196:199], a[216:219], a[48:51], v[196:199]
    ds_read_b64_tr_b16 a[238:239], v80 offset:29696
    v_mfma_f32_16x16x32_bf16 v[200:203], a[220:223], a[12:15], v[200:203]
    ds_read_b64_tr_b16 a[216:217], v79 offset:30720
    v_mfma_f32_16x16x32_bf16 v[204:207], a[220:223], a[48:51], v[204:207]
    ds_read_b64_tr_b16 a[218:219], v79 offset:31744
    s_waitcnt lgkmcnt(6)
    v_mfma_f32_16x16x32_bf16 v[192:195], a[224:227], a[16:19], v[192:195]
    ds_read_b64_tr_b16 a[220:221], v80 offset:30720
    v_mfma_f32_16x16x32_bf16 v[196:199], a[224:227], a[52:55], v[196:199]
    ds_read_b64_tr_b16 a[222:223], v80 offset:31744
    v_mfma_f32_16x16x32_bf16 v[200:203], a[228:231], a[16:19], v[200:203]
    ds_read_b64_tr_b16 a[224:225], v79 offset:32768
    v_mfma_f32_16x16x32_bf16 v[204:207], a[228:231], a[52:55], v[204:207]
    ds_read_b64_tr_b16 a[226:227], v79 offset:33792
    s_waitcnt lgkmcnt(6)
    v_mfma_f32_16x16x32_bf16 v[192:195], a[232:235], a[20:23], v[192:195]
    ds_read_b64_tr_b16 a[228:229], v80 offset:32768
    v_mfma_f32_16x16x32_bf16 v[196:199], a[232:235], a[56:59], v[196:199]
    ds_read_b64_tr_b16 a[230:231], v80 offset:33792
    v_mfma_f32_16x16x32_bf16 v[200:203], a[236:239], a[20:23], v[200:203]
    ds_read_b64_tr_b16 a[232:233], v79 offset:34816
    v_mfma_f32_16x16x32_bf16 v[204:207], a[236:239], a[56:59], v[204:207]
    ds_read_b64_tr_b16 a[234:235], v79 offset:35840
    s_waitcnt lgkmcnt(6)
    v_mfma_f32_16x16x32_bf16 v[192:195], a[216:219], a[24:27], v[192:195]
    ds_read_b64_tr_b16 a[236:237], v80 offset:34816
    v_mfma_f32_16x16x32_bf16 v[196:199], a[216:219], a[60:63], v[196:199]
    ds_read_b64_tr_b16 a[238:239], v80 offset:35840
    v_mfma_f32_16x16x32_bf16 v[200:203], a[220:223], a[24:27], v[200:203]
    v_mfma_f32_16x16x32_bf16 v[204:207], a[220:223], a[60:63], v[204:207]
    s_waitcnt lgkmcnt(4)
    v_mfma_f32_16x16x32_bf16 v[192:195], a[224:227], a[28:31], v[192:195]
    v_mfma_f32_16x16x32_bf16 v[196:199], a[224:227], a[64:67], v[196:199]
    v_mfma_f32_16x16x32_bf16 v[200:203], a[228:231], a[28:31], v[200:203]
    v_mfma_f32_16x16x32_bf16 v[204:207], a[228:231], a[64:67], v[204:207]
    s_waitcnt lgkmcnt(0)
    v_mfma_f32_16x16x32_bf16 v[192:195], a[232:235], a[32:35], v[192:195]
    v_mfma_f32_16x16x32_bf16 v[196:199], a[232:235], a[68:71], v[196:199]
    buffer_load_dwordx2 v[86:87], v120, s[60:63], s76 offen sc1
    v_mfma_f32_16x16x32_bf16 v[200:203], a[236:239], a[32:35], v[200:203]
    v_mfma_f32_16x16x32_bf16 v[204:207], a[236:239], a[68:71], v[204:207]
    s_nop 7
    v_cvt_pk_bf16_f32 v90, v192, v193
    v_cvt_pk_bf16_f32 v91, v194, v195
    v_cvt_pk_bf16_f32 v92, v200, v201
    v_cvt_pk_bf16_f32 v93, v202, v203
    buffer_store_dwordx4 v[90:93], v81, s[40:43], s72 offen offset:0 sc1
    v_cvt_pk_bf16_f32 v94, v196, v197
    v_cvt_pk_bf16_f32 v95, v198, v199
    v_cvt_pk_bf16_f32 v96, v204, v205
    v_cvt_pk_bf16_f32 v97, v206, v207
    buffer_store_dwordx4 v[94:97], v119, s[40:43], s72 offen offset:2048 sc1
    s_mov_b32 s6, 0x240000
    s_mov_b32 s7, 0x20000
    s_mov_b32 s64, 0x00003f80
    s_mov_b32 s65, 0x3f800000
    s_waitcnt vmcnt(2)
    v_xor_b32 v86, v86, v84
    v_xor_b32 v87, v87, v85
    v_or_b32 v86, v86, v87
    v_cmp_ne_u32 vcc, 0, v86
    s_waitcnt lgkmcnt(0)
    s_nop 3
    s_cbranch_vccz L_t_a
    v_min_u32 v4, 7, v1
    v_lshlrev_b32 v4, 3, v4
    s_mov_b32 s74, 0
L_t_a_spin:
    buffer_load_dwordx2 v[2:3], v4, s[60:63], s76 offen sc1
    s_add_u32 s74, s74, 1
    s_waitcnt vmcnt(0)
    v_xor_b32 v2, v2, v84
    v_xor_b32 v3, v3, v85
    v_or_b32 v2, v2, v3
    v_cmp_ne_u32 vcc, 0, v2
    s_cmp_ge_u32 s74, 0x40000
    s_cbranch_scc1 L_t_a_go
    s_nop 3
    s_cbranch_vccz L_t_a_go
    s_sleep 1
    s_branch L_t_a_spin
L_t_a_go:
L_t_a:
    s_and_b32 s59, s3, 5
    s_cmp_eq_u32 s59, 1
    s_cselect_b32 s49, 0x100000, s49
    s_cmp_ge_u32 s3, 4
    s_cbranch_scc1 L_t_one
    s_lshl_b32 s58, s47, 10
    s_add_u32 s58, s58, s45
    buffer_load_dwordx4 v[128:131], v81, s[24:27], s58 offen sc1
    buffer_load_dwordx4 v[132:135], v81, s[40:43], s58 offen sc1
    s_add_u32 s58, s58, 0x240000
    buffer_load_dwordx4 v[136:139], v81, s[40:43], s58 offen sc1
    s_add_u32 s58, s58, 0x240000
    buffer_load_dwordx4 v[140:143], v81, s[40:43], s58 offen sc1
    s_add_u32 s58, s58, 0x240000
    buffer_load_dwordx4 v[144:147], v81, s[40:43], s58 offen sc1
    s_add_u32 s58, s58, 0x240000
    buffer_load_dwordx4 v[148:151], v81, s[40:43], s58 offen sc1
    s_add_u32 s58, s58, 0x240000
    buffer_load_dwordx4 v[152:155], v81, s[40:43], s58 offen sc1
    s_add_u32 s58, s58, 0x240000
    buffer_load_dwordx4 v[156:159], v81, s[40:43], s58 offen sc1
    s_add_u32 s58, s58, 0x240000
    buffer_load_dwordx4 v[160:163], v81, s[40:43], s58 offen sc1
    s_lshl_b32 s58, s48, 10
    s_add_u32 s58, s58, s45
    buffer_load_dwordx4 v[208:211], v81, s[24:27], s58 offen sc1
    buffer_load_dwordx4 v[212:215], v81, s[40:43], s58 offen sc1
    s_add_u32 s58, s58, 0x240000
    buffer_load_dwordx4 v[216:219], v81, s[40:43], s58 offen sc1
    s_add_u32 s58, s58, 0x240000
    buffer_load_dwordx4 v[220:223], v81, s[40:43], s58 offen sc1
    s_add_u32 s58, s58, 0x240000
    buffer_load_dwordx4 v[224:227], v81, s[40:43], s58 offen sc1
    s_add_u32 s58, s58, 0x240000
    buffer_load_dwordx4 v[228:231], v81, s[40:43], s58 offen sc1
    s_add_u32 s58, s58, 0x240000
    buffer_load_dwordx4 v[232:235], v81, s[40:43], s58 offen sc1
    s_add_u32 s58, s58, 0x240000
    buffer_load_dwordx4 v[236:239], v81, s[40:43], s58 offen sc1
    s_add_u32 s58, s58, 0x240000
    buffer_load_dwordx4 v[240:243], v81, s[40:43], s58 offen sc1
    s_lshl_b32 s58, s49, 10
    s_add_u32 s58, s58, s45
    buffer_load_dwordx4 v[164:167], v81, s[24:27], s58 offen sc1
    buffer_load_dwordx4 v[168:171], v81, s[40:43], s58 offen sc1
    s_add_u32 s58, s58, 0x240000
    buffer_load_dwordx4 v[172:175], v81, s[40:43], s58 offen sc1
    s_add_u32 s58, s58, 0x240000
    buffer_load_dwordx4 v[176:179], v81, s[40:43], s58 offen sc1
    s_add_u32 s58, s58, 0x240000
    buffer_load_dwordx4 v[180:183], v81, s[40:43], s58 offen sc1
    s_add_u32 s58, s58, 0x240000
    buffer_load_dwordx4 v[184:187], v81, s[40:43], s58 offen sc1
    s_add_u32 s58, s58, 0x240000
    buffer_load_dwordx4 v[188:191], v81, s[40:43], s58 offen sc1
    s_add_u32 s58, s58, 0x240000
    buffer_load_dwordx4 v[192:195], v81, s[40:43], s58 offen sc1
    s_add_u32 s58, s58, 0x240000
    buffer_load_dwordx4 v[196:199], v81, s[40:43], s58 offen sc1
    v_mov_b32 v244, 0
    v_mov_b32 v245, 0
    v_mov_b32 v246, 0
    v_mov_b32 v247, 0
    v_mov_b32 v248, 0
    v_mov_b32 v249, 0
    v_mov_b32 v250, 0
    v_mov_b32 v251, 0
    s_waitcnt vmcnt(24)
    v_dot2c_f32_bf16 v244, s64, v132
    v_dot2c_f32_bf16 v245, s65, v132
    v_dot2c_f32_bf16 v246, s64, v133
    v_dot2c_f32_bf16 v247, s65, v133
    v_dot2c_f32_bf16 v248, s64, v134
    v_dot2c_f32_bf16 v249, s65, v134
    v_dot2c_f32_bf16 v250, s64, v135
    v_dot2c_f32_bf16 v251, s65, v135
    v_dot2c_f32_bf16 v244, s64, v136
    v_dot2c_f32_bf16 v245, s65, v136
    v_dot2c_f32_bf16 v246, s64, v137
    v_dot2c_f32_bf16 v247, s65, v137
    v_dot2c_f32_bf16 v248, s64, v138
    v_dot2c_f32_bf16 v249, s65, v138
    v_dot2c_f32_bf16 v250, s64, v139
    v_dot2c_f32_bf16 v251, s65, v139
    s_waitcnt vmcnt(22)
    v_dot2c_f32_bf16 v244, s64, v140
    v_dot2c_f32_bf16 v245, s65, v140
    v_dot2c_f32_bf16 v246, s64, v141
    v_dot2c_f32_bf16 v247, s65, v141
    v_dot2c_f32_bf16 v248, s64, v142
    v_dot2c_f32_bf16 v249, s65, v142
    v_dot2c_f32_bf16 v250, s64, v143
    v_dot2c_f32_bf16 v251, s65, v143
    v_dot2c_f32_bf16 v244, s64, v144
    v_dot2c_f32_bf16 v245, s65, v144
    v_dot2c_f32_bf16 v246, s64, v145
    v_dot2c_f32_bf16 v247, s65, v145
    v_dot2c_f32_bf16 v248, s64, v146
    v_dot2c_f32_bf16 v249, s65, v146
    v_dot2c_f32_bf16 v250, s64, v147
    v_dot2c_f32_bf16 v251, s65, v147
    s_waitcnt vmcnt(20)
    v_dot2c_f32_bf16 v244, s64, v148
    v_dot2c_f32_bf16 v245, s65, v148
    v_dot2c_f32_bf16 v246, s64, v149
    v_dot2c_f32_bf16 v247, s65, v149
    v_dot2c_f32_bf16 v248, s64, v150
    v_dot2c_f32_bf16 v249, s65, v150
    v_dot2c_f32_bf16 v250, s64, v151
    v_dot2c_f32_bf16 v251, s65, v151
    v_dot2c_f32_bf16 v244, s64, v152
    v_dot2c_f32_bf16 v245, s65, v152
    v_dot2c_f32_bf16 v246, s64, v153
    v_dot2c_f32_bf16 v247, s65, v153
    v_dot2c_f32_bf16 v248, s64, v154
    v_dot2c_f32_bf16 v249, s65, v154
    v_dot2c_f32_bf16 v250, s64, v155
    v_dot2c_f32_bf16 v251, s65, v155
    s_waitcnt vmcnt(18)
    v_dot2c_f32_bf16 v244, s64, v156
    v_dot2c_f32_bf16 v245, s65, v156
    v_dot2c_f32_bf16 v246, s64, v157
    v_dot2c_f32_bf16 v247, s65, v157
    v_dot2c_f32_bf16 v248, s64, v158
    v_dot2c_f32_bf16 v249, s65, v158
    v_dot2c_f32_bf16 v250, s64, v159
    v_dot2c_f32_bf16 v251, s65, v159
    v_dot2c_f32_bf16 v244, s64, v160
    v_dot2c_f32_bf16 v245, s65, v160
    v_dot2c_f32_bf16 v246, s64, v161
    v_dot2c_f32_bf16 v247, s65, v161
    v_dot2c_f32_bf16 v248, s64, v162
    v_dot2c_f32_bf16 v249, s65, v162
    v_dot2c_f32_bf16 v250, s64, v163
    v_dot2c_f32_bf16 v251, s65, v163
    v_lshlrev_b32 v132, 16, v128
    v_and_b32 v133, 0xffff0000, v128
    v_lshlrev_b32 v134, 16, v129
    v_and_b32 v135, 0xffff0000, v129
    v_lshlrev_b32 v136, 16, v130
    v_and_b32 v137, 0xffff0000, v130
    v_lshlrev_b32 v138, 16, v131
    v_and_b32 v139, 0xffff0000, v131
    v_fmac_f32 v132, v122, v244
    v_fmac_f32 v133, v122, v245
    v_fmac_f32 v134, v122, v246
    v_fmac_f32 v135, v122, v247
    v_fmac_f32 v136, v122, v248
    v_fmac_f32 v137, v122, v249
    v_fmac_f32 v138, v122, v250
    v_fmac_f32 v139, v122, v251
    v_cvt_pk_bf16_f32 v128, v132, v133
    v_cvt_pk_bf16_f32 v129, v134, v135
    v_cvt_pk_bf16_f32 v130, v136, v137
    v_cvt_pk_bf16_f32 v131, v138, v139
    s_lshl_b32 s58, s47, 6
    s_nop 0
    v_permlane16_swap_b32 v128, v130
    v_permlane16_swap_b32 v129, v131
    buffer_store_dwordx4 v[128:131], v121, s[4:7], s58 offen
    v_mov_b32 v244, 0
    v_mov_b32 v245, 0
    v_mov_b32 v246, 0
    v_mov_b32 v247, 0
    v_mov_b32 v248, 0
    v_mov_b32 v249, 0
    v_mov_b32 v250, 0
    v_mov_b32 v251, 0
    s_waitcnt vmcnt(16)
    v_dot2c_f32_bf16 v244, s64, v212
    v_dot2c_f32_bf16 v245, s65, v212
    v_dot2c_f32_bf16 v246, s64, v213
    v_dot2c_f32_bf16 v247, s65, v213
    v_dot2c_f32_bf16 v248, s64, v214
    v_dot2c_f32_bf16 v249, s65, v214
    v_dot2c_f32_bf16 v250, s64, v215
    v_dot2c_f32_bf16 v251, s65, v215
    v_dot2c_f32_bf16 v244, s64, v216
    v_dot2c_f32_bf16 v245, s65, v216
    v_dot2c_f32_bf16 v246, s64, v217
    v_dot2c_f32_bf16 v247, s65, v217
    v_dot2c_f32_bf16 v248, s64, v218
    v_dot2c_f32_bf16 v249, s65, v218
    v_dot2c_f32_bf16 v250, s64, v219
    v_dot2c_f32_bf16 v251, s65, v219
    s_waitcnt vmcnt(14)
    v_dot2c_f32_bf16 v244, s64, v220
    v_dot2c_f32_bf16 v245, s65, v220
    v_dot2c_f32_bf16 v246, s64, v221
    v_dot2c_f32_bf16 v247, s65, v221
    v_dot2c_f32_bf16 v248, s64, v222
    v_dot2c_f32_bf16 v249, s65, v222
    v_dot2c_f32_bf16 v250, s64, v223
    v_dot2c_f32_bf16 v251, s65, v223
    v_dot2c_f32_bf16 v244, s64, v224
    v_dot2c_f32_bf16 v245, s65, v224
    v_dot2c_f32_bf16 v246, s64, v225
    v_dot2c_f32_bf16 v247, s65, v225
    v_dot2c_f32_bf16 v248, s64, v226
    v_dot2c_f32_bf16 v249, s65, v226
    v_dot2c_f32_bf16 v250, s64, v227
    v_dot2c_f32_bf16 v251, s65, v227
    s_waitcnt vmcnt(12)
    v_dot2c_f32_bf16 v244, s64, v228
    v_dot2c_f32_bf16 v245, s65, v228
    v_dot2c_f32_bf16 v246, s64, v229
    v_dot2c_f32_bf16 v247, s65, v229
    v_dot2c_f32_bf16 v248, s64, v230
    v_dot2c_f32_bf16 v249, s65, v230
    v_dot2c_f32_bf16 v250, s64, v231
    v_dot2c_f32_bf16 v251, s65, v231
    v_dot2c_f32_bf16 v244, s64, v232
    v_dot2c_f32_bf16 v245, s65, v232
    v_dot2c_f32_bf16 v246, s64, v233
    v_dot2c_f32_bf16 v247, s65, v233
    v_dot2c_f32_bf16 v248, s64, v234
    v_dot2c_f32_bf16 v249, s65, v234
    v_dot2c_f32_bf16 v250, s64, v235
    v_dot2c_f32_bf16 v251, s65, v235
    s_waitcnt vmcnt(10)
    v_dot2c_f32_bf16 v244, s64, v236
    v_dot2c_f32_bf16 v245, s65, v236
    v_dot2c_f32_bf16 v246, s64, v237
    v_dot2c_f32_bf16 v247, s65, v237
    v_dot2c_f32_bf16 v248, s64, v238
    v_dot2c_f32_bf16 v249, s65, v238
    v_dot2c_f32_bf16 v250, s64, v239
    v_dot2c_f32_bf16 v251, s65, v239
    v_dot2c_f32_bf16 v244, s64, v240
    v_dot2c_f32_bf16 v245, s65, v240
    v_dot2c_f32_bf16 v246, s64, v241
    v_dot2c_f32_bf16 v247, s65, v241
    v_dot2c_f32_bf16 v248, s64, v242
    v_dot2c_f32_bf16 v249, s65, v242
    v_dot2c_f32_bf16 v250, s64, v243
    v_dot2c_f32_bf16 v251, s65, v243
    v_lshlrev_b32 v212, 16, v208
    v_and_b32 v213, 0xffff0000, v208
    v_lshlrev_b32 v214, 16, v209
    v_and_b32 v215, 0xffff0000, v209
    v_lshlrev_b32 v216, 16, v210
    v_and_b32 v217, 0xffff0000, v210
    v_lshlrev_b32 v218, 16, v211
    v_and_b32 v219, 0xffff0000, v211
    v_fmac_f32 v212, v122, v244
    v_fmac_f32 v213, v122, v245
    v_fmac_f32 v214, v122, v246
    v_fmac_f32 v215, v122, v247
    v_fmac_f32 v216, v122, v248
    v_fmac_f32 v217, v122, v249
    v_fmac_f32 v218, v122, v250
    v_fmac_f32 v219, v122, v251
    v_cvt_pk_bf16_f32 v208, v212, v213
    v_cvt_pk_bf16_f32 v209, v214, v215
    v_cvt_pk_bf16_f32 v210, v216, v217
    v_cvt_pk_bf16_f32 v211, v218, v219
    s_lshl_b32 s58, s48, 6
    s_nop 0
    v_permlane16_swap_b32 v208, v210
    v_permlane16_swap_b32 v209, v211
    buffer_store_dwordx4 v[208:211], v121, s[4:7], s58 offen
    s_branch L_t_late
L_t_one:
    s_lshl_b32 s58, s47, 10
    s_add_u32 s58, s58, s45
    buffer_load_dwordx4 v[128:131], v81, s[24:27], s58 offen sc1
    buffer_load_dwordx4 v[132:135], v81, s[40:43], s58 offen sc1
    s_add_u32 s58, s58, 0x240000
    buffer_load_dwordx4 v[136:139], v81, s[40:43], s58 offen sc1
    s_add_u32 s58, s58, 0x240000
    buffer_load_dwordx4 v[140:143], v81, s[40:43], s58 offen sc1
    s_add_u32 s58, s58, 0x240000
    buffer_load_dwordx4 v[144:147], v81, s[40:43], s58 offen sc1
    s_add_u32 s58, s58, 0x240000
    buffer_load_dwordx4 v[148:151], v81, s[40:43], s58 offen sc1
    s_add_u32 s58, s58, 0x240000
    buffer_load_dwordx4 v[152:155], v81, s[40:43], s58 offen sc1
    s_add_u32 s58, s58, 0x240000
    buffer_load_dwordx4 v[156:159], v81, s[40:43], s58 offen sc1
    s_add_u32 s58, s58, 0x240000
    buffer_load_dwordx4 v[160:163], v81, s[40:43], s58 offen sc1
    s_lshl_b32 s58, s49, 10
    s_add_u32 s58, s58, s45
    buffer_load_dwordx4 v[164:167], v81, s[24:27], s58 offen sc1
    buffer_load_dwordx4 v[168:171], v81, s[40:43], s58 offen sc1
    s_add_u32 s58, s58, 0x240000
    buffer_load_dwordx4 v[172:175], v81, s[40:43], s58 offen sc1
    s_add_u32 s58, s58, 0x240000
    buffer_load_dwordx4 v[176:179], v81, s[40:43], s58 offen sc1
    s_add_u32 s58, s58, 0x240000
    buffer_load_dwordx4 v[180:183], v81, s[40:43], s58 offen sc1
    s_add_u32 s58, s58, 0x240000
    buffer_load_dwordx4 v[184:187], v81, s[40:43], s58 offen sc1
    s_add_u32 s58, s58, 0x240000
    buffer_load_dwordx4 v[188:191], v81, s[40:43], s58 offen sc1
    s_add_u32 s58, s58, 0x240000
    buffer_load_dwordx4 v[192:195], v81, s[40:43], s58 offen sc1
    s_add_u32 s58, s58, 0x240000
    buffer_load_dwordx4 v[196:199], v81, s[40:43], s58 offen sc1
    v_mov_b32 v244, 0
    v_mov_b32 v245, 0
    v_mov_b32 v246, 0
    v_mov_b32 v247, 0
    v_mov_b32 v248, 0
    v_mov_b32 v249, 0
    v_mov_b32 v250, 0
    v_mov_b32 v251, 0
    s_waitcnt vmcnt(15)
    v_dot2c_f32_bf16 v244, s64, v132
    v_dot2c_f32_bf16 v245, s65, v132
    v_dot2c_f32_bf16 v246, s64, v133
    v_dot2c_f32_bf16 v247, s65, v133
    v_dot2c_f32_bf16 v248, s64, v134
    v_dot2c_f32_bf16 v249, s65, v134
    v_dot2c_f32_bf16 v250, s64, v135
    v_dot2c_f32_bf16 v251, s65, v135
    v_dot2c_f32_bf16 v244, s64, v136
    v_dot2c_f32_bf16 v245, s65, v136
    v_dot2c_f32_bf16 v246, s64, v137
    v_dot2c_f32_bf16 v247, s65, v137
    v_dot2c_f32_bf16 v248, s64, v138
    v_dot2c_f32_bf16 v249, s65, v138
    v_dot2c_f32_bf16 v250, s64, v139
    v_dot2c_f32_bf16 v251, s65, v139
    s_waitcnt vmcnt(13)
    v_dot2c_f32_bf16 v244, s64, v140
    v_dot2c_f32_bf16 v245, s65, v140
    v_dot2c_f32_bf16 v246, s64, v141
    v_dot2c_f32_bf16 v247, s65, v141
    v_dot2c_f32_bf16 v248, s64, v142
    v_dot2c_f32_bf16 v249, s65, v142
    v_dot2c_f32_bf16 v250, s64, v143
    v_dot2c_f32_bf16 v251, s65, v143
    v_dot2c_f32_bf16 v244, s64, v144
    v_dot2c_f32_bf16 v245, s65, v144
    v_dot2c_f32_bf16 v246, s64, v145
    v_dot2c_f32_bf16 v247, s65, v145
    v_dot2c_f32_bf16 v248, s64, v146
    v_dot2c_f32_bf16 v249, s65, v146
    v_dot2c_f32_bf16 v250, s64, v147
    v_dot2c_f32_bf16 v251, s65, v147
    s_waitcnt vmcnt(11)
    v_dot2c_f32_bf16 v244, s64, v148
    v_dot2c_f32_bf16 v245, s65, v148
    v_dot2c_f32_bf16 v246, s64, v149
    v_dot2c_f32_bf16 v247, s65, v149
    v_dot2c_f32_bf16 v248, s64, v150
    v_dot2c_f32_bf16 v249, s65, v150
    v_dot2c_f32_bf16 v250, s64, v151
    v_dot2c_f32_bf16 v251, s65, v151
    v_dot2c_f32_bf16 v244, s64, v152
    v_dot2c_f32_bf16 v245, s65, v152
    v_dot2c_f32_bf16 v246, s64, v153
    v_dot2c_f32_bf16 v247, s65, v153
    v_dot2c_f32_bf16 v248, s64, v154
    v_dot2c_f32_bf16 v249, s65, v154
    v_dot2c_f32_bf16 v250, s64, v155
    v_dot2c_f32_bf16 v251, s65, v155
    s_waitcnt vmcnt(9)
    v_dot2c_f32_bf16 v244, s64, v156
    v_dot2c_f32_bf16 v245, s65, v156
    v_dot2c_f32_bf16 v246, s64, v157
    v_dot2c_f32_bf16 v247, s65, v157
    v_dot2c_f32_bf16 v248, s64, v158
    v_dot2c_f32_bf16 v249, s65, v158
    v_dot2c_f32_bf16 v250, s64, v159
    v_dot2c_f32_bf16 v251, s65, v159
    v_dot2c_f32_bf16 v244, s64, v160
    v_dot2c_f32_bf16 v245, s65, v160
    v_dot2c_f32_bf16 v246, s64, v161
    v_dot2c_f32_bf16 v247, s65, v161
    v_dot2c_f32_bf16 v248, s64, v162
    v_dot2c_f32_bf16 v249, s65, v162
    v_dot2c_f32_bf16 v250, s64, v163
    v_dot2c_f32_bf16 v251, s65, v163
    v_lshlrev_b32 v132, 16, v128
    v_and_b32 v133, 0xffff0000, v128
    v_lshlrev_b32 v134, 16, v129
    v_and_b32 v135, 0xffff0000, v129
    v_lshlrev_b32 v136, 16, v130
    v_and_b32 v137, 0xffff0000, v130
    v_lshlrev_b32 v138, 16, v131
    v_and_b32 v139, 0xffff0000, v131
    v_fmac_f32 v132, v122, v244
    v_fmac_f32 v133, v122, v245
    v_fmac_f32 v134, v122, v246
    v_fmac_f32 v135, v122, v247
    v_fmac_f32 v136, v122, v248
    v_fmac_f32 v137, v122, v249
    v_fmac_f32 v138, v122, v250
    v_fmac_f32 v139, v122, v251
    v_cvt_pk_bf16_f32 v128, v132, v133
    v_cvt_pk_bf16_f32 v129, v134, v135
    v_cvt_pk_bf16_f32 v130, v136, v137
    v_cvt_pk_bf16_f32 v131, v138, v139
    s_lshl_b32 s58, s47, 6
    s_nop 0
    v_permlane16_swap_b32 v128, v130
    v_permlane16_swap_b32 v129, v131
    buffer_store_dwordx4 v[128:131], v121, s[4:7], s58 offen
L_t_late:
    s_mov_b32 s74, 0
    s_waitcnt vmcnt(1)
L_t_try:
    v_max3_u32 v2, v168, v169, v170
    v_max3_u32 v3, v171, v172, v173
    v_max3_u32 v2, v2, v174, v175
    v_max3_u32 v3, v3, v176, v177
    v_max3_u32 v2, v2, v178, v179
    v_max3_u32 v3, v3, v180, v181
    v_max3_u32 v2, v2, v182, v183
    v_max3_u32 v3, v3, v184, v185
    v_max3_u32 v2, v2, v186, v187
    v_max3_u32 v3, v3, v188, v189
    v_max3_u32 v2, v2, v190, v191
    v_max3_u32 v3, v3, v192, v193
    v_max3_u32 v2, v2, v194, v195
    v_max3_u32 v3, v3, v196, v197
    v_max3_u32 v2, v2, v198, v199
    v_max_u32 v2, v2, v3
    v_cmp_eq_u32 vcc, -1, v2
    s_add_u32 s74, s74, 1
    s_cmp_ge_u32 s74, 0x40000
    s_cbranch_scc1 L_t_got
    s_nop 2
    s_cbranch_vccz L_t_got
    s_lshl_b32 s58, s49, 10
    s_add_u32 s58, s58, s45
    buffer_load_dwordx4 v[164:167], v81, s[24:27], s58 offen sc1
    buffer_load_dwordx4 v[168:171], v81, s[40:43], s58 offen sc1
    s_add_u32 s58, s58, 0x240000
    buffer_load_dwordx4 v[172:175], v81, s[40:43], s58 offen sc1
    s_add_u32 s58, s58, 0x240000
    buffer_load_dwordx4 v[176:179], v81, s[40:43], s58 offen sc1
    s_add_u32 s58, s58, 0x240000
    buffer_load_dwordx4 v[180:183], v81, s[40:43], s58 offen sc1
    s_add_u32 s58, s58, 0x240000
    buffer_load_dwordx4 v[184:187], v81, s[40:43], s58 offen sc1
    s_add_u32 s58, s58, 0x240000
    buffer_load_dwordx4 v[188:191], v81, s[40:43], s58 offen sc1
    s_add_u32 s58, s58, 0x240000
    buffer_load_dwordx4 v[192:195], v81, s[40:43], s58 offen sc1
    s_add_u32 s58, s58, 0x240000
    buffer_load_dwordx4 v[196:199], v81, s[40:43], s58 offen sc1
    s_waitcnt vmcnt(0)
    s_branch L_t_try
L_t_got:
    v_mov_b32 v244, 0
    v_mov_b32 v245, 0
    v_mov_b32 v246, 0
    v_mov_b32 v247, 0
    v_mov_b32 v248, 0
    v_mov_b32 v249, 0
    v_mov_b32 v250, 0
    v_mov_b32 v251, 0
    s_waitcnt vmcnt(56)
    v_dot2c_f32_bf16 v244, s64, v168
    v_dot2c_f32_bf16 v245, s65, v168
    v_dot2c_f32_bf16 v246, s64, v169
    v_dot2c_f32_bf16 v247, s65, v169
    v_dot2c_f32_bf16 v248, s64, v170
    v_dot2c_f32_bf16 v249, s65, v170
    v_dot2c_f32_bf16 v250, s64, v171
    v_dot2c_f32_bf16 v251, s65, v171
    v_dot2c_f32_bf16 v244, s64, v172
    v_dot2c_f32_bf16 v245, s65, v172
    v_dot2c_f32_bf16 v246, s64, v173
    v_dot2c_f32_bf16 v247, s65, v173
    v_dot2c_f32_bf16 v248, s64, v174
    v_dot2c_f32_bf16 v249, s65, v174
    v_dot2c_f32_bf16 v250, s64, v175
    v_dot2c_f32_bf16 v251, s65, v175
    s_waitcnt vmcnt(54)
    v_dot2c_f32_bf16 v244, s64, v176
    v_dot2c_f32_bf16 v245, s65, v176
    v_dot2c_f32_bf16 v246, s64, v177
    v_dot2c_f32_bf16 v247, s65, v177
    v_dot2c_f32_bf16 v248, s64, v178
    v_dot2c_f32_bf16 v249, s65, v178
    v_dot2c_f32_bf16 v250, s64, v179
    v_dot2c_f32_bf16 v251, s65, v179
    v_dot2c_f32_bf16 v244, s64, v180
    v_dot2c_f32_bf16 v245, s65, v180
    v_dot2c_f32_bf16 v246, s64, v181
    v_dot2c_f32_bf16 v247, s65, v181
    v_dot2c_f32_bf16 v248, s64, v182
    v_dot2c_f32_bf16 v249, s65, v182
    v_dot2c_f32_bf16 v250, s64, v183
    v_dot2c_f32_bf16 v251, s65, v183
    s_waitcnt vmcnt(52)
    v_dot2c_f32_bf16 v244, s64, v184
    v_dot2c_f32_bf16 v245, s65, v184
    v_dot2c_f32_bf16 v246, s64, v185
    v_dot2c_f32_bf16 v247, s65, v185
    v_dot2c_f32_bf16 v248, s64, v186
    v_dot2c_f32_bf16 v249, s65, v186
    v_dot2c_f32_bf16 v250, s64, v187
    v_dot2c_f32_bf16 v251, s65, v187
    v_dot2c_f32_bf16 v244, s64, v188
    v_dot2c_f32_bf16 v245, s65, v188
    v_dot2c_f32_bf16 v246, s64, v189
    v_dot2c_f32_bf16 v247, s65, v189
    v_dot2c_f32_bf16 v248, s64, v190
    v_dot2c_f32_bf16 v249, s65, v190
    v_dot2c_f32_bf16 v250, s64, v191
    v_dot2c_f32_bf16 v251, s65, v191
    s_waitcnt vmcnt(50)
    v_dot2c_f32_bf16 v244, s64, v192
    v_dot2c_f32_bf16 v245, s65, v192
    v_dot2c_f32_bf16 v246, s64, v193
    v_dot2c_f32_bf16 v247, s65, v193
    v_dot2c_f32_bf16 v248, s64, v194
    v_dot2c_f32_bf16 v249, s65, v194
    v_dot2c_f32_bf16 v250, s64, v195
    v_dot2c_f32_bf16 v251, s65, v195
    v_dot2c_f32_bf16 v244, s64, v196
    v_dot2c_f32_bf16 v245, s65, v196
    v_dot2c_f32_bf16 v246, s64, v197
    v_dot2c_f32_bf16 v247, s65, v197
    v_dot2c_f32_bf16 v248, s64, v198
    v_dot2c_f32_bf16 v249, s65, v198
    v_dot2c_f32_bf16 v250, s64, v199
    v_dot2c_f32_bf16 v251, s65, v199
    v_lshlrev_b32 v168, 16, v164
    v_and_b32 v169, 0xffff0000, v164
    v_lshlrev_b32 v170, 16, v165
    v_and_b32 v171, 0xffff0000, v165
    v_lshlrev_b32 v172, 16, v166
    v_and_b32 v173, 0xffff0000, v166
    v_lshlrev_b32 v174, 16, v167
    v_and_b32 v175, 0xffff0000, v167
    v_fmac_f32 v168, v122, v244
    v_fmac_f32 v169, v122, v245
    v_fmac_f32 v170, v122, v246
    v_fmac_f32 v171, v122, v247
    v_fmac_f32 v172, v122, v248
    v_fmac_f32 v173, v122, v249
    v_fmac_f32 v174, v122, v250
    v_fmac_f32 v175, v122, v251
    v_cvt_pk_bf16_f32 v164, v168, v169
    v_cvt_pk_bf16_f32 v165, v170, v171
    v_cvt_pk_bf16_f32 v166, v172, v173
    v_cvt_pk_bf16_f32 v167, v174, v175
    s_lshl_b32 s58, s49, 6
    s_nop 0
    v_permlane16_swap_b32 v164, v166
    v_permlane16_swap_b32 v165, v167
    buffer_store_dwordx4 v[164:167], v121, s[4:7], s58 offen
L_t_done:
L_k3_end:
    s_endpgm
L_k3_slow0:
    s_mov_b32 s58, 0
L_k3_spin0:
    s_sleep 2
    buffer_load_dwordx2 v[86:87], v82, s[60:63], s69 offen offset:0 sc1
    s_add_u32 s58, s58, 1
    s_waitcnt vmcnt(0)
    v_readfirstlane_b32 s74, v86
    v_readfirstlane_b32 s75, v87
    s_cmp_eq_u64 s[74:75], s[100:101]
    s_cbranch_scc1 L_k3_back0
    s_cmp_lt_u32 s58, 0x40000
    s_cbranch_scc1 L_k3_spin0
    s_branch L_k3_back0
L_k3_slow1:
    s_mov_b32 s58, 0
L_k3_spin1:
    s_sleep 2
    buffer_load_dwordx2 v[126:127], v82, s[60:63], s69 offen offset:32 sc1
    s_add_u32 s58, s58, 1
    s_waitcnt vmcnt(0)
    v_readfirstlane_b32 s74, v126
    v_readfirstlane_b32 s75, v127
    s_cmp_eq_u64 s[74:75], s[100:101]
    s_cbranch_scc1 L_k3_back1
    s_cmp_lt_u32 s58, 0x40000
    s_cbranch_scc1 L_k3_spin1
    s_branch L_k3_back1
L_k3_slow2:
    s_mov_b32 s58, 0
L_k3_spin2:
    s_sleep 2
    buffer_load_dwordx2 v[106:107], v82, s[60:63], s69 offen offset:64 sc1
    s_add_u32 s58, s58, 1
    s_waitcnt vmcnt(0)
    v_readfirstlane_b32 s74, v106
    v_readfirstlane_b32 s75, v107
    s_cmp_eq_u64 s[74:75], s[100:101]
    s_cbranch_scc1 L_k3_back2
    s_cmp_lt_u32 s58, 0x40000
    s_cbranch_scc1 L_k3_spin2
    s_branch L_k3_back2
L_f_cs_slow:
    s_mov_b32 s75, 0
L_f_cs_spin:
    s_sleep 2
    s_movk_i32 s58, 18432
    s_mov_b32 s59, 36864
    buffer_load_dwordx4 v[244:247], v11, s[32:35], 0 offen sc1
    buffer_load_dwordx4 v[248:251], v11, s[32:35], s58 offen sc1
    buffer_load_dwordx4 v[252:255], v11, s[32:35], s59 offen sc1
    s_add_u32 s75, s75, 1
    s_waitcnt vmcnt(0)
    v_mov_b32 v2, 0
    v_xor_b32 v244, s76, v244
    v_xor_b32 v245, s77, v245
    v_xor_b32 v246, s44, v246
    v_xor_b32 v247, s45, v247
    v_or3_b32 v2, v2, v244, v245
    v_or3_b32 v2, v2, v246, v247
    v_xor_b32 v248, s76, v248
    v_xor_b32 v249, s77, v249
    v_xor_b32 v250, s44, v250
    v_xor_b32 v251, s45, v251
    v_or3_b32 v2, v2, v248, v249
    v_or3_b32 v2, v2, v250, v251
    v_xor_b32 v252, s76, v252
    v_xor_b32 v253, s77, v253
    v_xor_b32 v254, s44, v254
    v_xor_b32 v255, s45, v255
    v_or3_b32 v2, v2, v252, v253
    v_or3_b32 v2, v2, v254, v255
    v_cmp_gt_u32 vcc, 18, v1
    v_and_b32 v2, 0xfff, v2
    s_nop 0
    v_cndmask_b32 v2, 0, v2, vcc
    v_cmp_ne_u32 vcc, 0, v2
    s_nop 4
    s_cbranch_vccz L_f_cs_ok
    s_cmp_lt_u32 s75, 0x10000
    s_cbranch_scc1 L_f_cs_spin
    s_branch L_f_cs_ok
L_k3_last:
L_text_last:
.section .rodata,"a"
.p2align 6
.amdhsa_kernel sequential_preLN__linear_kernel_hedgehog__dense_activation_relu__prompt_kernel
  .amdhsa_next_free_vgpr 512
  .amdhsa_next_free_sgpr 102
  .amdhsa_accum_offset 256
  .amdhsa_group_segment_fixed_size 0
  .amdhsa_kernarg_size 80
  .amdhsa_user_sgpr_count 2
  .amdhsa_user_sgpr_kernarg_segment_ptr 1
  .amdhsa_system_sgpr_workgroup_id_x 1
.end_amdhsa_kernel
```
